```python
import torch

def _softmax(x, axis=-1):
    return torch.softmax(x, dim=axis)
def _gelu(x):
    return torch.nn.functional.gelu(x, approximate="tanh")
def _silu(x):
    return torch.nn.functional.silu(x)
def _sigmoid(x):
    return torch.sigmoid(x)
def _layernorm(x, axis=-1, eps=1e-5):
    m = x.mean(dim=axis, keepdim=True)
    v = x.var(dim=axis, keepdim=True, unbiased=False)
    return (x - m) / torch.sqrt(v + eps)
def _scatter_add(tgt, idx, src, axis=0):
    return tgt.clone().index_add_(axis, idx, src)
def _segment_sum(src, seg, n):
    out = torch.zeros((n,) + src.shape[1:], dtype=src.dtype)
    return out.index_add_(0, seg, src)
def _pad(x, pw):
    flat = tuple(v for pair in reversed(pw) for v in pair)
    return torch.nn.functional.pad(x, flat)

kernel_name = 'standalone__mha_softmax__near_ridge'

def setup_inputs():

    _w = (lambda a: (lambda t: t.to(torch.bfloat16) if t.is_floating_point() else t)(torch.as_tensor(a)))
    B, H, Sq, Sk, D = 16, 32, 304, 1024, 128
    return {
        "q": _w((lambda *s: torch.randn(*s, dtype=torch.bfloat16) * 0.8)(B, H, Sq, D)),
        "k": _w((lambda *s: torch.randn(*s, dtype=torch.bfloat16) * 0.8)(B, H, Sk, D)),
        "v": _w((lambda *s: torch.randn(*s, dtype=torch.bfloat16) * 0.05)(B, H, Sk, D)),
    }

def reference(q, k, v):
    scale = q.shape[-1] ** -0.5
    scores = torch.einsum("bhqd,bhkd->bhqk", q, k) * scale
    p = _softmax(scores, axis=-1)
    return torch.einsum("bhqk,bhkd->bhqd", p, v)
```

```asm
; @launch grid=(256,1,1) block=(256,1,1) lds=163840
.amdgcn_target "amdgcn-amd-amdhsa--gfx950"
.text
.globl standalone__mha_softmax__near_ridge_kernel
.p2align 8
.type standalone__mha_softmax__near_ridge_kernel,@function
standalone__mha_softmax__near_ridge_kernel:
    s_cmp_ge_u32 s2, 256
    s_cbranch_scc1 L_exit
    s_load_dwordx8 s[4:11], s[0:1], 0
    s_getpc_b64 s[56:57]
    v_lshlrev_b32 v181, 7, v0
    v_add_u32 v182, 0x8000, v181
    v_min_u32 v182, L_exit-standalone__mha_softmax__near_ridge_kernel-64, v182
    global_load_dword v184, v181, s[56:57]
    global_load_dword v184, v182, s[56:57]
    s_getreg_b32 s60, hwreg(HW_REG_XCC_ID)
    s_lshr_b32 s3, s2, 3
    s_and_b32 s54, s2, 7
    s_lshl_b32 s54, s54, 5
    s_or_b32 s3, s3, s54
    v_lshrrev_b32 v181, 6, v0
    v_and_b32 v0, 63, v0
    v_lshrrev_b32 v182, 4, v0
    v_readfirstlane_b32 s47, v181
    v_and_b32 v183, 15, v0
    v_lshlrev_b32 v181, 1, v182
    v_xor_b32 v183, v183, v181
    v_lshlrev_b32 v183, 4, v183
    v_lshl_or_b32 v100, v182, 8, v183
    s_lshl_b32 s36, s47, 12
    s_lshr_b32 s54, s47, 1
    s_mul_i32 s54, s54, 0x90
    s_and_b32 s55, s47, 1
    s_lshl_b32 s55, s55, 7
    s_xor_b32 s54, s54, s55
    s_or_b32 s61, s54, s36
    v_xor_b32 v1, s61, v100
    s_lshl_b32 s54, s3, 19
    s_mov_b32 s33, 524288
    s_mov_b32 s15, 0x00020000
    s_mov_b32 s19, 0x00020000
    s_mov_b32 s23, 0x00020000
    s_mov_b32 s27, 0x00020000
    s_mov_b32 s22, 77824
    s_mov_b32 s26, 77824
    s_mov_b32 s45, 0
    s_mov_b32 s46, 0
    s_mov_b32 s63, 0
    s_mov_b32 s64, 0
    v_and_b32 v181, 15, v0
    v_lshlrev_b32 v181, 8, v181
    v_lshl_or_b32 v181, v182, 4, v181
    s_add_u32 s55, s36, 65536
    v_add_u32 v15, s55, v181
    s_waitcnt lgkmcnt(0)
    s_add_u32 s12, s6, s54
    s_addc_u32 s13, s7, 0
    s_add_u32 s16, s8, s54
    s_addc_u32 s17, s9, 0
    s_mov_b32 s20, s10
    s_mov_b32 s21, s11
L_start:
    v_mbcnt_lo_u32_b32 v0, -1, 0
    v_mbcnt_hi_u32_b32 v0, -1, v0
    s_lshl_b32 s54, s3, 1
    s_add_u32 s54, s54, s63
    s_mul_i32 s54, s54, 77824
    s_add_u32 s24, s4, s54
    s_addc_u32 s25, s5, 0
    s_mov_b32 s49, 0
    s_lshl_b32 s28, s63, 18
    s_mov_b32 s30, s28
    s_mov_b32 s14, s33
    s_mov_b32 s18, s33
    s_mov_b32 s35, 0
    s_mov_b32 s53, 16
    s_mov_b32 s52, 65536
    v_xor_b32 v100, s61, v1
    v_and_b32 v108, 0xff, v100
    v_bfe_u32 v181, v0, 4, 1
    v_lshl_or_b32 v108, v181, 8, v108
    v_lshrrev_b32 v181, 5, v0
    v_lshl_or_b32 v108, v181, 9, v108
    s_and_b32 s54, s61, 0xff
    v_xor_b32 v98, s54, v108
    v_xor_b32 v109, 0x80, v108
    v_xor_b32 v110, 0x90, v108
    v_xor_b32 v111, 0x10, v108
    s_and_b32 s54, s47, 1
    s_lshl_b32 s54, s54, 16
    s_lshr_b32 s55, s47, 1
    s_lshl_b32 s55, s55, 17
    s_or_b32 s54, s54, s55
    s_add_u32 s54, s54, s28
    s_add_u32 m0, s36, 0
    s_add_u32 s38, s54, 0
    buffer_load_dwordx4 v98, s[12:15], s38 offen nt lds
    s_add_u32 m0, s36, 1024
    s_add_u32 s38, s54, 16384
    buffer_load_dwordx4 v98, s[12:15], s38 offen nt lds
    s_add_u32 m0, s36, 2048
    s_add_u32 s38, s54, 32768
    buffer_load_dwordx4 v98, s[12:15], s38 offen nt lds
    s_add_u32 m0, s36, 3072
    s_add_u32 s38, s54, 49152
    buffer_load_dwordx4 v98, s[12:15], s38 offen nt lds
    v_xor_b32 v101, 4224, v100
    v_xor_b32 v102, 8336, v100
    v_xor_b32 v103, 12304, v100
    s_lshl_b32 s29, s47, 14
    s_add_u32 m0, s29, 98304
    s_nop 0
    buffer_load_dwordx4 v100, s[24:27], s29 offen nt lds
    s_add_u32 m0, s29, 102400
    s_nop 0
    buffer_load_dwordx4 v101, s[24:27], s29 offen nt lds
    s_add_u32 m0, s29, 106496
    s_nop 0
    buffer_load_dwordx4 v102, s[24:27], s29 offen nt lds
    s_add_u32 m0, s29, 110592
    s_nop 0
    buffer_load_dwordx4 v103, s[24:27], s29 offen nt lds
    s_add_u32 m0, s29, 98304
    s_nop 0
    buffer_load_dwordx4 v100, s[24:27], s29 offen offset:1024 nt lds
    s_add_u32 m0, s29, 102400
    s_nop 0
    buffer_load_dwordx4 v101, s[24:27], s29 offen offset:1024 nt lds
    s_add_u32 m0, s29, 106496
    s_nop 0
    buffer_load_dwordx4 v102, s[24:27], s29 offen offset:1024 nt lds
    s_add_u32 m0, s29, 110592
    s_nop 0
    buffer_load_dwordx4 v103, s[24:27], s29 offen offset:1024 nt lds
    s_add_u32 m0, s29, 98304
    s_nop 0
    buffer_load_dwordx4 v100, s[24:27], s29 offen offset:2048 nt lds
    s_add_u32 m0, s29, 102400
    s_nop 0
    buffer_load_dwordx4 v101, s[24:27], s29 offen offset:2048 nt lds
    s_add_u32 m0, s29, 106496
    s_nop 0
    buffer_load_dwordx4 v102, s[24:27], s29 offen offset:2048 nt lds
    s_add_u32 m0, s29, 110592
    s_nop 0
    buffer_load_dwordx4 v103, s[24:27], s29 offen offset:2048 nt lds
    v_and_b32 v181, 3, v0
    v_bfe_u32 v182, v0, 2, 2
    v_lshl_or_b32 v183, v182, 4, v181
    v_lshlrev_b32 v14, 8, v183
    v_and_b32 v181, 7, v0
    v_lshlrev_b32 v181, 1, v181
    v_bfe_u32 v182, v0, 3, 1
    v_mul_u32_u24 v182, 9, v182
    v_xor_b32 v181, v181, v182
    v_lshrrev_b32 v182, 4, v0
    v_xor_b32 v181, v181, v182
    v_lshl_or_b32 v14, v181, 4, v14
    v_bfe_u32 v181, v0, 2, 2
    v_lshrrev_b32 v182, 4, v0
    v_lshl_or_b32 v183, v182, 4, v181
    v_lshlrev_b32 v6, 8, v183
    v_bfe_u32 v181, v0, 2, 3
    v_lshlrev_b32 v181, 1, v181
    v_lshrrev_b32 v182, 5, v0
    v_mul_u32_u24 v182, 9, v182
    v_xor_b32 v181, v181, v182
    v_bfe_u32 v182, v0, 1, 1
    v_xor_b32 v181, v181, v182
    v_lshl_or_b32 v6, v181, 4, v6
    v_and_b32 v182, 1, v0
    v_lshl_or_b32 v6, v182, 3, v6
    v_add_u32 v6, 49152, v6
    v_and_b32 v181, 15, v0
    v_lshrrev_b32 v182, 4, v0
    v_xor_b32 v183, v181, v182
    v_lshlrev_b32 v183, 4, v183
    v_lshl_or_b32 v17, v182, 8, v183
    v_and_b32 v183, 7, v0
    v_lshrrev_b32 v16, 5, v0
    v_xor_b32 v183, v183, v16
    v_lshlrev_b32 v183, 4, v183
    v_lshl_or_b32 v16, v181, 8, v183
    v_and_b32 v182, 1, v182
    v_lshl_or_b32 v16, v182, 3, v16
    v_lshlrev_b32 v18, 4, v0
    s_mov_b32 s50, 0x3e0293ee
    s_mov_b32 s51, 0x3e0293ee
    s_mov_b32 s62, 0x53800000
    s_mov_b32 s39, 0xffff0000
    s_lshl_b32 s54, s47, 14
    s_add_u32 s54, s54, 98304
    v_xor_b32 v2, 0, v14
    v_xor_b32 v3, 64, v14
    v_xor_b32 v4, 128, v14
    v_xor_b32 v5, 192, v14
    v_xor_b32 v7, 32, v6
    v_xor_b32 v8, 64, v6
    v_xor_b32 v9, 96, v6
    v_xor_b32 v10, 128, v6
    v_xor_b32 v11, 160, v6
    v_xor_b32 v12, 192, v6
    v_xor_b32 v13, 224, v6
    v_add_u32 v14, s54, v14
    v_mov_b32 v132, 0
    v_mov_b32 v133, 0
    v_mov_b32 v134, 0
    v_mov_b32 v135, 0
    v_xor_b32 v180, 0, v14
    v_xor_b32 v181, 64, v14
    v_xor_b32 v182, 128, v14
    v_xor_b32 v183, 192, v14
    v_and_b32 v0, 1, v0
    v_mul_u32_u24 v0, 0xaaaa, v0
    v_add_u32 v0, 0x4444, v0
    v_lshl_or_b32 v0, v0, 16, v0
    v_mfma_f32_32x32x16_bf16 a[0:15], v[132:135], v[132:135], 0
    v_mfma_f32_32x32x16_bf16 a[16:31], v[132:135], v[132:135], 0
    v_mfma_f32_32x32x16_bf16 a[32:47], v[132:135], v[132:135], 0
    v_mfma_f32_32x32x16_bf16 a[48:63], v[132:135], v[132:135], 0
    v_mfma_f32_32x32x16_bf16 a[64:79], v[132:135], v[132:135], 0
    v_mfma_f32_32x32x16_bf16 a[80:95], v[132:135], v[132:135], 0
    v_mfma_f32_32x32x16_bf16 a[96:111], v[132:135], v[132:135], 0
    v_mfma_f32_32x32x16_bf16 a[112:127], v[132:135], v[132:135], 0
    v_mfma_f32_32x32x16_bf16 a[128:143], v[132:135], v[132:135], 0
    v_mfma_f32_32x32x16_bf16 a[144:159], v[132:135], v[132:135], 0
    s_waitcnt vmcnt(12)
    s_barrier
    ds_read_b128 v[184:187], v2
    ds_read_b128 v[188:191], v3
    ds_read_b128 v[192:195], v4
    ds_read_b128 v[196:199], v5
    ds_read_b128 v[200:203], v5 offset:1024
    ds_read_b128 v[204:207], v4 offset:1024
    ds_read_b128 v[208:211], v3 offset:1024
    ds_read_b128 v[212:215], v2 offset:1024
    ds_read_b128 v[216:219], v2 offset:2048
    ds_read_b128 v[220:223], v3 offset:2048
    ds_read_b128 v[224:227], v4 offset:2048
    ds_read_b128 v[228:231], v5 offset:2048
    ds_read_b128 v[232:235], v5 offset:3072
    ds_read_b128 v[236:239], v4 offset:3072
    ds_read_b128 v[240:243], v3 offset:3072
    ds_read_b128 v[244:247], v2 offset:3072
    s_branch L_pro
L_trans:
    s_cmp_eq_u32 s48, 0
    s_cbranch_scc1 L_final
    s_lshl_b32 s40, s47, 14
    s_add_u32 s54, s40, 98304
    v_add_u32 v122, s54, v16
    v_add_u32 v126, s54, v17
    v_xor_b32 v123, 32, v122
    v_xor_b32 v124, 64, v122
    v_xor_b32 v125, 96, v122
    v_xor_b32 v127, 64, v126
    s_mov_b32 s35, 13
    s_mov_b32 s53, 15
    s_cmp_eq_u32 s47, 3
    s_cbranch_scc0 L_m4
    v_add_u32 v96, 98304, v17
    v_xor_b32 v97, 64, v96
    s_branch L_m03
L_m4:
    v_accvgpr_read_b32 v136, a128
    v_accvgpr_read_b32 v137, a129
    v_accvgpr_read_b32 v138, a130
    v_accvgpr_read_b32 v139, a131
    v_pk_mul_f32 v[136:137], v[136:137], v[120:121] op_sel_hi:[1,0]
    v_pk_mul_f32 v[138:139], v[138:139], v[120:121] op_sel_hi:[1,0]
    v_cvt_pk_bf16_f32 v136, v136, v137
    v_cvt_pk_bf16_f32 v137, v138, v139
    v_accvgpr_read_b32 v140, a132
    v_accvgpr_read_b32 v141, a133
    v_accvgpr_read_b32 v142, a134
    v_accvgpr_read_b32 v143, a135
    v_pk_mul_f32 v[140:141], v[140:141], v[120:121] op_sel_hi:[1,0]
    v_pk_mul_f32 v[142:143], v[142:143], v[120:121] op_sel_hi:[1,0]
    v_cvt_pk_bf16_f32 v140, v140, v141
    v_cvt_pk_bf16_f32 v141, v142, v143
    v_accvgpr_read_b32 v144, a136
    v_accvgpr_read_b32 v145, a137
    v_accvgpr_read_b32 v146, a138
    v_accvgpr_read_b32 v147, a139
    v_pk_mul_f32 v[144:145], v[144:145], v[120:121] op_sel_hi:[1,0]
    v_pk_mul_f32 v[146:147], v[146:147], v[120:121] op_sel_hi:[1,0]
    v_cvt_pk_bf16_f32 v144, v144, v145
    v_cvt_pk_bf16_f32 v145, v146, v147
    v_accvgpr_read_b32 v148, a140
    v_accvgpr_read_b32 v149, a141
    v_accvgpr_read_b32 v150, a142
    v_accvgpr_read_b32 v151, a143
    v_pk_mul_f32 v[148:149], v[148:149], v[120:121] op_sel_hi:[1,0]
    v_pk_mul_f32 v[150:151], v[150:151], v[120:121] op_sel_hi:[1,0]
    v_cvt_pk_bf16_f32 v148, v148, v149
    v_cvt_pk_bf16_f32 v149, v150, v151
    v_mfma_f32_32x32x16_bf16 a[128:143], v[132:135], v[132:135], 0
    ds_write_b64 v122, v[136:137] offset:0
    ds_write_b64 v123, v[140:141] offset:0
    ds_write_b64 v124, v[144:145] offset:0
    ds_write_b64 v125, v[148:149] offset:0
    v_accvgpr_read_b32 v136, a144
    v_accvgpr_read_b32 v137, a145
    v_accvgpr_read_b32 v138, a146
    v_accvgpr_read_b32 v139, a147
    v_pk_mul_f32 v[136:137], v[136:137], v[120:121] op_sel_hi:[1,0]
    v_pk_mul_f32 v[138:139], v[138:139], v[120:121] op_sel_hi:[1,0]
    v_cvt_pk_bf16_f32 v136, v136, v137
    v_cvt_pk_bf16_f32 v137, v138, v139
    v_accvgpr_read_b32 v140, a148
    v_accvgpr_read_b32 v141, a149
    v_accvgpr_read_b32 v142, a150
    v_accvgpr_read_b32 v143, a151
    v_pk_mul_f32 v[140:141], v[140:141], v[120:121] op_sel_hi:[1,0]
    v_pk_mul_f32 v[142:143], v[142:143], v[120:121] op_sel_hi:[1,0]
    v_cvt_pk_bf16_f32 v140, v140, v141
    v_cvt_pk_bf16_f32 v141, v142, v143
    v_accvgpr_read_b32 v144, a152
    v_accvgpr_read_b32 v145, a153
    v_accvgpr_read_b32 v146, a154
    v_accvgpr_read_b32 v147, a155
    v_pk_mul_f32 v[144:145], v[144:145], v[120:121] op_sel_hi:[1,0]
    v_pk_mul_f32 v[146:147], v[146:147], v[120:121] op_sel_hi:[1,0]
    v_cvt_pk_bf16_f32 v144, v144, v145
    v_cvt_pk_bf16_f32 v145, v146, v147
    v_accvgpr_read_b32 v148, a156
    v_accvgpr_read_b32 v149, a157
    v_accvgpr_read_b32 v150, a158
    v_accvgpr_read_b32 v151, a159
    v_pk_mul_f32 v[148:149], v[148:149], v[120:121] op_sel_hi:[1,0]
    v_pk_mul_f32 v[150:151], v[150:151], v[120:121] op_sel_hi:[1,0]
    v_cvt_pk_bf16_f32 v148, v148, v149
    v_cvt_pk_bf16_f32 v149, v150, v151
    v_mfma_f32_32x32x16_bf16 a[144:159], v[132:135], v[132:135], 0
    ds_write_b64 v122, v[136:137] offset:128
    ds_write_b64 v123, v[140:141] offset:128
    ds_write_b64 v124, v[144:145] offset:128
    ds_write_b64 v125, v[148:149] offset:128
    ds_read_b128 a[240:243], v126 offset:0
    ds_read_b128 a[244:247], v127 offset:1024
    ds_read_b128 a[248:251], v126 offset:2048
    ds_read_b128 a[252:255], v127 offset:3072
L_m03:
    v_accvgpr_read_b32 v136, a0
    v_accvgpr_read_b32 v137, a1
    v_accvgpr_read_b32 v138, a2
    v_accvgpr_read_b32 v139, a3
    v_pk_mul_f32 v[136:137], v[136:137], v[112:113] op_sel_hi:[1,0]
    v_pk_mul_f32 v[138:139], v[138:139], v[112:113] op_sel_hi:[1,0]
    v_cvt_pk_bf16_f32 v136, v136, v137
    v_cvt_pk_bf16_f32 v137, v138, v139
    v_accvgpr_read_b32 v140, a4
    v_accvgpr_read_b32 v141, a5
    v_accvgpr_read_b32 v142, a6
    v_accvgpr_read_b32 v143, a7
    v_pk_mul_f32 v[140:141], v[140:141], v[112:113] op_sel_hi:[1,0]
    v_pk_mul_f32 v[142:143], v[142:143], v[112:113] op_sel_hi:[1,0]
    v_cvt_pk_bf16_f32 v140, v140, v141
    v_cvt_pk_bf16_f32 v141, v142, v143
    v_accvgpr_read_b32 v144, a8
    v_accvgpr_read_b32 v145, a9
    v_accvgpr_read_b32 v146, a10
    v_accvgpr_read_b32 v147, a11
    v_pk_mul_f32 v[144:145], v[144:145], v[112:113] op_sel_hi:[1,0]
    v_pk_mul_f32 v[146:147], v[146:147], v[112:113] op_sel_hi:[1,0]
    v_cvt_pk_bf16_f32 v144, v144, v145
    v_cvt_pk_bf16_f32 v145, v146, v147
    v_accvgpr_read_b32 v148, a12
    v_accvgpr_read_b32 v149, a13
    v_accvgpr_read_b32 v150, a14
    v_accvgpr_read_b32 v151, a15
    v_pk_mul_f32 v[148:149], v[148:149], v[112:113] op_sel_hi:[1,0]
    v_pk_mul_f32 v[150:151], v[150:151], v[112:113] op_sel_hi:[1,0]
    v_cvt_pk_bf16_f32 v148, v148, v149
    v_cvt_pk_bf16_f32 v149, v150, v151
    v_mfma_f32_32x32x16_bf16 a[0:15], v[132:135], v[132:135], 0
    ds_write_b64 v122, v[136:137] offset:0
    ds_write_b64 v123, v[140:141] offset:0
    ds_write_b64 v124, v[144:145] offset:0
    ds_write_b64 v125, v[148:149] offset:0
    v_accvgpr_read_b32 v136, a16
    v_accvgpr_read_b32 v137, a17
    v_accvgpr_read_b32 v138, a18
    v_accvgpr_read_b32 v139, a19
    v_pk_mul_f32 v[136:137], v[136:137], v[112:113] op_sel_hi:[1,0]
    v_pk_mul_f32 v[138:139], v[138:139], v[112:113] op_sel_hi:[1,0]
    v_cvt_pk_bf16_f32 v136, v136, v137
    v_cvt_pk_bf16_f32 v137, v138, v139
    v_accvgpr_read_b32 v140, a20
    v_accvgpr_read_b32 v141, a21
    v_accvgpr_read_b32 v142, a22
    v_accvgpr_read_b32 v143, a23
    v_pk_mul_f32 v[140:141], v[140:141], v[112:113] op_sel_hi:[1,0]
    v_pk_mul_f32 v[142:143], v[142:143], v[112:113] op_sel_hi:[1,0]
    v_cvt_pk_bf16_f32 v140, v140, v141
    v_cvt_pk_bf16_f32 v141, v142, v143
    v_accvgpr_read_b32 v144, a24
    v_accvgpr_read_b32 v145, a25
    v_accvgpr_read_b32 v146, a26
    v_accvgpr_read_b32 v147, a27
    v_pk_mul_f32 v[144:145], v[144:145], v[112:113] op_sel_hi:[1,0]
    v_pk_mul_f32 v[146:147], v[146:147], v[112:113] op_sel_hi:[1,0]
    v_cvt_pk_bf16_f32 v144, v144, v145
    v_cvt_pk_bf16_f32 v145, v146, v147
    v_accvgpr_read_b32 v148, a28
    v_accvgpr_read_b32 v149, a29
    v_accvgpr_read_b32 v150, a30
    v_accvgpr_read_b32 v151, a31
    v_pk_mul_f32 v[148:149], v[148:149], v[112:113] op_sel_hi:[1,0]
    v_pk_mul_f32 v[150:151], v[150:151], v[112:113] op_sel_hi:[1,0]
    v_cvt_pk_bf16_f32 v148, v148, v149
    v_cvt_pk_bf16_f32 v149, v150, v151
    v_mfma_f32_32x32x16_bf16 a[16:31], v[132:135], v[132:135], 0
    ds_write_b64 v122, v[136:137] offset:128
    ds_write_b64 v123, v[140:141] offset:128
    ds_write_b64 v124, v[144:145] offset:128
    ds_write_b64 v125, v[148:149] offset:128
    v_accvgpr_read_b32 v136, a32
    v_accvgpr_read_b32 v137, a33
    v_accvgpr_read_b32 v138, a34
    v_accvgpr_read_b32 v139, a35
    v_pk_mul_f32 v[136:137], v[136:137], v[114:115] op_sel_hi:[1,0]
    v_pk_mul_f32 v[138:139], v[138:139], v[114:115] op_sel_hi:[1,0]
    v_cvt_pk_bf16_f32 v136, v136, v137
    v_cvt_pk_bf16_f32 v137, v138, v139
    v_accvgpr_read_b32 v140, a36
    v_accvgpr_read_b32 v141, a37
    v_accvgpr_read_b32 v142, a38
    v_accvgpr_read_b32 v143, a39
    v_pk_mul_f32 v[140:141], v[140:141], v[114:115] op_sel_hi:[1,0]
    v_pk_mul_f32 v[142:143], v[142:143], v[114:115] op_sel_hi:[1,0]
    v_cvt_pk_bf16_f32 v140, v140, v141
    v_cvt_pk_bf16_f32 v141, v142, v143
    v_accvgpr_read_b32 v144, a40
    v_accvgpr_read_b32 v145, a41
    v_accvgpr_read_b32 v146, a42
    v_accvgpr_read_b32 v147, a43
    v_pk_mul_f32 v[144:145], v[144:145], v[114:115] op_sel_hi:[1,0]
    v_pk_mul_f32 v[146:147], v[146:147], v[114:115] op_sel_hi:[1,0]
    v_cvt_pk_bf16_f32 v144, v144, v145
    v_cvt_pk_bf16_f32 v145, v146, v147
    v_accvgpr_read_b32 v148, a44
    v_accvgpr_read_b32 v149, a45
    v_accvgpr_read_b32 v150, a46
    v_accvgpr_read_b32 v151, a47
    v_pk_mul_f32 v[148:149], v[148:149], v[114:115] op_sel_hi:[1,0]
    v_pk_mul_f32 v[150:151], v[150:151], v[114:115] op_sel_hi:[1,0]
    v_cvt_pk_bf16_f32 v148, v148, v149
    v_cvt_pk_bf16_f32 v149, v150, v151
    v_mfma_f32_32x32x16_bf16 a[32:47], v[132:135], v[132:135], 0
    ds_write_b64 v122, v[136:137] offset:4096
    ds_write_b64 v123, v[140:141] offset:4096
    ds_write_b64 v124, v[144:145] offset:4096
    ds_write_b64 v125, v[148:149] offset:4096
    v_accvgpr_read_b32 v136, a48
    v_accvgpr_read_b32 v137, a49
    v_accvgpr_read_b32 v138, a50
    v_accvgpr_read_b32 v139, a51
    v_pk_mul_f32 v[136:137], v[136:137], v[114:115] op_sel_hi:[1,0]
    v_pk_mul_f32 v[138:139], v[138:139], v[114:115] op_sel_hi:[1,0]
    v_cvt_pk_bf16_f32 v136, v136, v137
    v_cvt_pk_bf16_f32 v137, v138, v139
    v_accvgpr_read_b32 v140, a52
    v_accvgpr_read_b32 v141, a53
    v_accvgpr_read_b32 v142, a54
    v_accvgpr_read_b32 v143, a55
    v_pk_mul_f32 v[140:141], v[140:141], v[114:115] op_sel_hi:[1,0]
    v_pk_mul_f32 v[142:143], v[142:143], v[114:115] op_sel_hi:[1,0]
    v_cvt_pk_bf16_f32 v140, v140, v141
    v_cvt_pk_bf16_f32 v141, v142, v143
    v_accvgpr_read_b32 v144, a56
    v_accvgpr_read_b32 v145, a57
    v_accvgpr_read_b32 v146, a58
    v_accvgpr_read_b32 v147, a59
    v_pk_mul_f32 v[144:145], v[144:145], v[114:115] op_sel_hi:[1,0]
    v_pk_mul_f32 v[146:147], v[146:147], v[114:115] op_sel_hi:[1,0]
    v_cvt_pk_bf16_f32 v144, v144, v145
    v_cvt_pk_bf16_f32 v145, v146, v147
    v_accvgpr_read_b32 v148, a60
    v_accvgpr_read_b32 v149, a61
    v_accvgpr_read_b32 v150, a62
    v_accvgpr_read_b32 v151, a63
    v_pk_mul_f32 v[148:149], v[148:149], v[114:115] op_sel_hi:[1,0]
    v_pk_mul_f32 v[150:151], v[150:151], v[114:115] op_sel_hi:[1,0]
    v_cvt_pk_bf16_f32 v148, v148, v149
    v_cvt_pk_bf16_f32 v149, v150, v151
    v_mfma_f32_32x32x16_bf16 a[48:63], v[132:135], v[132:135], 0
    ds_write_b64 v122, v[136:137] offset:4224
    ds_write_b64 v123, v[140:141] offset:4224
    ds_write_b64 v124, v[144:145] offset:4224
    ds_write_b64 v125, v[148:149] offset:4224
    v_accvgpr_read_b32 v136, a64
    v_accvgpr_read_b32 v137, a65
    v_accvgpr_read_b32 v138, a66
    v_accvgpr_read_b32 v139, a67
    v_pk_mul_f32 v[136:137], v[136:137], v[116:117] op_sel_hi:[1,0]
    v_pk_mul_f32 v[138:139], v[138:139], v[116:117] op_sel_hi:[1,0]
    v_cvt_pk_bf16_f32 v136, v136, v137
    v_cvt_pk_bf16_f32 v137, v138, v139
    v_accvgpr_read_b32 v140, a68
    v_accvgpr_read_b32 v141, a69
    v_accvgpr_read_b32 v142, a70
    v_accvgpr_read_b32 v143, a71
    v_pk_mul_f32 v[140:141], v[140:141], v[116:117] op_sel_hi:[1,0]
    v_pk_mul_f32 v[142:143], v[142:143], v[116:117] op_sel_hi:[1,0]
    v_cvt_pk_bf16_f32 v140, v140, v141
    v_cvt_pk_bf16_f32 v141, v142, v143
    v_accvgpr_read_b32 v144, a72
    v_accvgpr_read_b32 v145, a73
    v_accvgpr_read_b32 v146, a74
    v_accvgpr_read_b32 v147, a75
    v_pk_mul_f32 v[144:145], v[144:145], v[116:117] op_sel_hi:[1,0]
    v_pk_mul_f32 v[146:147], v[146:147], v[116:117] op_sel_hi:[1,0]
    v_cvt_pk_bf16_f32 v144, v144, v145
    v_cvt_pk_bf16_f32 v145, v146, v147
    v_accvgpr_read_b32 v148, a76
    v_accvgpr_read_b32 v149, a77
    v_accvgpr_read_b32 v150, a78
    v_accvgpr_read_b32 v151, a79
    v_pk_mul_f32 v[148:149], v[148:149], v[116:117] op_sel_hi:[1,0]
    v_pk_mul_f32 v[150:151], v[150:151], v[116:117] op_sel_hi:[1,0]
    v_cvt_pk_bf16_f32 v148, v148, v149
    v_cvt_pk_bf16_f32 v149, v150, v151
    v_mfma_f32_32x32x16_bf16 a[64:79], v[132:135], v[132:135], 0
    ds_write_b64 v122, v[136:137] offset:8192
    ds_write_b64 v123, v[140:141] offset:8192
    ds_write_b64 v124, v[144:145] offset:8192
    ds_write_b64 v125, v[148:149] offset:8192
    v_accvgpr_read_b32 v136, a80
    v_accvgpr_read_b32 v137, a81
    v_accvgpr_read_b32 v138, a82
    v_accvgpr_read_b32 v139, a83
    v_pk_mul_f32 v[136:137], v[136:137], v[116:117] op_sel_hi:[1,0]
    v_pk_mul_f32 v[138:139], v[138:139], v[116:117] op_sel_hi:[1,0]
    v_cvt_pk_bf16_f32 v136, v136, v137
    v_cvt_pk_bf16_f32 v137, v138, v139
    v_accvgpr_read_b32 v140, a84
    v_accvgpr_read_b32 v141, a85
    v_accvgpr_read_b32 v142, a86
    v_accvgpr_read_b32 v143, a87
    v_pk_mul_f32 v[140:141], v[140:141], v[116:117] op_sel_hi:[1,0]
    v_pk_mul_f32 v[142:143], v[142:143], v[116:117] op_sel_hi:[1,0]
    v_cvt_pk_bf16_f32 v140, v140, v141
    v_cvt_pk_bf16_f32 v141, v142, v143
    v_accvgpr_read_b32 v144, a88
    v_accvgpr_read_b32 v145, a89
    v_accvgpr_read_b32 v146, a90
    v_accvgpr_read_b32 v147, a91
    v_pk_mul_f32 v[144:145], v[144:145], v[116:117] op_sel_hi:[1,0]
    v_pk_mul_f32 v[146:147], v[146:147], v[116:117] op_sel_hi:[1,0]
    v_cvt_pk_bf16_f32 v144, v144, v145
    v_cvt_pk_bf16_f32 v145, v146, v147
    v_accvgpr_read_b32 v148, a92
    v_accvgpr_read_b32 v149, a93
    v_accvgpr_read_b32 v150, a94
    v_accvgpr_read_b32 v151, a95
    v_pk_mul_f32 v[148:149], v[148:149], v[116:117] op_sel_hi:[1,0]
    v_pk_mul_f32 v[150:151], v[150:151], v[116:117] op_sel_hi:[1,0]
    v_cvt_pk_bf16_f32 v148, v148, v149
    v_cvt_pk_bf16_f32 v149, v150, v151
    v_mfma_f32_32x32x16_bf16 a[80:95], v[132:135], v[132:135], 0
    ds_write_b64 v122, v[136:137] offset:8320
    ds_write_b64 v123, v[140:141] offset:8320
    ds_write_b64 v124, v[144:145] offset:8320
    ds_write_b64 v125, v[148:149] offset:8320
    v_accvgpr_read_b32 v136, a96
    v_accvgpr_read_b32 v137, a97
    v_accvgpr_read_b32 v138, a98
    v_accvgpr_read_b32 v139, a99
    v_pk_mul_f32 v[136:137], v[136:137], v[118:119] op_sel_hi:[1,0]
    v_pk_mul_f32 v[138:139], v[138:139], v[118:119] op_sel_hi:[1,0]
    v_cvt_pk_bf16_f32 v136, v136, v137
    v_cvt_pk_bf16_f32 v137, v138, v139
    v_accvgpr_read_b32 v140, a100
    v_accvgpr_read_b32 v141, a101
    v_accvgpr_read_b32 v142, a102
    v_accvgpr_read_b32 v143, a103
    v_pk_mul_f32 v[140:141], v[140:141], v[118:119] op_sel_hi:[1,0]
    v_pk_mul_f32 v[142:143], v[142:143], v[118:119] op_sel_hi:[1,0]
    v_cvt_pk_bf16_f32 v140, v140, v141
    v_cvt_pk_bf16_f32 v141, v142, v143
    v_accvgpr_read_b32 v144, a104
    v_accvgpr_read_b32 v145, a105
    v_accvgpr_read_b32 v146, a106
    v_accvgpr_read_b32 v147, a107
    v_pk_mul_f32 v[144:145], v[144:145], v[118:119] op_sel_hi:[1,0]
    v_pk_mul_f32 v[146:147], v[146:147], v[118:119] op_sel_hi:[1,0]
    v_cvt_pk_bf16_f32 v144, v144, v145
    v_cvt_pk_bf16_f32 v145, v146, v147
    v_accvgpr_read_b32 v148, a108
    v_accvgpr_read_b32 v149, a109
    v_accvgpr_read_b32 v150, a110
    v_accvgpr_read_b32 v151, a111
    v_pk_mul_f32 v[148:149], v[148:149], v[118:119] op_sel_hi:[1,0]
    v_pk_mul_f32 v[150:151], v[150:151], v[118:119] op_sel_hi:[1,0]
    v_cvt_pk_bf16_f32 v148, v148, v149
    v_cvt_pk_bf16_f32 v149, v150, v151
    v_mfma_f32_32x32x16_bf16 a[96:111], v[132:135], v[132:135], 0
    ds_write_b64 v122, v[136:137] offset:12288
    ds_write_b64 v123, v[140:141] offset:12288
    ds_write_b64 v124, v[144:145] offset:12288
    ds_write_b64 v125, v[148:149] offset:12288
    v_accvgpr_read_b32 v136, a112
    v_accvgpr_read_b32 v137, a113
    v_accvgpr_read_b32 v138, a114
    v_accvgpr_read_b32 v139, a115
    v_pk_mul_f32 v[136:137], v[136:137], v[118:119] op_sel_hi:[1,0]
    v_pk_mul_f32 v[138:139], v[138:139], v[118:119] op_sel_hi:[1,0]
    v_cvt_pk_bf16_f32 v136, v136, v137
    v_cvt_pk_bf16_f32 v137, v138, v139
    v_accvgpr_read_b32 v140, a116
    v_accvgpr_read_b32 v141, a117
    v_accvgpr_read_b32 v142, a118
    v_accvgpr_read_b32 v143, a119
    v_pk_mul_f32 v[140:141], v[140:141], v[118:119] op_sel_hi:[1,0]
    v_pk_mul_f32 v[142:143], v[142:143], v[118:119] op_sel_hi:[1,0]
    v_cvt_pk_bf16_f32 v140, v140, v141
    v_cvt_pk_bf16_f32 v141, v142, v143
    v_accvgpr_read_b32 v144, a120
    v_accvgpr_read_b32 v145, a121
    v_accvgpr_read_b32 v146, a122
    v_accvgpr_read_b32 v147, a123
    v_pk_mul_f32 v[144:145], v[144:145], v[118:119] op_sel_hi:[1,0]
    v_pk_mul_f32 v[146:147], v[146:147], v[118:119] op_sel_hi:[1,0]
    v_cvt_pk_bf16_f32 v144, v144, v145
    v_cvt_pk_bf16_f32 v145, v146, v147
    v_accvgpr_read_b32 v148, a124
    v_accvgpr_read_b32 v149, a125
    v_accvgpr_read_b32 v150, a126
    v_accvgpr_read_b32 v151, a127
    v_pk_mul_f32 v[148:149], v[148:149], v[118:119] op_sel_hi:[1,0]
    v_pk_mul_f32 v[150:151], v[150:151], v[118:119] op_sel_hi:[1,0]
    v_cvt_pk_bf16_f32 v148, v148, v149
    v_cvt_pk_bf16_f32 v149, v150, v151
    v_mfma_f32_32x32x16_bf16 a[112:127], v[132:135], v[132:135], 0
    ds_write_b64 v122, v[136:137] offset:12416
    ds_write_b64 v123, v[140:141] offset:12416
    ds_write_b64 v124, v[144:145] offset:12416
    ds_write_b64 v125, v[148:149] offset:12416
L_pro:
    s_cmp_eq_u32 s49, 0
    s_cselect_b32 s64, s63, 1
    s_or_b32 s54, s64, s46
    s_xor_b32 s48, s54, 1
    s_mul_i32 s32, s48, 4
    s_mul_i32 s31, s48, 3
    s_add_u32 s31, s31, 13
    s_mov_b32 s37, 0
    s_cmp_eq_u32 s49, 0
    s_cselect_b32 s44, 0, 0
    s_bitcmp1_b32 s60, 0
    s_cselect_b32 s44, 64, s44
    s_mov_b32 s58, 0
    s_waitcnt lgkmcnt(0)
    s_cmp_eq_u32 s49, 0
    s_cbranch_scc1 L_fs0
L_f0:
    v_lshlrev_b32 v136, 16, v32
    v_and_b32 v137, s39, v32
    v_lshlrev_b32 v138, 16, v33
    v_and_b32 v139, s39, v33
    v_pk_mul_f32 v[136:137], v[136:137], s[50:51]
    v_pk_mul_f32 v[138:139], v[138:139], s[50:51]
    v_mfma_f32_16x16x32_bf16 v[20:23], v[132:135], v[132:135], 0
    v_cvt_pk_bf16_f32 v32, v136, v137
    v_cvt_pk_bf16_f32 v33, v138, v139
    v_lshlrev_b32 v140, 16, v34
    v_and_b32 v141, s39, v34
    v_lshlrev_b32 v142, 16, v35
    v_and_b32 v143, s39, v35
    v_pk_mul_f32 v[140:141], v[140:141], s[50:51]
    v_pk_mul_f32 v[142:143], v[142:143], s[50:51]
    v_mfma_f32_16x16x32_bf16 v[24:27], v[132:135], v[132:135], 0
    v_cvt_pk_bf16_f32 v34, v140, v141
    v_cvt_pk_bf16_f32 v35, v142, v143
    v_lshlrev_b32 v144, 16, v36
    v_and_b32 v145, s39, v36
    v_lshlrev_b32 v146, 16, v37
    v_and_b32 v147, s39, v37
    v_pk_mul_f32 v[144:145], v[144:145], s[50:51]
    v_pk_mul_f32 v[146:147], v[146:147], s[50:51]
    v_mfma_f32_16x16x32_bf16 v[28:31], v[132:135], v[132:135], 0
    v_cvt_pk_bf16_f32 v36, v144, v145
    v_cvt_pk_bf16_f32 v37, v146, v147
    v_lshlrev_b32 v148, 16, v38
    v_and_b32 v149, s39, v38
    v_lshlrev_b32 v150, 16, v39
    v_and_b32 v151, s39, v39
    v_pk_mul_f32 v[148:149], v[148:149], s[50:51]
    v_pk_mul_f32 v[150:151], v[150:151], s[50:51]
    v_mfma_f32_16x16x32_bf16 v[248:251], v[132:135], v[132:135], 0
    v_cvt_pk_bf16_f32 v38, v148, v149
    v_cvt_pk_bf16_f32 v39, v150, v151
    v_lshlrev_b32 v136, 16, v40
    v_and_b32 v137, s39, v40
    v_lshlrev_b32 v138, 16, v41
    v_and_b32 v139, s39, v41
    v_pk_mul_f32 v[136:137], v[136:137], s[50:51]
    v_pk_mul_f32 v[138:139], v[138:139], s[50:51]
    v_mfma_f32_16x16x32_bf16 v[252:255], v[132:135], v[132:135], 0
    v_cvt_pk_bf16_f32 v40, v136, v137
    v_cvt_pk_bf16_f32 v41, v138, v139
    v_lshlrev_b32 v140, 16, v42
    v_and_b32 v141, s39, v42
    v_lshlrev_b32 v142, 16, v43
    v_and_b32 v143, s39, v43
    v_pk_mul_f32 v[140:141], v[140:141], s[50:51]
    v_pk_mul_f32 v[142:143], v[142:143], s[50:51]
    v_cvt_pk_bf16_f32 v42, v140, v141
    v_cvt_pk_bf16_f32 v43, v142, v143
    v_lshlrev_b32 v144, 16, v44
    v_and_b32 v145, s39, v44
    v_lshlrev_b32 v146, 16, v45
    v_and_b32 v147, s39, v45
    v_pk_mul_f32 v[144:145], v[144:145], s[50:51]
    v_pk_mul_f32 v[146:147], v[146:147], s[50:51]
    v_cvt_pk_bf16_f32 v44, v144, v145
    v_cvt_pk_bf16_f32 v45, v146, v147
    v_lshlrev_b32 v148, 16, v46
    v_and_b32 v149, s39, v46
    v_lshlrev_b32 v150, 16, v47
    v_and_b32 v151, s39, v47
    v_pk_mul_f32 v[148:149], v[148:149], s[50:51]
    v_pk_mul_f32 v[150:151], v[150:151], s[50:51]
    v_cvt_pk_bf16_f32 v46, v148, v149
    v_cvt_pk_bf16_f32 v47, v150, v151
    s_cmp_eq_u32 s49, 0
    s_cbranch_scc1 L_fs1
L_f1:
    v_lshlrev_b32 v136, 16, v48
    v_and_b32 v137, s39, v48
    v_lshlrev_b32 v138, 16, v49
    v_and_b32 v139, s39, v49
    v_pk_mul_f32 v[136:137], v[136:137], s[50:51]
    v_pk_mul_f32 v[138:139], v[138:139], s[50:51]
    v_mfma_f32_16x16x32_bf16 v[152:155], v[184:187], v[32:35], 0
    v_cvt_pk_bf16_f32 v48, v136, v137
    v_cvt_pk_bf16_f32 v49, v138, v139
    v_lshlrev_b32 v140, 16, v50
    v_and_b32 v141, s39, v50
    v_lshlrev_b32 v142, 16, v51
    v_and_b32 v143, s39, v51
    v_pk_mul_f32 v[140:141], v[140:141], s[50:51]
    v_pk_mul_f32 v[142:143], v[142:143], s[50:51]
    v_mfma_f32_16x16x32_bf16 v[152:155], v[188:191], v[36:39], v[152:155]
    v_cvt_pk_bf16_f32 v50, v140, v141
    v_cvt_pk_bf16_f32 v51, v142, v143
    v_lshlrev_b32 v144, 16, v52
    v_and_b32 v145, s39, v52
    v_lshlrev_b32 v146, 16, v53
    v_and_b32 v147, s39, v53
    v_pk_mul_f32 v[144:145], v[144:145], s[50:51]
    v_pk_mul_f32 v[146:147], v[146:147], s[50:51]
    v_mfma_f32_16x16x32_bf16 v[152:155], v[192:195], v[40:43], v[152:155]
    v_cvt_pk_bf16_f32 v52, v144, v145
    v_cvt_pk_bf16_f32 v53, v146, v147
    v_lshlrev_b32 v148, 16, v54
    v_and_b32 v149, s39, v54
    v_lshlrev_b32 v150, 16, v55
    v_and_b32 v151, s39, v55
    v_pk_mul_f32 v[148:149], v[148:149], s[50:51]
    v_pk_mul_f32 v[150:151], v[150:151], s[50:51]
    v_mfma_f32_16x16x32_bf16 v[152:155], v[196:199], v[44:47], v[152:155]
    v_cvt_pk_bf16_f32 v54, v148, v149
    v_cvt_pk_bf16_f32 v55, v150, v151
    v_lshlrev_b32 v136, 16, v56
    v_and_b32 v137, s39, v56
    v_lshlrev_b32 v138, 16, v57
    v_and_b32 v139, s39, v57
    v_pk_mul_f32 v[136:137], v[136:137], s[50:51]
    v_pk_mul_f32 v[138:139], v[138:139], s[50:51]
    v_cvt_pk_bf16_f32 v56, v136, v137
    v_cvt_pk_bf16_f32 v57, v138, v139
    v_lshlrev_b32 v140, 16, v58
    v_and_b32 v141, s39, v58
    v_lshlrev_b32 v142, 16, v59
    v_and_b32 v143, s39, v59
    v_pk_mul_f32 v[140:141], v[140:141], s[50:51]
    v_pk_mul_f32 v[142:143], v[142:143], s[50:51]
    v_cvt_pk_bf16_f32 v58, v140, v141
    v_cvt_pk_bf16_f32 v59, v142, v143
    v_lshlrev_b32 v144, 16, v60
    v_and_b32 v145, s39, v60
    v_lshlrev_b32 v146, 16, v61
    v_and_b32 v147, s39, v61
    v_pk_mul_f32 v[144:145], v[144:145], s[50:51]
    v_pk_mul_f32 v[146:147], v[146:147], s[50:51]
    v_cvt_pk_bf16_f32 v60, v144, v145
    v_cvt_pk_bf16_f32 v61, v146, v147
    v_lshlrev_b32 v148, 16, v62
    v_and_b32 v149, s39, v62
    v_lshlrev_b32 v150, 16, v63
    v_and_b32 v151, s39, v63
    v_pk_mul_f32 v[148:149], v[148:149], s[50:51]
    v_pk_mul_f32 v[150:151], v[150:151], s[50:51]
    v_cvt_pk_bf16_f32 v62, v148, v149
    v_cvt_pk_bf16_f32 v63, v150, v151
    v_max3_f32 v176, v152, v153, v154
    v_max_f32 v176, v176, v155
    s_cmp_eq_u32 s49, 0
    s_cbranch_scc1 L_fs2
L_f2:
    v_lshlrev_b32 v136, 16, v64
    v_and_b32 v137, s39, v64
    v_lshlrev_b32 v138, 16, v65
    v_and_b32 v139, s39, v65
    v_pk_mul_f32 v[136:137], v[136:137], s[50:51]
    v_pk_mul_f32 v[138:139], v[138:139], s[50:51]
    v_mfma_f32_16x16x32_bf16 v[156:159], v[184:187], v[48:51], 0
    v_cvt_pk_bf16_f32 v64, v136, v137
    v_cvt_pk_bf16_f32 v65, v138, v139
    v_lshlrev_b32 v140, 16, v66
    v_and_b32 v141, s39, v66
    v_lshlrev_b32 v142, 16, v67
    v_and_b32 v143, s39, v67
    v_pk_mul_f32 v[140:141], v[140:141], s[50:51]
    v_pk_mul_f32 v[142:143], v[142:143], s[50:51]
    v_mfma_f32_16x16x32_bf16 v[156:159], v[188:191], v[52:55], v[156:159]
    v_cvt_pk_bf16_f32 v66, v140, v141
    v_cvt_pk_bf16_f32 v67, v142, v143
    v_lshlrev_b32 v144, 16, v68
    v_and_b32 v145, s39, v68
    v_lshlrev_b32 v146, 16, v69
    v_and_b32 v147, s39, v69
    v_pk_mul_f32 v[144:145], v[144:145], s[50:51]
    v_pk_mul_f32 v[146:147], v[146:147], s[50:51]
    v_mfma_f32_16x16x32_bf16 v[156:159], v[192:195], v[56:59], v[156:159]
    v_cvt_pk_bf16_f32 v68, v144, v145
    v_cvt_pk_bf16_f32 v69, v146, v147
    v_lshlrev_b32 v148, 16, v70
    v_and_b32 v149, s39, v70
    v_lshlrev_b32 v150, 16, v71
    v_and_b32 v151, s39, v71
    v_pk_mul_f32 v[148:149], v[148:149], s[50:51]
    v_pk_mul_f32 v[150:151], v[150:151], s[50:51]
    v_mfma_f32_16x16x32_bf16 v[156:159], v[196:199], v[60:63], v[156:159]
    v_cvt_pk_bf16_f32 v70, v148, v149
    v_cvt_pk_bf16_f32 v71, v150, v151
    v_lshlrev_b32 v136, 16, v72
    v_and_b32 v137, s39, v72
    v_lshlrev_b32 v138, 16, v73
    v_and_b32 v139, s39, v73
    v_pk_mul_f32 v[136:137], v[136:137], s[50:51]
    v_pk_mul_f32 v[138:139], v[138:139], s[50:51]
    v_cvt_pk_bf16_f32 v72, v136, v137
    v_cvt_pk_bf16_f32 v73, v138, v139
    v_lshlrev_b32 v140, 16, v74
    v_and_b32 v141, s39, v74
    v_lshlrev_b32 v142, 16, v75
    v_and_b32 v143, s39, v75
    v_pk_mul_f32 v[140:141], v[140:141], s[50:51]
    v_pk_mul_f32 v[142:143], v[142:143], s[50:51]
    v_cvt_pk_bf16_f32 v74, v140, v141
    v_cvt_pk_bf16_f32 v75, v142, v143
    v_lshlrev_b32 v144, 16, v76
    v_and_b32 v145, s39, v76
    v_lshlrev_b32 v146, 16, v77
    v_and_b32 v147, s39, v77
    v_pk_mul_f32 v[144:145], v[144:145], s[50:51]
    v_pk_mul_f32 v[146:147], v[146:147], s[50:51]
    v_cvt_pk_bf16_f32 v76, v144, v145
    v_cvt_pk_bf16_f32 v77, v146, v147
    v_lshlrev_b32 v148, 16, v78
    v_and_b32 v149, s39, v78
    v_lshlrev_b32 v150, 16, v79
    v_and_b32 v151, s39, v79
    v_pk_mul_f32 v[148:149], v[148:149], s[50:51]
    v_pk_mul_f32 v[150:151], v[150:151], s[50:51]
    v_cvt_pk_bf16_f32 v78, v148, v149
    v_cvt_pk_bf16_f32 v79, v150, v151
    v_max3_f32 v177, v156, v157, v158
    v_max_f32 v177, v177, v159
    s_cmp_eq_u32 s49, 0
    s_cbranch_scc1 L_fs3
L_f3:
    v_lshlrev_b32 v136, 16, v80
    v_and_b32 v137, s39, v80
    v_lshlrev_b32 v138, 16, v81
    v_and_b32 v139, s39, v81
    v_pk_mul_f32 v[136:137], v[136:137], s[50:51]
    v_pk_mul_f32 v[138:139], v[138:139], s[50:51]
    v_mfma_f32_16x16x32_bf16 v[160:163], v[184:187], v[64:67], 0
    v_cvt_pk_bf16_f32 v80, v136, v137
    v_cvt_pk_bf16_f32 v81, v138, v139
    v_lshlrev_b32 v140, 16, v82
    v_and_b32 v141, s39, v82
    v_lshlrev_b32 v142, 16, v83
    v_and_b32 v143, s39, v83
    v_pk_mul_f32 v[140:141], v[140:141], s[50:51]
    v_pk_mul_f32 v[142:143], v[142:143], s[50:51]
    v_mfma_f32_16x16x32_bf16 v[160:163], v[188:191], v[68:71], v[160:163]
    v_cvt_pk_bf16_f32 v82, v140, v141
    v_cvt_pk_bf16_f32 v83, v142, v143
    v_lshlrev_b32 v144, 16, v84
    v_and_b32 v145, s39, v84
    v_lshlrev_b32 v146, 16, v85
    v_and_b32 v147, s39, v85
    v_pk_mul_f32 v[144:145], v[144:145], s[50:51]
    v_pk_mul_f32 v[146:147], v[146:147], s[50:51]
    v_mfma_f32_16x16x32_bf16 v[160:163], v[192:195], v[72:75], v[160:163]
    v_cvt_pk_bf16_f32 v84, v144, v145
    v_cvt_pk_bf16_f32 v85, v146, v147
    v_lshlrev_b32 v148, 16, v86
    v_and_b32 v149, s39, v86
    v_lshlrev_b32 v150, 16, v87
    v_and_b32 v151, s39, v87
    v_pk_mul_f32 v[148:149], v[148:149], s[50:51]
    v_pk_mul_f32 v[150:151], v[150:151], s[50:51]
    v_mfma_f32_16x16x32_bf16 v[160:163], v[196:199], v[76:79], v[160:163]
    v_cvt_pk_bf16_f32 v86, v148, v149
    v_cvt_pk_bf16_f32 v87, v150, v151
    v_lshlrev_b32 v136, 16, v88
    v_and_b32 v137, s39, v88
    v_lshlrev_b32 v138, 16, v89
    v_and_b32 v139, s39, v89
    v_pk_mul_f32 v[136:137], v[136:137], s[50:51]
    v_pk_mul_f32 v[138:139], v[138:139], s[50:51]
    v_cvt_pk_bf16_f32 v88, v136, v137
    v_cvt_pk_bf16_f32 v89, v138, v139
    v_lshlrev_b32 v140, 16, v90
    v_and_b32 v141, s39, v90
    v_lshlrev_b32 v142, 16, v91
    v_and_b32 v143, s39, v91
    v_pk_mul_f32 v[140:141], v[140:141], s[50:51]
    v_pk_mul_f32 v[142:143], v[142:143], s[50:51]
    v_cvt_pk_bf16_f32 v90, v140, v141
    v_cvt_pk_bf16_f32 v91, v142, v143
    v_lshlrev_b32 v144, 16, v92
    v_and_b32 v145, s39, v92
    v_lshlrev_b32 v146, 16, v93
    v_and_b32 v147, s39, v93
    v_pk_mul_f32 v[144:145], v[144:145], s[50:51]
    v_pk_mul_f32 v[146:147], v[146:147], s[50:51]
    v_cvt_pk_bf16_f32 v92, v144, v145
    v_cvt_pk_bf16_f32 v93, v146, v147
    v_lshlrev_b32 v148, 16, v94
    v_and_b32 v149, s39, v94
    v_lshlrev_b32 v150, 16, v95
    v_and_b32 v151, s39, v95
    v_pk_mul_f32 v[148:149], v[148:149], s[50:51]
    v_pk_mul_f32 v[150:151], v[150:151], s[50:51]
    v_cvt_pk_bf16_f32 v94, v148, v149
    v_cvt_pk_bf16_f32 v95, v150, v151
    v_max3_f32 v178, v160, v161, v162
    v_max_f32 v178, v178, v163
    s_cmp_eq_u32 s47, 3
    s_cbranch_scc1 L_noq4
    s_waitcnt vmcnt(4)
    v_accvgpr_read_b32 v96, a224
    v_accvgpr_read_b32 v97, a225
    v_accvgpr_read_b32 v98, a226
    v_accvgpr_read_b32 v99, a227
    v_accvgpr_read_b32 v100, a228
    v_accvgpr_read_b32 v101, a229
    v_accvgpr_read_b32 v102, a230
    v_accvgpr_read_b32 v103, a231
    v_accvgpr_read_b32 v104, a232
    v_accvgpr_read_b32 v105, a233
    v_accvgpr_read_b32 v106, a234
    v_accvgpr_read_b32 v107, a235
    v_accvgpr_read_b32 v108, a236
    v_accvgpr_read_b32 v109, a237
    v_accvgpr_read_b32 v110, a238
    v_accvgpr_read_b32 v111, a239
    v_lshlrev_b32 v136, 16, v96
    v_and_b32 v137, s39, v96
    v_lshlrev_b32 v138, 16, v97
    v_and_b32 v139, s39, v97
    v_pk_mul_f32 v[136:137], v[136:137], s[50:51]
    v_pk_mul_f32 v[138:139], v[138:139], s[50:51]
    v_mfma_f32_16x16x32_bf16 v[164:167], v[184:187], v[80:83], 0
    v_cvt_pk_bf16_f32 v96, v136, v137
    v_cvt_pk_bf16_f32 v97, v138, v139
    v_lshlrev_b32 v140, 16, v98
    v_and_b32 v141, s39, v98
    v_lshlrev_b32 v142, 16, v99
    v_and_b32 v143, s39, v99
    v_pk_mul_f32 v[140:141], v[140:141], s[50:51]
    v_pk_mul_f32 v[142:143], v[142:143], s[50:51]
    v_mfma_f32_16x16x32_bf16 v[164:167], v[188:191], v[84:87], v[164:167]
    v_cvt_pk_bf16_f32 v98, v140, v141
    v_cvt_pk_bf16_f32 v99, v142, v143
    v_lshlrev_b32 v144, 16, v100
    v_and_b32 v145, s39, v100
    v_lshlrev_b32 v146, 16, v101
    v_and_b32 v147, s39, v101
    v_pk_mul_f32 v[144:145], v[144:145], s[50:51]
    v_pk_mul_f32 v[146:147], v[146:147], s[50:51]
    v_mfma_f32_16x16x32_bf16 v[164:167], v[192:195], v[88:91], v[164:167]
    v_cvt_pk_bf16_f32 v100, v144, v145
    v_cvt_pk_bf16_f32 v101, v146, v147
    v_lshlrev_b32 v148, 16, v102
    v_and_b32 v149, s39, v102
    v_lshlrev_b32 v150, 16, v103
    v_and_b32 v151, s39, v103
    v_pk_mul_f32 v[148:149], v[148:149], s[50:51]
    v_pk_mul_f32 v[150:151], v[150:151], s[50:51]
    v_mfma_f32_16x16x32_bf16 v[164:167], v[196:199], v[92:95], v[164:167]
    v_cvt_pk_bf16_f32 v102, v148, v149
    v_cvt_pk_bf16_f32 v103, v150, v151
    v_lshlrev_b32 v136, 16, v104
    v_and_b32 v137, s39, v104
    v_lshlrev_b32 v138, 16, v105
    v_and_b32 v139, s39, v105
    v_pk_mul_f32 v[136:137], v[136:137], s[50:51]
    v_pk_mul_f32 v[138:139], v[138:139], s[50:51]
    v_cvt_pk_bf16_f32 v104, v136, v137
    v_cvt_pk_bf16_f32 v105, v138, v139
    v_lshlrev_b32 v140, 16, v106
    v_and_b32 v141, s39, v106
    v_lshlrev_b32 v142, 16, v107
    v_and_b32 v143, s39, v107
    v_pk_mul_f32 v[140:141], v[140:141], s[50:51]
    v_pk_mul_f32 v[142:143], v[142:143], s[50:51]
    v_cvt_pk_bf16_f32 v106, v140, v141
    v_cvt_pk_bf16_f32 v107, v142, v143
    v_lshlrev_b32 v144, 16, v108
    v_and_b32 v145, s39, v108
    v_lshlrev_b32 v146, 16, v109
    v_and_b32 v147, s39, v109
    v_pk_mul_f32 v[144:145], v[144:145], s[50:51]
    v_pk_mul_f32 v[146:147], v[146:147], s[50:51]
    v_cvt_pk_bf16_f32 v108, v144, v145
    v_cvt_pk_bf16_f32 v109, v146, v147
    v_lshlrev_b32 v148, 16, v110
    v_and_b32 v149, s39, v110
    v_lshlrev_b32 v150, 16, v111
    v_and_b32 v151, s39, v111
    v_pk_mul_f32 v[148:149], v[148:149], s[50:51]
    v_pk_mul_f32 v[150:151], v[150:151], s[50:51]
    v_cvt_pk_bf16_f32 v110, v148, v149
    v_cvt_pk_bf16_f32 v111, v150, v151
    s_nop 1
    v_mfma_f32_16x16x32_bf16 v[168:171], v[184:187], v[96:99], 0
    v_mfma_f32_16x16x32_bf16 v[168:171], v[188:191], v[100:103], v[168:171]
    v_mfma_f32_16x16x32_bf16 v[168:171], v[192:195], v[104:107], v[168:171]
    v_mfma_f32_16x16x32_bf16 v[168:171], v[196:199], v[108:111], v[168:171]
L_q4done:
    s_add_u32 s24, s24, 77824
    s_addc_u32 s25, s25, 0
    v_mfma_f32_32x32x16_bf16 a[160:175], v[132:135], v[132:135], 0
    s_cmp_lg_u32 s46, 0
    s_nop 5
    v_max3_f32 v179, v164, v165, v166
    v_max_f32 v179, v179, v167
    v_max3_f32 v180, v168, v169, v170
    v_max_f32 v180, v180, v171
    s_cbranch_scc1 L_redomax
L_maxdone:
    v_mfma_f32_32x32x16_bf16 a[176:191], v[132:135], v[132:135], 0
    v_mov_b32 v136, v176
    v_mov_b32 v137, v177
    v_mov_b32 v138, v178
    v_mov_b32 v139, v179
    v_mov_b32 v140, v180
    v_permlane16_swap_b32 v176, v136
    v_permlane16_swap_b32 v177, v137
    v_permlane16_swap_b32 v178, v138
    v_mfma_f32_32x32x16_bf16 a[192:207], v[132:135], v[132:135], 0
    v_permlane16_swap_b32 v179, v139
    v_permlane16_swap_b32 v180, v140
    v_max_f32 v176, v176, v136
    v_max_f32 v177, v177, v137
    v_max_f32 v178, v178, v138
    v_max_f32 v179, v179, v139
    v_max_f32 v180, v180, v140
    v_mov_b32 v136, v176
    v_mfma_f32_32x32x16_bf16 a[208:223], v[132:135], v[132:135], 0
    v_mov_b32 v137, v177
    v_mov_b32 v138, v178
    v_mov_b32 v139, v179
    v_mov_b32 v140, v180
    v_permlane32_swap_b32 v176, v136
    v_permlane32_swap_b32 v177, v137
    v_permlane32_swap_b32 v178, v138
    v_permlane32_swap_b32 v179, v139
    v_permlane32_swap_b32 v180, v140
    v_max_f32 v176, v176, v136
    v_max_f32 v177, v177, v137
    v_max_f32 v178, v178, v138
    v_max_f32 v179, v179, v139
    v_max_f32 v180, v180, v140
    v_sub_f32 v112, 0, v176
    v_sub_f32 v113, 0, v176
    v_sub_f32 v114, 0, v176
    v_sub_f32 v115, 0, v176
    v_and_b32 v181, 32, v18
    v_cmp_eq_u32 vcc, 0, v181
    v_mov_b32 v181, 0x3f803f80
    s_waitcnt lgkmcnt(0)
    v_sub_f32 v116, 0, v177
    v_mfma_f32_16x16x32_bf16 v[136:139], v[184:187], v[32:35], v[112:115]
    v_sub_f32 v117, 0, v177
    v_sub_f32 v118, 0, v177
    v_sub_f32 v119, 0, v177
    v_sub_f32 v120, 0, v178
    v_mfma_f32_16x16x32_bf16 v[136:139], v[188:191], v[36:39], v[136:139]
    v_sub_f32 v121, 0, v178
    v_sub_f32 v122, 0, v178
    v_sub_f32 v123, 0, v178
    v_sub_f32 v124, 0, v179
    v_mfma_f32_16x16x32_bf16 v[136:139], v[192:195], v[40:43], v[136:139]
    v_sub_f32 v125, 0, v179
    v_sub_f32 v126, 0, v179
    v_sub_f32 v127, 0, v179
    v_sub_f32 v128, 0, v180
    v_mfma_f32_16x16x32_bf16 v[136:139], v[196:199], v[44:47], v[136:139]
    v_sub_f32 v129, 0, v180
    v_sub_f32 v130, 0, v180
    v_sub_f32 v131, 0, v180
    v_mov_b32 v168, 0
    v_mfma_f32_16x16x32_bf16 v[140:143], v[200:203], v[44:47], v[112:115]
    v_mov_b32 v169, 0
    v_mov_b32 v170, 0
    v_mov_b32 v171, 0
    v_mov_b32 v172, 0
    v_mfma_f32_16x16x32_bf16 v[140:143], v[204:207], v[40:43], v[140:143]
    v_mov_b32 v173, 0
    v_mov_b32 v174, 0
    v_mov_b32 v175, 0
    v_cndmask_b32 v132, 0, v181, vcc
    v_mfma_f32_16x16x32_bf16 v[140:143], v[208:211], v[36:39], v[140:143]
    v_cndmask_b32 v133, 0, v181, vcc
    v_cndmask_b32 v134, 0, v181, vcc
    v_cndmask_b32 v135, 0, v181, vcc
    v_mfma_f32_16x16x32_bf16 v[140:143], v[212:215], v[32:35], v[140:143]
    s_cmp_eq_u32 s49, 0
    s_cbranch_scc0 L_prodone
    s_cmp_eq_u32 s47, 3
    s_cbranch_scc1 L_pro3
    s_waitcnt vmcnt(0)
    s_barrier
    s_cmp_eq_u32 s48, 0
    s_cbranch_scc1 L_prodone
    buffer_load_dwordx4 a[224:227], v15, s[24:27], 0 offen offset:0 nt
    buffer_load_dwordx4 a[228:231], v15, s[24:27], 0 offen offset:64 nt
    buffer_load_dwordx4 a[232:235], v15, s[24:27], 0 offen offset:128 nt
    buffer_load_dwordx4 a[236:239], v15, s[24:27], 0 offen offset:192 nt
    s_branch L_prodone
L_pro3:
    s_waitcnt vmcnt(32)
    s_barrier
    s_mov_b32 m0, 32768
    s_add_u32 s38, s28, 0
    buffer_load_dwordx4 v108, s[12:15], s38 offen nt lds
    s_mov_b32 m0, 33792
    s_add_u32 s38, s28, 16384
    buffer_load_dwordx4 v108, s[12:15], s38 offen nt lds
    s_mov_b32 m0, 34816
    s_add_u32 s38, s28, 32768
    buffer_load_dwordx4 v108, s[12:15], s38 offen nt lds
    s_mov_b32 m0, 35840
    s_add_u32 s38, s28, 49152
    buffer_load_dwordx4 v108, s[12:15], s38 offen nt lds
    s_mov_b32 m0, 36864
    s_add_u32 s38, s28, 65536
    buffer_load_dwordx4 v109, s[12:15], s38 offen nt lds
    s_mov_b32 m0, 37888
    s_add_u32 s38, s28, 81920
    buffer_load_dwordx4 v109, s[12:15], s38 offen nt lds
    s_mov_b32 m0, 38912
    s_add_u32 s38, s28, 98304
    buffer_load_dwordx4 v109, s[12:15], s38 offen nt lds
    s_mov_b32 m0, 39936
    s_add_u32 s38, s28, 114688
    buffer_load_dwordx4 v109, s[12:15], s38 offen nt lds
    s_mov_b32 m0, 40960
    s_add_u32 s38, s28, 131072
    buffer_load_dwordx4 v110, s[12:15], s38 offen nt lds
    s_mov_b32 m0, 41984
    s_add_u32 s38, s28, 147456
    buffer_load_dwordx4 v110, s[12:15], s38 offen nt lds
    s_mov_b32 m0, 43008
    s_add_u32 s38, s28, 163840
    buffer_load_dwordx4 v110, s[12:15], s38 offen nt lds
    s_mov_b32 m0, 44032
    s_add_u32 s38, s28, 180224
    buffer_load_dwordx4 v110, s[12:15], s38 offen nt lds
    s_mov_b32 m0, 45056
    s_add_u32 s38, s28, 196608
    buffer_load_dwordx4 v111, s[12:15], s38 offen nt lds
    s_mov_b32 m0, 46080
    s_add_u32 s38, s28, 212992
    buffer_load_dwordx4 v111, s[12:15], s38 offen nt lds
    s_mov_b32 m0, 47104
    s_add_u32 s38, s28, 229376
    buffer_load_dwordx4 v111, s[12:15], s38 offen nt lds
    s_mov_b32 m0, 48128
    s_add_u32 s38, s28, 245760
    buffer_load_dwordx4 v111, s[12:15], s38 offen nt lds
    s_mov_b32 m0, 81920
    s_add_u32 s38, s28, 0
    buffer_load_dwordx4 v108, s[16:19], s38 offen nt lds
    s_mov_b32 m0, 82944
    s_add_u32 s38, s28, 16384
    buffer_load_dwordx4 v108, s[16:19], s38 offen nt lds
    s_mov_b32 m0, 83968
    s_add_u32 s38, s28, 32768
    buffer_load_dwordx4 v108, s[16:19], s38 offen nt lds
    s_mov_b32 m0, 84992
    s_add_u32 s38, s28, 49152
    buffer_load_dwordx4 v108, s[16:19], s38 offen nt lds
    s_mov_b32 m0, 86016
    s_add_u32 s38, s28, 65536
    buffer_load_dwordx4 v109, s[16:19], s38 offen nt lds
    s_mov_b32 m0, 87040
    s_add_u32 s38, s28, 81920
    buffer_load_dwordx4 v109, s[16:19], s38 offen nt lds
    s_mov_b32 m0, 88064
    s_add_u32 s38, s28, 98304
    buffer_load_dwordx4 v109, s[16:19], s38 offen nt lds
    s_mov_b32 m0, 89088
    s_add_u32 s38, s28, 114688
    buffer_load_dwordx4 v109, s[16:19], s38 offen nt lds
    s_mov_b32 m0, 90112
    s_add_u32 s38, s28, 131072
    buffer_load_dwordx4 v110, s[16:19], s38 offen nt lds
    s_mov_b32 m0, 91136
    s_add_u32 s38, s28, 147456
    buffer_load_dwordx4 v110, s[16:19], s38 offen nt lds
    s_mov_b32 m0, 92160
    s_add_u32 s38, s28, 163840
    buffer_load_dwordx4 v110, s[16:19], s38 offen nt lds
    s_mov_b32 m0, 93184
    s_add_u32 s38, s28, 180224
    buffer_load_dwordx4 v110, s[16:19], s38 offen nt lds
    s_mov_b32 m0, 94208
    s_add_u32 s38, s28, 196608
    buffer_load_dwordx4 v111, s[16:19], s38 offen nt lds
    s_mov_b32 m0, 95232
    s_add_u32 s38, s28, 212992
    buffer_load_dwordx4 v111, s[16:19], s38 offen nt lds
    s_mov_b32 m0, 96256
    s_add_u32 s38, s28, 229376
    buffer_load_dwordx4 v111, s[16:19], s38 offen nt lds
    s_mov_b32 m0, 97280
    s_add_u32 s38, s28, 245760
    buffer_load_dwordx4 v111, s[16:19], s38 offen nt lds
    s_or_b32 s28, s28, 0xffffc3ff
    s_add_u32 s28, s28, 1
    s_and_b32 s28, s28, 0x3c00
    s_add_u32 s30, s30, 16384
    s_and_b32 s55, s30, 262144
    s_or_b32 s28, s28, s55
L_prodone:
    s_cmp_eq_u32 s47, 3
    s_cbranch_scc1 L_ent4
    s_cmp_eq_u32 s49, 0
    s_cbranch_scc0 L_loop5_1
.p2align 6
L_loop5_0:
    v_mfma_f32_16x16x32_bf16 v[144:147], v[216:219], v[32:35], v[112:115]
    s_waitcnt lgkmcnt(0)
    v_mfma_f32_16x16x32_bf16 v[144:147], v[220:223], v[36:39], v[144:147]
    v_exp_f32 v136, v136
    v_mfma_f32_16x16x32_bf16 v[144:147], v[224:227], v[40:43], v[144:147]
    v_mfma_f32_16x16x32_bf16 v[144:147], v[228:231], v[44:47], v[144:147]
    v_exp_f32 v137, v137
    v_mfma_f32_16x16x32_bf16 v[148:151], v[232:235], v[44:47], v[112:115]
    v_cvt_pk_bf16_f32 v136, v136, v137
    v_mfma_f32_16x16x32_bf16 v[148:151], v[236:239], v[40:43], v[148:151]
    v_exp_f32 v138, v138
    v_mfma_f32_16x16x32_bf16 v[148:151], v[240:243], v[36:39], v[148:151]
    v_mfma_f32_16x16x32_bf16 v[148:151], v[244:247], v[32:35], v[148:151]
    v_exp_f32 v139, v139
    v_mfma_f32_16x16x32_bf16 a[128:131], a[160:163], v[168:171], a[128:131]
    ds_read_b64_tr_b16 a[160:161], v6
    v_cvt_pk_bf16_f32 v137, v138, v139
    v_mfma_f32_16x16x32_bf16 a[128:131], a[164:167], v[172:175], a[128:131]
    v_exp_f32 v140, v140
    v_mfma_f32_16x16x32_bf16 a[132:135], a[168:171], v[172:175], a[132:135]
    ds_read_b64_tr_b16 a[162:163], v6 offset:1024
    ds_read_b64_tr_b16 a[164:165], v6 offset:2048
    v_mfma_f32_16x16x32_bf16 a[132:135], a[172:175], v[168:171], a[132:135]
    v_exp_f32 v141, v141
    v_mfma_f32_16x16x32_bf16 a[136:139], a[176:179], v[168:171], a[136:139]
    ds_read_b64_tr_b16 a[166:167], v6 offset:3072
    v_cvt_pk_bf16_f32 v138, v140, v141
    v_mfma_f32_16x16x32_bf16 a[136:139], a[180:183], v[172:175], a[136:139]
    v_exp_f32 v142, v142
    v_mfma_f32_16x16x32_bf16 a[140:143], a[184:187], v[172:175], a[140:143]
    ds_read_b64_tr_b16 a[168:169], v7 offset:2048
    ds_read_b64_tr_b16 a[170:171], v7 offset:3072
    v_mfma_f32_16x16x32_bf16 a[140:143], a[188:191], v[168:171], a[140:143]
    v_exp_f32 v143, v143
    v_mfma_f32_16x16x32_bf16 a[144:147], a[192:195], v[168:171], a[144:147]
    ds_read_b64_tr_b16 a[172:173], v7
    v_cvt_pk_bf16_f32 v139, v142, v143
    v_mfma_f32_16x16x32_bf16 a[144:147], a[196:199], v[172:175], a[144:147]
    v_exp_f32 v144, v144
    v_mfma_f32_16x16x32_bf16 a[148:151], a[200:203], v[172:175], a[148:151]
    ds_read_b64_tr_b16 a[174:175], v7 offset:1024
    ds_read_b64_tr_b16 a[176:177], v8
    v_mfma_f32_16x16x32_bf16 a[148:151], a[204:207], v[168:171], a[148:151]
    v_exp_f32 v145, v145
    v_mfma_f32_16x16x32_bf16 a[152:155], a[208:211], v[168:171], a[152:155]
    ds_read_b64_tr_b16 a[178:179], v8 offset:1024
    v_cvt_pk_bf16_f32 v140, v144, v145
    v_mfma_f32_16x16x32_bf16 a[152:155], a[212:215], v[172:175], a[152:155]
    v_exp_f32 v146, v146
    v_mfma_f32_16x16x32_bf16 a[156:159], a[216:219], v[172:175], a[156:159]
    ds_read_b64_tr_b16 a[180:181], v8 offset:2048
    ds_read_b64_tr_b16 a[182:183], v8 offset:3072
    v_mfma_f32_16x16x32_bf16 a[156:159], a[220:223], v[168:171], a[156:159]
    v_exp_f32 v147, v147
    v_smfmac_f32_16x16x64_bf16 v[252:255], v[132:135], v[168:175], v0
    ds_read_b64_tr_b16 a[184:185], v9 offset:2048
    v_cvt_pk_bf16_f32 v141, v146, v147
    v_mfma_f32_16x16x32_bf16 v[152:155], v[184:187], v[48:51], v[116:119]
    v_exp_f32 v148, v148
    v_mfma_f32_16x16x32_bf16 v[152:155], v[188:191], v[52:55], v[152:155]
    ds_read_b64_tr_b16 a[186:187], v9 offset:3072
    ds_read_b64_tr_b16 a[188:189], v9
    v_mfma_f32_16x16x32_bf16 v[152:155], v[192:195], v[56:59], v[152:155]
    v_exp_f32 v149, v149
    v_mfma_f32_16x16x32_bf16 v[152:155], v[196:199], v[60:63], v[152:155]
    ds_read_b64_tr_b16 a[190:191], v9 offset:1024
    v_cvt_pk_bf16_f32 v142, v148, v149
    v_mfma_f32_16x16x32_bf16 v[156:159], v[200:203], v[60:63], v[116:119]
    v_exp_f32 v150, v150
    v_mfma_f32_16x16x32_bf16 v[156:159], v[204:207], v[56:59], v[156:159]
    ds_read_b64_tr_b16 a[192:193], v10
    ds_read_b64_tr_b16 a[194:195], v10 offset:1024
    v_mfma_f32_16x16x32_bf16 v[156:159], v[208:211], v[52:55], v[156:159]
    v_exp_f32 v151, v151
    v_mfma_f32_16x16x32_bf16 v[156:159], v[212:215], v[48:51], v[156:159]
    ds_read_b64_tr_b16 a[196:197], v10 offset:2048
    v_cvt_pk_bf16_f32 v143, v150, v151
    v_mfma_f32_16x16x32_bf16 v[160:163], v[216:219], v[48:51], v[116:119]
    ds_read_b64_tr_b16 a[198:199], v10 offset:3072
    ds_read_b64_tr_b16 a[200:201], v11 offset:2048
    v_mfma_f32_16x16x32_bf16 v[160:163], v[220:223], v[52:55], v[160:163]
    v_exp_f32 v152, v152
    v_mfma_f32_16x16x32_bf16 v[160:163], v[224:227], v[56:59], v[160:163]
    ds_read_b64_tr_b16 a[202:203], v11 offset:3072
    ds_read_b64_tr_b16 a[204:205], v11
    v_mfma_f32_16x16x32_bf16 v[160:163], v[228:231], v[60:63], v[160:163]
    v_exp_f32 v153, v153
    v_mfma_f32_16x16x32_bf16 v[164:167], v[232:235], v[60:63], v[116:119]
    ds_read_b64_tr_b16 a[206:207], v11 offset:1024
    v_cvt_pk_bf16_f32 v152, v152, v153
    v_mfma_f32_16x16x32_bf16 v[164:167], v[236:239], v[56:59], v[164:167]
    v_exp_f32 v154, v154
    v_mfma_f32_16x16x32_bf16 v[164:167], v[240:243], v[52:55], v[164:167]
    ds_read_b64_tr_b16 a[208:209], v12
    ds_read_b64_tr_b16 a[210:211], v12 offset:1024
    v_mfma_f32_16x16x32_bf16 v[164:167], v[244:247], v[48:51], v[164:167]
    s_waitcnt lgkmcnt(7)
    v_exp_f32 v155, v155
    v_mfma_f32_16x16x32_bf16 a[0:3], a[160:163], v[136:139], a[0:3]
    ds_read_b64_tr_b16 a[212:213], v12 offset:2048
    v_cvt_pk_bf16_f32 v153, v154, v155
    v_mfma_f32_16x16x32_bf16 a[0:3], a[164:167], v[140:143], a[0:3]
    v_exp_f32 v156, v156
    v_mfma_f32_16x16x32_bf16 a[4:7], a[168:171], v[140:143], a[4:7]
    ds_read_b64_tr_b16 a[214:215], v12 offset:3072
    ds_read_b64_tr_b16 a[216:217], v13 offset:2048
    v_mfma_f32_16x16x32_bf16 a[4:7], a[172:175], v[136:139], a[4:7]
    v_exp_f32 v157, v157
    v_mfma_f32_16x16x32_bf16 a[8:11], a[176:179], v[136:139], a[8:11]
    ds_read_b64_tr_b16 a[218:219], v13 offset:3072
    v_cvt_pk_bf16_f32 v154, v156, v157
    v_mfma_f32_16x16x32_bf16 a[8:11], a[180:183], v[140:143], a[8:11]
    v_exp_f32 v158, v158
    v_mfma_f32_16x16x32_bf16 a[12:15], a[184:187], v[140:143], a[12:15]
    ds_read_b64_tr_b16 a[220:221], v13
    ds_read_b64_tr_b16 a[222:223], v13 offset:1024
    v_mfma_f32_16x16x32_bf16 a[12:15], a[188:191], v[136:139], a[12:15]
    v_exp_f32 v159, v159
    v_mfma_f32_16x16x32_bf16 a[16:19], a[192:195], v[136:139], a[16:19]
    s_waitcnt lgkmcnt(5)
    v_cvt_pk_bf16_f32 v155, v158, v159
    v_mfma_f32_16x16x32_bf16 a[16:19], a[196:199], v[140:143], a[16:19]
    v_exp_f32 v160, v160
    v_mfma_f32_16x16x32_bf16 a[20:23], a[200:203], v[140:143], a[20:23]
    v_mfma_f32_16x16x32_bf16 a[20:23], a[204:207], v[136:139], a[20:23]
    v_exp_f32 v161, v161
    v_mfma_f32_16x16x32_bf16 a[24:27], a[208:211], v[136:139], a[24:27]
    s_waitcnt lgkmcnt(2)
    v_cvt_pk_bf16_f32 v156, v160, v161
    v_mfma_f32_16x16x32_bf16 a[24:27], a[212:215], v[140:143], a[24:27]
    v_exp_f32 v162, v162
    v_mfma_f32_16x16x32_bf16 a[28:31], a[216:219], v[140:143], a[28:31]
    s_waitcnt lgkmcnt(0)
    v_mfma_f32_16x16x32_bf16 a[28:31], a[220:223], v[136:139], a[28:31]
    v_exp_f32 v163, v163
    v_smfmac_f32_16x16x64_bf16 v[20:23], v[132:135], v[136:143], v0
    v_cvt_pk_bf16_f32 v157, v162, v163
    v_mfma_f32_16x16x32_bf16 v[136:139], v[184:187], v[64:67], v[120:123]
    v_exp_f32 v164, v164
    v_mfma_f32_16x16x32_bf16 v[136:139], v[188:191], v[68:71], v[136:139]
    v_mfma_f32_16x16x32_bf16 v[136:139], v[192:195], v[72:75], v[136:139]
    v_exp_f32 v165, v165
    v_mfma_f32_16x16x32_bf16 v[136:139], v[196:199], v[76:79], v[136:139]
    v_cvt_pk_bf16_f32 v158, v164, v165
    v_mfma_f32_16x16x32_bf16 v[140:143], v[200:203], v[76:79], v[120:123]
    v_exp_f32 v166, v166
    v_mfma_f32_16x16x32_bf16 v[140:143], v[204:207], v[72:75], v[140:143]
    v_mfma_f32_16x16x32_bf16 v[140:143], v[208:211], v[68:71], v[140:143]
    v_exp_f32 v167, v167
    v_mfma_f32_16x16x32_bf16 v[140:143], v[212:215], v[64:67], v[140:143]
    v_cvt_pk_bf16_f32 v159, v166, v167
    v_mfma_f32_16x16x32_bf16 v[144:147], v[216:219], v[64:67], v[120:123]
    v_mfma_f32_16x16x32_bf16 v[144:147], v[220:223], v[68:71], v[144:147]
    v_exp_f32 v136, v136
    v_mfma_f32_16x16x32_bf16 v[144:147], v[224:227], v[72:75], v[144:147]
    v_mfma_f32_16x16x32_bf16 v[144:147], v[228:231], v[76:79], v[144:147]
    v_exp_f32 v137, v137
    v_mfma_f32_16x16x32_bf16 v[148:151], v[232:235], v[76:79], v[120:123]
    v_cvt_pk_bf16_f32 v136, v136, v137
    v_mfma_f32_16x16x32_bf16 v[148:151], v[236:239], v[72:75], v[148:151]
    v_exp_f32 v138, v138
    v_mfma_f32_16x16x32_bf16 v[148:151], v[240:243], v[68:71], v[148:151]
    v_mfma_f32_16x16x32_bf16 v[148:151], v[244:247], v[64:67], v[148:151]
    v_exp_f32 v139, v139
    v_mfma_f32_16x16x32_bf16 a[32:35], a[160:163], v[152:155], a[32:35]
    v_cvt_pk_bf16_f32 v137, v138, v139
    v_mfma_f32_16x16x32_bf16 a[32:35], a[164:167], v[156:159], a[32:35]
    v_exp_f32 v140, v140
    v_mfma_f32_16x16x32_bf16 a[36:39], a[168:171], v[156:159], a[36:39]
    v_mfma_f32_16x16x32_bf16 a[36:39], a[172:175], v[152:155], a[36:39]
    v_exp_f32 v141, v141
    v_mfma_f32_16x16x32_bf16 a[40:43], a[176:179], v[152:155], a[40:43]
    v_cvt_pk_bf16_f32 v138, v140, v141
    v_mfma_f32_16x16x32_bf16 a[40:43], a[180:183], v[156:159], a[40:43]
    v_exp_f32 v142, v142
    v_mfma_f32_16x16x32_bf16 a[44:47], a[184:187], v[156:159], a[44:47]
    v_mfma_f32_16x16x32_bf16 a[44:47], a[188:191], v[152:155], a[44:47]
    v_exp_f32 v143, v143
    v_mfma_f32_16x16x32_bf16 a[48:51], a[192:195], v[152:155], a[48:51]
    v_cvt_pk_bf16_f32 v139, v142, v143
    v_mfma_f32_16x16x32_bf16 a[48:51], a[196:199], v[156:159], a[48:51]
    v_exp_f32 v144, v144
    v_mfma_f32_16x16x32_bf16 a[52:55], a[200:203], v[156:159], a[52:55]
    v_mfma_f32_16x16x32_bf16 a[52:55], a[204:207], v[152:155], a[52:55]
    v_exp_f32 v145, v145
    v_mfma_f32_16x16x32_bf16 a[56:59], a[208:211], v[152:155], a[56:59]
    v_cvt_pk_bf16_f32 v140, v144, v145
    v_mfma_f32_16x16x32_bf16 a[56:59], a[212:215], v[156:159], a[56:59]
    v_exp_f32 v146, v146
    v_mfma_f32_16x16x32_bf16 a[60:63], a[216:219], v[156:159], a[60:63]
    v_mfma_f32_16x16x32_bf16 a[60:63], a[220:223], v[152:155], a[60:63]
    v_exp_f32 v147, v147
    v_smfmac_f32_16x16x64_bf16 v[24:27], v[132:135], v[152:159], v0
    v_cvt_pk_bf16_f32 v141, v146, v147
    v_mfma_f32_16x16x32_bf16 v[152:155], v[184:187], v[80:83], v[124:127]
    v_exp_f32 v148, v148
    v_mfma_f32_16x16x32_bf16 v[152:155], v[188:191], v[84:87], v[152:155]
    v_mfma_f32_16x16x32_bf16 v[152:155], v[192:195], v[88:91], v[152:155]
    v_exp_f32 v149, v149
    v_mfma_f32_16x16x32_bf16 v[152:155], v[196:199], v[92:95], v[152:155]
    v_cvt_pk_bf16_f32 v142, v148, v149
    v_mfma_f32_16x16x32_bf16 v[156:159], v[200:203], v[92:95], v[124:127]
    v_exp_f32 v150, v150
    v_mfma_f32_16x16x32_bf16 v[156:159], v[204:207], v[88:91], v[156:159]
    v_mfma_f32_16x16x32_bf16 v[156:159], v[208:211], v[84:87], v[156:159]
    v_exp_f32 v151, v151
    v_mfma_f32_16x16x32_bf16 v[156:159], v[212:215], v[80:83], v[156:159]
    v_cvt_pk_bf16_f32 v143, v150, v151
    v_mfma_f32_16x16x32_bf16 v[160:163], v[216:219], v[80:83], v[124:127]
    v_mfma_f32_16x16x32_bf16 v[160:163], v[220:223], v[84:87], v[160:163]
    v_exp_f32 v152, v152
    v_mfma_f32_16x16x32_bf16 v[160:163], v[224:227], v[88:91], v[160:163]
    v_mfma_f32_16x16x32_bf16 v[160:163], v[228:231], v[92:95], v[160:163]
    v_exp_f32 v153, v153
    v_mfma_f32_16x16x32_bf16 v[164:167], v[232:235], v[92:95], v[124:127]
    v_cvt_pk_bf16_f32 v152, v152, v153
    v_mfma_f32_16x16x32_bf16 v[164:167], v[236:239], v[88:91], v[164:167]
    v_exp_f32 v154, v154
    v_mfma_f32_16x16x32_bf16 v[164:167], v[240:243], v[84:87], v[164:167]
    v_mfma_f32_16x16x32_bf16 v[164:167], v[244:247], v[80:83], v[164:167]
    v_exp_f32 v155, v155
    v_mfma_f32_16x16x32_bf16 a[64:67], a[160:163], v[136:139], a[64:67]
    v_cvt_pk_bf16_f32 v153, v154, v155
    v_mfma_f32_16x16x32_bf16 a[64:67], a[164:167], v[140:143], a[64:67]
    v_exp_f32 v156, v156
    v_mfma_f32_16x16x32_bf16 a[68:71], a[168:171], v[140:143], a[68:71]
    v_mfma_f32_16x16x32_bf16 a[68:71], a[172:175], v[136:139], a[68:71]
    v_exp_f32 v157, v157
    v_mfma_f32_16x16x32_bf16 a[72:75], a[176:179], v[136:139], a[72:75]
    v_cvt_pk_bf16_f32 v154, v156, v157
    v_mfma_f32_16x16x32_bf16 a[72:75], a[180:183], v[140:143], a[72:75]
    v_exp_f32 v158, v158
    v_mfma_f32_16x16x32_bf16 a[76:79], a[184:187], v[140:143], a[76:79]
    v_mfma_f32_16x16x32_bf16 a[76:79], a[188:191], v[136:139], a[76:79]
    v_exp_f32 v159, v159
    v_mfma_f32_16x16x32_bf16 a[80:83], a[192:195], v[136:139], a[80:83]
    v_cvt_pk_bf16_f32 v155, v158, v159
    v_mfma_f32_16x16x32_bf16 a[80:83], a[196:199], v[140:143], a[80:83]
    s_waitcnt lgkmcnt(0)
    v_exp_f32 v160, v160
    v_mfma_f32_16x16x32_bf16 a[84:87], a[200:203], v[140:143], a[84:87]
    s_barrier
    v_mfma_f32_16x16x32_bf16 a[84:87], a[204:207], v[136:139], a[84:87]
    v_exp_f32 v161, v161
    v_mfma_f32_16x16x32_bf16 a[88:91], a[208:211], v[136:139], a[88:91]
    v_cvt_pk_bf16_f32 v156, v160, v161
    v_mfma_f32_16x16x32_bf16 a[88:91], a[212:215], v[140:143], a[88:91]
    v_exp_f32 v162, v162
    v_mfma_f32_16x16x32_bf16 a[92:95], a[216:219], v[140:143], a[92:95]
    v_mfma_f32_16x16x32_bf16 a[92:95], a[220:223], v[136:139], a[92:95]
    v_exp_f32 v163, v163
    v_smfmac_f32_16x16x64_bf16 v[28:31], v[132:135], v[136:143], v0
    v_cvt_pk_bf16_f32 v157, v162, v163
    v_mfma_f32_16x16x32_bf16 v[168:171], v[184:187], v[96:99], v[128:131]
    v_exp_f32 v164, v164
    v_mfma_f32_16x16x32_bf16 v[168:171], v[188:191], v[100:103], v[168:171]
    ds_read_b128 v[184:187], v2 offset:16384
    v_mfma_f32_16x16x32_bf16 v[168:171], v[192:195], v[104:107], v[168:171]
    v_exp_f32 v165, v165
    v_mfma_f32_16x16x32_bf16 v[168:171], v[196:199], v[108:111], v[168:171]
    ds_read_b128 v[188:191], v3 offset:16384
    v_cvt_pk_bf16_f32 v158, v164, v165
    v_mfma_f32_16x16x32_bf16 v[172:175], v[200:203], v[108:111], v[128:131]
    v_exp_f32 v166, v166
    v_mfma_f32_16x16x32_bf16 v[172:175], v[204:207], v[104:107], v[172:175]
    ds_read_b128 v[192:195], v4 offset:16384
    v_mfma_f32_16x16x32_bf16 v[172:175], v[208:211], v[100:103], v[172:175]
    v_exp_f32 v167, v167
    v_mfma_f32_16x16x32_bf16 v[172:175], v[212:215], v[96:99], v[172:175]
    ds_read_b128 v[196:199], v5 offset:16384
    v_cvt_pk_bf16_f32 v159, v166, v167
    v_mfma_f32_16x16x32_bf16 v[176:179], v[216:219], v[96:99], v[128:131]
    ds_read_b128 v[200:203], v5 offset:17408
    v_mfma_f32_16x16x32_bf16 v[176:179], v[220:223], v[100:103], v[176:179]
    v_exp_f32 v168, v168
    v_mfma_f32_16x16x32_bf16 v[176:179], v[224:227], v[104:107], v[176:179]
    ds_read_b128 v[204:207], v4 offset:17408
    v_mfma_f32_16x16x32_bf16 v[176:179], v[228:231], v[108:111], v[176:179]
    v_exp_f32 v169, v169
    v_mfma_f32_16x16x32_bf16 v[180:183], v[232:235], v[108:111], v[128:131]
    ds_read_b128 v[208:211], v3 offset:17408
    v_cvt_pk_bf16_f32 v168, v168, v169
    v_mfma_f32_16x16x32_bf16 v[180:183], v[236:239], v[104:107], v[180:183]
    v_exp_f32 v170, v170
    v_mfma_f32_16x16x32_bf16 v[180:183], v[240:243], v[100:103], v[180:183]
    ds_read_b128 v[212:215], v2 offset:17408
    v_mfma_f32_16x16x32_bf16 v[180:183], v[244:247], v[96:99], v[180:183]
    v_exp_f32 v171, v171
    v_mfma_f32_16x16x32_bf16 a[96:99], a[160:163], v[152:155], a[96:99]
    ds_read_b128 v[216:219], v2 offset:18432
    v_cvt_pk_bf16_f32 v169, v170, v171
    v_mfma_f32_16x16x32_bf16 a[96:99], a[164:167], v[156:159], a[96:99]
    v_exp_f32 v172, v172
    v_mfma_f32_16x16x32_bf16 a[100:103], a[168:171], v[156:159], a[100:103]
    ds_read_b128 v[220:223], v3 offset:18432
    v_mfma_f32_16x16x32_bf16 a[100:103], a[172:175], v[152:155], a[100:103]
    v_exp_f32 v173, v173
    v_mfma_f32_16x16x32_bf16 a[104:107], a[176:179], v[152:155], a[104:107]
    ds_read_b128 v[224:227], v4 offset:18432
    v_cvt_pk_bf16_f32 v170, v172, v173
    v_mfma_f32_16x16x32_bf16 a[104:107], a[180:183], v[156:159], a[104:107]
    v_exp_f32 v174, v174
    v_mfma_f32_16x16x32_bf16 a[108:111], a[184:187], v[156:159], a[108:111]
    ds_read_b128 v[228:231], v5 offset:18432
    v_mfma_f32_16x16x32_bf16 a[108:111], a[188:191], v[152:155], a[108:111]
    v_exp_f32 v175, v175
    v_mfma_f32_16x16x32_bf16 a[112:115], a[192:195], v[152:155], a[112:115]
    ds_read_b128 v[232:235], v5 offset:19456
    v_cvt_pk_bf16_f32 v171, v174, v175
    v_mfma_f32_16x16x32_bf16 a[112:115], a[196:199], v[156:159], a[112:115]
    v_exp_f32 v176, v176
    v_mfma_f32_16x16x32_bf16 a[116:119], a[200:203], v[156:159], a[116:119]
    ds_read_b128 v[236:239], v4 offset:19456
    v_mfma_f32_16x16x32_bf16 a[116:119], a[204:207], v[152:155], a[116:119]
    v_exp_f32 v177, v177
    v_mfma_f32_16x16x32_bf16 a[120:123], a[208:211], v[152:155], a[120:123]
    ds_read_b128 v[240:243], v3 offset:19456
    v_cvt_pk_bf16_f32 v172, v176, v177
    v_mfma_f32_16x16x32_bf16 a[120:123], a[212:215], v[156:159], a[120:123]
    v_exp_f32 v178, v178
    v_mfma_f32_16x16x32_bf16 a[124:127], a[216:219], v[156:159], a[124:127]
    ds_read_b128 v[244:247], v2 offset:19456
    v_mfma_f32_16x16x32_bf16 a[124:127], a[220:223], v[152:155], a[124:127]
    v_exp_f32 v179, v179
    v_smfmac_f32_16x16x64_bf16 v[248:251], v[132:135], v[152:159], v0
    s_waitcnt lgkmcnt(3)
    v_cvt_pk_bf16_f32 v173, v178, v179
    v_mfma_f32_16x16x32_bf16 v[136:139], v[184:187], v[32:35], v[112:115]
    v_exp_f32 v180, v180
    v_mfma_f32_16x16x32_bf16 v[136:139], v[188:191], v[36:39], v[136:139]
    v_mfma_f32_16x16x32_bf16 v[136:139], v[192:195], v[40:43], v[136:139]
    v_exp_f32 v181, v181
    v_mfma_f32_16x16x32_bf16 v[136:139], v[196:199], v[44:47], v[136:139]
    v_cvt_pk_bf16_f32 v174, v180, v181
    v_mfma_f32_16x16x32_bf16 v[140:143], v[200:203], v[44:47], v[112:115]
    s_add_u32 s37, s37, 1
    v_exp_f32 v182, v182
    v_mfma_f32_16x16x32_bf16 v[140:143], v[204:207], v[40:43], v[140:143]
    v_mfma_f32_16x16x32_bf16 v[140:143], v[208:211], v[36:39], v[140:143]
    s_cmp_ge_u32 s37, s53
    v_exp_f32 v183, v183
    v_mfma_f32_16x16x32_bf16 v[140:143], v[212:215], v[32:35], v[140:143]
    v_cvt_pk_bf16_f32 v175, v182, v183
    s_cbranch_scc1 L_out5
L_loop5_1:
    v_mfma_f32_16x16x32_bf16 v[144:147], v[216:219], v[32:35], v[112:115]
    s_waitcnt lgkmcnt(0)
    v_mfma_f32_16x16x32_bf16 v[144:147], v[220:223], v[36:39], v[144:147]
    v_exp_f32 v136, v136
    v_mfma_f32_16x16x32_bf16 v[144:147], v[224:227], v[40:43], v[144:147]
    v_mfma_f32_16x16x32_bf16 v[144:147], v[228:231], v[44:47], v[144:147]
    v_exp_f32 v137, v137
    v_mfma_f32_16x16x32_bf16 v[148:151], v[232:235], v[44:47], v[112:115]
    v_cvt_pk_bf16_f32 v136, v136, v137
    v_mfma_f32_16x16x32_bf16 v[148:151], v[236:239], v[40:43], v[148:151]
    v_exp_f32 v138, v138
    v_mfma_f32_16x16x32_bf16 v[148:151], v[240:243], v[36:39], v[148:151]
    v_mfma_f32_16x16x32_bf16 v[148:151], v[244:247], v[32:35], v[148:151]
    v_exp_f32 v139, v139
    v_mfma_f32_16x16x32_bf16 a[128:131], a[160:163], v[168:171], a[128:131]
    ds_read_b64_tr_b16 a[160:161], v6 offset:16384
    v_cvt_pk_bf16_f32 v137, v138, v139
    v_mfma_f32_16x16x32_bf16 a[128:131], a[164:167], v[172:175], a[128:131]
    v_exp_f32 v140, v140
    v_mfma_f32_16x16x32_bf16 a[132:135], a[168:171], v[172:175], a[132:135]
    ds_read_b64_tr_b16 a[162:163], v6 offset:17408
    ds_read_b64_tr_b16 a[164:165], v6 offset:18432
    v_mfma_f32_16x16x32_bf16 a[132:135], a[172:175], v[168:171], a[132:135]
    v_exp_f32 v141, v141
    v_mfma_f32_16x16x32_bf16 a[136:139], a[176:179], v[168:171], a[136:139]
    ds_read_b64_tr_b16 a[166:167], v6 offset:19456
    v_cvt_pk_bf16_f32 v138, v140, v141
    v_mfma_f32_16x16x32_bf16 a[136:139], a[180:183], v[172:175], a[136:139]
    v_exp_f32 v142, v142
    v_mfma_f32_16x16x32_bf16 a[140:143], a[184:187], v[172:175], a[140:143]
    ds_read_b64_tr_b16 a[168:169], v7 offset:18432
    ds_read_b64_tr_b16 a[170:171], v7 offset:19456
    v_mfma_f32_16x16x32_bf16 a[140:143], a[188:191], v[168:171], a[140:143]
    v_exp_f32 v143, v143
    v_mfma_f32_16x16x32_bf16 a[144:147], a[192:195], v[168:171], a[144:147]
    ds_read_b64_tr_b16 a[172:173], v7 offset:16384
    v_cvt_pk_bf16_f32 v139, v142, v143
    v_mfma_f32_16x16x32_bf16 a[144:147], a[196:199], v[172:175], a[144:147]
    v_exp_f32 v144, v144
    v_mfma_f32_16x16x32_bf16 a[148:151], a[200:203], v[172:175], a[148:151]
    ds_read_b64_tr_b16 a[174:175], v7 offset:17408
    ds_read_b64_tr_b16 a[176:177], v8 offset:16384
    v_mfma_f32_16x16x32_bf16 a[148:151], a[204:207], v[168:171], a[148:151]
    v_exp_f32 v145, v145
    v_mfma_f32_16x16x32_bf16 a[152:155], a[208:211], v[168:171], a[152:155]
    ds_read_b64_tr_b16 a[178:179], v8 offset:17408
    v_cvt_pk_bf16_f32 v140, v144, v145
    v_mfma_f32_16x16x32_bf16 a[152:155], a[212:215], v[172:175], a[152:155]
    v_exp_f32 v146, v146
    v_mfma_f32_16x16x32_bf16 a[156:159], a[216:219], v[172:175], a[156:159]
    ds_read_b64_tr_b16 a[180:181], v8 offset:18432
    ds_read_b64_tr_b16 a[182:183], v8 offset:19456
    v_mfma_f32_16x16x32_bf16 a[156:159], a[220:223], v[168:171], a[156:159]
    v_exp_f32 v147, v147
    v_smfmac_f32_16x16x64_bf16 v[252:255], v[132:135], v[168:175], v0
    ds_read_b64_tr_b16 a[184:185], v9 offset:18432
    v_cvt_pk_bf16_f32 v141, v146, v147
    v_mfma_f32_16x16x32_bf16 v[152:155], v[184:187], v[48:51], v[116:119]
    v_exp_f32 v148, v148
    v_mfma_f32_16x16x32_bf16 v[152:155], v[188:191], v[52:55], v[152:155]
    ds_read_b64_tr_b16 a[186:187], v9 offset:19456
    ds_read_b64_tr_b16 a[188:189], v9 offset:16384
    v_mfma_f32_16x16x32_bf16 v[152:155], v[192:195], v[56:59], v[152:155]
    v_exp_f32 v149, v149
    v_mfma_f32_16x16x32_bf16 v[152:155], v[196:199], v[60:63], v[152:155]
    ds_read_b64_tr_b16 a[190:191], v9 offset:17408
    v_cvt_pk_bf16_f32 v142, v148, v149
    v_mfma_f32_16x16x32_bf16 v[156:159], v[200:203], v[60:63], v[116:119]
    v_exp_f32 v150, v150
    v_mfma_f32_16x16x32_bf16 v[156:159], v[204:207], v[56:59], v[156:159]
    ds_read_b64_tr_b16 a[192:193], v10 offset:16384
    ds_read_b64_tr_b16 a[194:195], v10 offset:17408
    v_mfma_f32_16x16x32_bf16 v[156:159], v[208:211], v[52:55], v[156:159]
    v_exp_f32 v151, v151
    v_mfma_f32_16x16x32_bf16 v[156:159], v[212:215], v[48:51], v[156:159]
    ds_read_b64_tr_b16 a[196:197], v10 offset:18432
    v_cvt_pk_bf16_f32 v143, v150, v151
    v_mfma_f32_16x16x32_bf16 v[160:163], v[216:219], v[48:51], v[116:119]
    ds_read_b64_tr_b16 a[198:199], v10 offset:19456
    ds_read_b64_tr_b16 a[200:201], v11 offset:18432
    v_mfma_f32_16x16x32_bf16 v[160:163], v[220:223], v[52:55], v[160:163]
    v_exp_f32 v152, v152
    v_mfma_f32_16x16x32_bf16 v[160:163], v[224:227], v[56:59], v[160:163]
    ds_read_b64_tr_b16 a[202:203], v11 offset:19456
    ds_read_b64_tr_b16 a[204:205], v11 offset:16384
    v_mfma_f32_16x16x32_bf16 v[160:163], v[228:231], v[60:63], v[160:163]
    v_exp_f32 v153, v153
    v_mfma_f32_16x16x32_bf16 v[164:167], v[232:235], v[60:63], v[116:119]
    ds_read_b64_tr_b16 a[206:207], v11 offset:17408
    v_cvt_pk_bf16_f32 v152, v152, v153
    v_mfma_f32_16x16x32_bf16 v[164:167], v[236:239], v[56:59], v[164:167]
    v_exp_f32 v154, v154
    v_mfma_f32_16x16x32_bf16 v[164:167], v[240:243], v[52:55], v[164:167]
    ds_read_b64_tr_b16 a[208:209], v12 offset:16384
    ds_read_b64_tr_b16 a[210:211], v12 offset:17408
    v_mfma_f32_16x16x32_bf16 v[164:167], v[244:247], v[48:51], v[164:167]
    s_waitcnt lgkmcnt(7)
    v_exp_f32 v155, v155
    v_mfma_f32_16x16x32_bf16 a[0:3], a[160:163], v[136:139], a[0:3]
    ds_read_b64_tr_b16 a[212:213], v12 offset:18432
    v_cvt_pk_bf16_f32 v153, v154, v155
    v_mfma_f32_16x16x32_bf16 a[0:3], a[164:167], v[140:143], a[0:3]
    v_exp_f32 v156, v156
    v_mfma_f32_16x16x32_bf16 a[4:7], a[168:171], v[140:143], a[4:7]
    ds_read_b64_tr_b16 a[214:215], v12 offset:19456
    ds_read_b64_tr_b16 a[216:217], v13 offset:18432
    v_mfma_f32_16x16x32_bf16 a[4:7], a[172:175], v[136:139], a[4:7]
    v_exp_f32 v157, v157
    v_mfma_f32_16x16x32_bf16 a[8:11], a[176:179], v[136:139], a[8:11]
    ds_read_b64_tr_b16 a[218:219], v13 offset:19456
    v_cvt_pk_bf16_f32 v154, v156, v157
    v_mfma_f32_16x16x32_bf16 a[8:11], a[180:183], v[140:143], a[8:11]
    v_exp_f32 v158, v158
    v_mfma_f32_16x16x32_bf16 a[12:15], a[184:187], v[140:143], a[12:15]
    ds_read_b64_tr_b16 a[220:221], v13 offset:16384
    ds_read_b64_tr_b16 a[222:223], v13 offset:17408
    v_mfma_f32_16x16x32_bf16 a[12:15], a[188:191], v[136:139], a[12:15]
    v_exp_f32 v159, v159
    v_mfma_f32_16x16x32_bf16 a[16:19], a[192:195], v[136:139], a[16:19]
    s_waitcnt lgkmcnt(5)
    v_cvt_pk_bf16_f32 v155, v158, v159
    v_mfma_f32_16x16x32_bf16 a[16:19], a[196:199], v[140:143], a[16:19]
    v_exp_f32 v160, v160
    v_mfma_f32_16x16x32_bf16 a[20:23], a[200:203], v[140:143], a[20:23]
    v_mfma_f32_16x16x32_bf16 a[20:23], a[204:207], v[136:139], a[20:23]
    v_exp_f32 v161, v161
    v_mfma_f32_16x16x32_bf16 a[24:27], a[208:211], v[136:139], a[24:27]
    s_waitcnt lgkmcnt(2)
    v_cvt_pk_bf16_f32 v156, v160, v161
    v_mfma_f32_16x16x32_bf16 a[24:27], a[212:215], v[140:143], a[24:27]
    v_exp_f32 v162, v162
    v_mfma_f32_16x16x32_bf16 a[28:31], a[216:219], v[140:143], a[28:31]
    s_waitcnt lgkmcnt(0)
    v_mfma_f32_16x16x32_bf16 a[28:31], a[220:223], v[136:139], a[28:31]
    v_exp_f32 v163, v163
    v_smfmac_f32_16x16x64_bf16 v[20:23], v[132:135], v[136:143], v0
    v_cvt_pk_bf16_f32 v157, v162, v163
    v_mfma_f32_16x16x32_bf16 v[136:139], v[184:187], v[64:67], v[120:123]
    v_exp_f32 v164, v164
    v_mfma_f32_16x16x32_bf16 v[136:139], v[188:191], v[68:71], v[136:139]
    v_mfma_f32_16x16x32_bf16 v[136:139], v[192:195], v[72:75], v[136:139]
    v_exp_f32 v165, v165
    v_mfma_f32_16x16x32_bf16 v[136:139], v[196:199], v[76:79], v[136:139]
    v_cvt_pk_bf16_f32 v158, v164, v165
    v_mfma_f32_16x16x32_bf16 v[140:143], v[200:203], v[76:79], v[120:123]
    v_exp_f32 v166, v166
    v_mfma_f32_16x16x32_bf16 v[140:143], v[204:207], v[72:75], v[140:143]
    v_mfma_f32_16x16x32_bf16 v[140:143], v[208:211], v[68:71], v[140:143]
    v_exp_f32 v167, v167
    v_mfma_f32_16x16x32_bf16 v[140:143], v[212:215], v[64:67], v[140:143]
    v_cvt_pk_bf16_f32 v159, v166, v167
    v_mfma_f32_16x16x32_bf16 v[144:147], v[216:219], v[64:67], v[120:123]
    v_mfma_f32_16x16x32_bf16 v[144:147], v[220:223], v[68:71], v[144:147]
    v_exp_f32 v136, v136
    v_mfma_f32_16x16x32_bf16 v[144:147], v[224:227], v[72:75], v[144:147]
    v_mfma_f32_16x16x32_bf16 v[144:147], v[228:231], v[76:79], v[144:147]
    v_exp_f32 v137, v137
    v_mfma_f32_16x16x32_bf16 v[148:151], v[232:235], v[76:79], v[120:123]
    v_cvt_pk_bf16_f32 v136, v136, v137
    v_mfma_f32_16x16x32_bf16 v[148:151], v[236:239], v[72:75], v[148:151]
    v_exp_f32 v138, v138
    v_mfma_f32_16x16x32_bf16 v[148:151], v[240:243], v[68:71], v[148:151]
    v_mfma_f32_16x16x32_bf16 v[148:151], v[244:247], v[64:67], v[148:151]
    v_exp_f32 v139, v139
    v_mfma_f32_16x16x32_bf16 a[32:35], a[160:163], v[152:155], a[32:35]
    v_cvt_pk_bf16_f32 v137, v138, v139
    v_mfma_f32_16x16x32_bf16 a[32:35], a[164:167], v[156:159], a[32:35]
    v_exp_f32 v140, v140
    v_mfma_f32_16x16x32_bf16 a[36:39], a[168:171], v[156:159], a[36:39]
    v_mfma_f32_16x16x32_bf16 a[36:39], a[172:175], v[152:155], a[36:39]
    v_exp_f32 v141, v141
    v_mfma_f32_16x16x32_bf16 a[40:43], a[176:179], v[152:155], a[40:43]
    v_cvt_pk_bf16_f32 v138, v140, v141
    v_mfma_f32_16x16x32_bf16 a[40:43], a[180:183], v[156:159], a[40:43]
    v_exp_f32 v142, v142
    v_mfma_f32_16x16x32_bf16 a[44:47], a[184:187], v[156:159], a[44:47]
    v_mfma_f32_16x16x32_bf16 a[44:47], a[188:191], v[152:155], a[44:47]
    v_exp_f32 v143, v143
    v_mfma_f32_16x16x32_bf16 a[48:51], a[192:195], v[152:155], a[48:51]
    v_cvt_pk_bf16_f32 v139, v142, v143
    v_mfma_f32_16x16x32_bf16 a[48:51], a[196:199], v[156:159], a[48:51]
    v_exp_f32 v144, v144
    v_mfma_f32_16x16x32_bf16 a[52:55], a[200:203], v[156:159], a[52:55]
    v_mfma_f32_16x16x32_bf16 a[52:55], a[204:207], v[152:155], a[52:55]
    v_exp_f32 v145, v145
    v_mfma_f32_16x16x32_bf16 a[56:59], a[208:211], v[152:155], a[56:59]
    v_cvt_pk_bf16_f32 v140, v144, v145
    v_mfma_f32_16x16x32_bf16 a[56:59], a[212:215], v[156:159], a[56:59]
    v_exp_f32 v146, v146
    v_mfma_f32_16x16x32_bf16 a[60:63], a[216:219], v[156:159], a[60:63]
    v_mfma_f32_16x16x32_bf16 a[60:63], a[220:223], v[152:155], a[60:63]
    v_exp_f32 v147, v147
    v_smfmac_f32_16x16x64_bf16 v[24:27], v[132:135], v[152:159], v0
    v_cvt_pk_bf16_f32 v141, v146, v147
    v_mfma_f32_16x16x32_bf16 v[152:155], v[184:187], v[80:83], v[124:127]
    v_exp_f32 v148, v148
    v_mfma_f32_16x16x32_bf16 v[152:155], v[188:191], v[84:87], v[152:155]
    v_mfma_f32_16x16x32_bf16 v[152:155], v[192:195], v[88:91], v[152:155]
    v_exp_f32 v149, v149
    v_mfma_f32_16x16x32_bf16 v[152:155], v[196:199], v[92:95], v[152:155]
    v_cvt_pk_bf16_f32 v142, v148, v149
    v_mfma_f32_16x16x32_bf16 v[156:159], v[200:203], v[92:95], v[124:127]
    v_exp_f32 v150, v150
    v_mfma_f32_16x16x32_bf16 v[156:159], v[204:207], v[88:91], v[156:159]
    v_mfma_f32_16x16x32_bf16 v[156:159], v[208:211], v[84:87], v[156:159]
    v_exp_f32 v151, v151
    v_mfma_f32_16x16x32_bf16 v[156:159], v[212:215], v[80:83], v[156:159]
    v_cvt_pk_bf16_f32 v143, v150, v151
    v_mfma_f32_16x16x32_bf16 v[160:163], v[216:219], v[80:83], v[124:127]
    v_mfma_f32_16x16x32_bf16 v[160:163], v[220:223], v[84:87], v[160:163]
    v_exp_f32 v152, v152
    v_mfma_f32_16x16x32_bf16 v[160:163], v[224:227], v[88:91], v[160:163]
    v_mfma_f32_16x16x32_bf16 v[160:163], v[228:231], v[92:95], v[160:163]
    v_exp_f32 v153, v153
    v_mfma_f32_16x16x32_bf16 v[164:167], v[232:235], v[92:95], v[124:127]
    v_cvt_pk_bf16_f32 v152, v152, v153
    v_mfma_f32_16x16x32_bf16 v[164:167], v[236:239], v[88:91], v[164:167]
    v_exp_f32 v154, v154
    v_mfma_f32_16x16x32_bf16 v[164:167], v[240:243], v[84:87], v[164:167]
    v_mfma_f32_16x16x32_bf16 v[164:167], v[244:247], v[80:83], v[164:167]
    v_exp_f32 v155, v155
    v_mfma_f32_16x16x32_bf16 a[64:67], a[160:163], v[136:139], a[64:67]
    v_cvt_pk_bf16_f32 v153, v154, v155
    v_mfma_f32_16x16x32_bf16 a[64:67], a[164:167], v[140:143], a[64:67]
    v_exp_f32 v156, v156
    v_mfma_f32_16x16x32_bf16 a[68:71], a[168:171], v[140:143], a[68:71]
    v_mfma_f32_16x16x32_bf16 a[68:71], a[172:175], v[136:139], a[68:71]
    v_exp_f32 v157, v157
    v_mfma_f32_16x16x32_bf16 a[72:75], a[176:179], v[136:139], a[72:75]
    v_cvt_pk_bf16_f32 v154, v156, v157
    v_mfma_f32_16x16x32_bf16 a[72:75], a[180:183], v[140:143], a[72:75]
    v_exp_f32 v158, v158
    v_mfma_f32_16x16x32_bf16 a[76:79], a[184:187], v[140:143], a[76:79]
    v_mfma_f32_16x16x32_bf16 a[76:79], a[188:191], v[136:139], a[76:79]
    v_exp_f32 v159, v159
    v_mfma_f32_16x16x32_bf16 a[80:83], a[192:195], v[136:139], a[80:83]
    v_cvt_pk_bf16_f32 v155, v158, v159
    v_mfma_f32_16x16x32_bf16 a[80:83], a[196:199], v[140:143], a[80:83]
    s_waitcnt lgkmcnt(0)
    v_exp_f32 v160, v160
    v_mfma_f32_16x16x32_bf16 a[84:87], a[200:203], v[140:143], a[84:87]
    s_barrier
    v_mfma_f32_16x16x32_bf16 a[84:87], a[204:207], v[136:139], a[84:87]
    v_exp_f32 v161, v161
    v_mfma_f32_16x16x32_bf16 a[88:91], a[208:211], v[136:139], a[88:91]
    v_cvt_pk_bf16_f32 v156, v160, v161
    v_mfma_f32_16x16x32_bf16 a[88:91], a[212:215], v[140:143], a[88:91]
    v_exp_f32 v162, v162
    v_mfma_f32_16x16x32_bf16 a[92:95], a[216:219], v[140:143], a[92:95]
    v_mfma_f32_16x16x32_bf16 a[92:95], a[220:223], v[136:139], a[92:95]
    v_exp_f32 v163, v163
    v_smfmac_f32_16x16x64_bf16 v[28:31], v[132:135], v[136:143], v0
    v_cvt_pk_bf16_f32 v157, v162, v163
    v_mfma_f32_16x16x32_bf16 v[168:171], v[184:187], v[96:99], v[128:131]
    v_exp_f32 v164, v164
    v_mfma_f32_16x16x32_bf16 v[168:171], v[188:191], v[100:103], v[168:171]
    ds_read_b128 v[184:187], v2 offset:32768
    v_mfma_f32_16x16x32_bf16 v[168:171], v[192:195], v[104:107], v[168:171]
    v_exp_f32 v165, v165
    v_mfma_f32_16x16x32_bf16 v[168:171], v[196:199], v[108:111], v[168:171]
    ds_read_b128 v[188:191], v3 offset:32768
    v_cvt_pk_bf16_f32 v158, v164, v165
    v_mfma_f32_16x16x32_bf16 v[172:175], v[200:203], v[108:111], v[128:131]
    v_exp_f32 v166, v166
    v_mfma_f32_16x16x32_bf16 v[172:175], v[204:207], v[104:107], v[172:175]
    ds_read_b128 v[192:195], v4 offset:32768
    v_mfma_f32_16x16x32_bf16 v[172:175], v[208:211], v[100:103], v[172:175]
    v_exp_f32 v167, v167
    v_mfma_f32_16x16x32_bf16 v[172:175], v[212:215], v[96:99], v[172:175]
    ds_read_b128 v[196:199], v5 offset:32768
    v_cvt_pk_bf16_f32 v159, v166, v167
    v_mfma_f32_16x16x32_bf16 v[176:179], v[216:219], v[96:99], v[128:131]
    ds_read_b128 v[200:203], v5 offset:33792
    v_mfma_f32_16x16x32_bf16 v[176:179], v[220:223], v[100:103], v[176:179]
    v_exp_f32 v168, v168
    v_mfma_f32_16x16x32_bf16 v[176:179], v[224:227], v[104:107], v[176:179]
    ds_read_b128 v[204:207], v4 offset:33792
    v_mfma_f32_16x16x32_bf16 v[176:179], v[228:231], v[108:111], v[176:179]
    v_exp_f32 v169, v169
    v_mfma_f32_16x16x32_bf16 v[180:183], v[232:235], v[108:111], v[128:131]
    ds_read_b128 v[208:211], v3 offset:33792
    v_cvt_pk_bf16_f32 v168, v168, v169
    v_mfma_f32_16x16x32_bf16 v[180:183], v[236:239], v[104:107], v[180:183]
    v_exp_f32 v170, v170
    v_mfma_f32_16x16x32_bf16 v[180:183], v[240:243], v[100:103], v[180:183]
    ds_read_b128 v[212:215], v2 offset:33792
    v_mfma_f32_16x16x32_bf16 v[180:183], v[244:247], v[96:99], v[180:183]
    v_exp_f32 v171, v171
    v_mfma_f32_16x16x32_bf16 a[96:99], a[160:163], v[152:155], a[96:99]
    ds_read_b128 v[216:219], v2 offset:34816
    v_cvt_pk_bf16_f32 v169, v170, v171
    v_mfma_f32_16x16x32_bf16 a[96:99], a[164:167], v[156:159], a[96:99]
    v_exp_f32 v172, v172
    v_mfma_f32_16x16x32_bf16 a[100:103], a[168:171], v[156:159], a[100:103]
    ds_read_b128 v[220:223], v3 offset:34816
    v_mfma_f32_16x16x32_bf16 a[100:103], a[172:175], v[152:155], a[100:103]
    v_exp_f32 v173, v173
    v_mfma_f32_16x16x32_bf16 a[104:107], a[176:179], v[152:155], a[104:107]
    ds_read_b128 v[224:227], v4 offset:34816
    v_cvt_pk_bf16_f32 v170, v172, v173
    v_mfma_f32_16x16x32_bf16 a[104:107], a[180:183], v[156:159], a[104:107]
    v_exp_f32 v174, v174
    v_mfma_f32_16x16x32_bf16 a[108:111], a[184:187], v[156:159], a[108:111]
    ds_read_b128 v[228:231], v5 offset:34816
    v_mfma_f32_16x16x32_bf16 a[108:111], a[188:191], v[152:155], a[108:111]
    v_exp_f32 v175, v175
    v_mfma_f32_16x16x32_bf16 a[112:115], a[192:195], v[152:155], a[112:115]
    ds_read_b128 v[232:235], v5 offset:35840
    v_cvt_pk_bf16_f32 v171, v174, v175
    v_mfma_f32_16x16x32_bf16 a[112:115], a[196:199], v[156:159], a[112:115]
    v_exp_f32 v176, v176
    v_mfma_f32_16x16x32_bf16 a[116:119], a[200:203], v[156:159], a[116:119]
    ds_read_b128 v[236:239], v4 offset:35840
    v_mfma_f32_16x16x32_bf16 a[116:119], a[204:207], v[152:155], a[116:119]
    v_exp_f32 v177, v177
    v_mfma_f32_16x16x32_bf16 a[120:123], a[208:211], v[152:155], a[120:123]
    ds_read_b128 v[240:243], v3 offset:35840
    v_cvt_pk_bf16_f32 v172, v176, v177
    v_mfma_f32_16x16x32_bf16 a[120:123], a[212:215], v[156:159], a[120:123]
    v_exp_f32 v178, v178
    v_mfma_f32_16x16x32_bf16 a[124:127], a[216:219], v[156:159], a[124:127]
    ds_read_b128 v[244:247], v2 offset:35840
    v_mfma_f32_16x16x32_bf16 a[124:127], a[220:223], v[152:155], a[124:127]
    v_exp_f32 v179, v179
    v_smfmac_f32_16x16x64_bf16 v[248:251], v[132:135], v[152:159], v0
    s_waitcnt lgkmcnt(3)
    v_cvt_pk_bf16_f32 v173, v178, v179
    v_mfma_f32_16x16x32_bf16 v[136:139], v[184:187], v[32:35], v[112:115]
    v_exp_f32 v180, v180
    v_mfma_f32_16x16x32_bf16 v[136:139], v[188:191], v[36:39], v[136:139]
    v_mfma_f32_16x16x32_bf16 v[136:139], v[192:195], v[40:43], v[136:139]
    v_exp_f32 v181, v181
    v_mfma_f32_16x16x32_bf16 v[136:139], v[196:199], v[44:47], v[136:139]
    v_cvt_pk_bf16_f32 v174, v180, v181
    v_mfma_f32_16x16x32_bf16 v[140:143], v[200:203], v[44:47], v[112:115]
    s_add_u32 s37, s37, 1
    v_exp_f32 v182, v182
    v_mfma_f32_16x16x32_bf16 v[140:143], v[204:207], v[40:43], v[140:143]
    v_mfma_f32_16x16x32_bf16 v[140:143], v[208:211], v[36:39], v[140:143]
    v_exp_f32 v183, v183
    v_mfma_f32_16x16x32_bf16 v[140:143], v[212:215], v[32:35], v[140:143]
    v_cvt_pk_bf16_f32 v175, v182, v183
L_loop5_2:
    v_mfma_f32_16x16x32_bf16 v[144:147], v[216:219], v[32:35], v[112:115]
    s_waitcnt lgkmcnt(0)
    v_mfma_f32_16x16x32_bf16 v[144:147], v[220:223], v[36:39], v[144:147]
    v_exp_f32 v136, v136
    v_mfma_f32_16x16x32_bf16 v[144:147], v[224:227], v[40:43], v[144:147]
    v_mfma_f32_16x16x32_bf16 v[144:147], v[228:231], v[44:47], v[144:147]
    v_exp_f32 v137, v137
    v_mfma_f32_16x16x32_bf16 v[148:151], v[232:235], v[44:47], v[112:115]
    v_cvt_pk_bf16_f32 v136, v136, v137
    v_mfma_f32_16x16x32_bf16 v[148:151], v[236:239], v[40:43], v[148:151]
    v_exp_f32 v138, v138
    v_mfma_f32_16x16x32_bf16 v[148:151], v[240:243], v[36:39], v[148:151]
    v_mfma_f32_16x16x32_bf16 v[148:151], v[244:247], v[32:35], v[148:151]
    v_exp_f32 v139, v139
    v_mfma_f32_16x16x32_bf16 a[128:131], a[160:163], v[168:171], a[128:131]
    ds_read_b64_tr_b16 a[160:161], v6 offset:32768
    v_cvt_pk_bf16_f32 v137, v138, v139
    v_mfma_f32_16x16x32_bf16 a[128:131], a[164:167], v[172:175], a[128:131]
    v_exp_f32 v140, v140
    v_mfma_f32_16x16x32_bf16 a[132:135], a[168:171], v[172:175], a[132:135]
    ds_read_b64_tr_b16 a[162:163], v6 offset:33792
    ds_read_b64_tr_b16 a[164:165], v6 offset:34816
    v_mfma_f32_16x16x32_bf16 a[132:135], a[172:175], v[168:171], a[132:135]
    v_exp_f32 v141, v141
    v_mfma_f32_16x16x32_bf16 a[136:139], a[176:179], v[168:171], a[136:139]
    ds_read_b64_tr_b16 a[166:167], v6 offset:35840
    v_cvt_pk_bf16_f32 v138, v140, v141
    v_mfma_f32_16x16x32_bf16 a[136:139], a[180:183], v[172:175], a[136:139]
    v_exp_f32 v142, v142
    v_mfma_f32_16x16x32_bf16 a[140:143], a[184:187], v[172:175], a[140:143]
    ds_read_b64_tr_b16 a[168:169], v7 offset:34816
    ds_read_b64_tr_b16 a[170:171], v7 offset:35840
    v_mfma_f32_16x16x32_bf16 a[140:143], a[188:191], v[168:171], a[140:143]
    v_exp_f32 v143, v143
    v_mfma_f32_16x16x32_bf16 a[144:147], a[192:195], v[168:171], a[144:147]
    ds_read_b64_tr_b16 a[172:173], v7 offset:32768
    v_cvt_pk_bf16_f32 v139, v142, v143
    v_mfma_f32_16x16x32_bf16 a[144:147], a[196:199], v[172:175], a[144:147]
    v_exp_f32 v144, v144
    v_mfma_f32_16x16x32_bf16 a[148:151], a[200:203], v[172:175], a[148:151]
    ds_read_b64_tr_b16 a[174:175], v7 offset:33792
    ds_read_b64_tr_b16 a[176:177], v8 offset:32768
    v_mfma_f32_16x16x32_bf16 a[148:151], a[204:207], v[168:171], a[148:151]
    v_exp_f32 v145, v145
    v_mfma_f32_16x16x32_bf16 a[152:155], a[208:211], v[168:171], a[152:155]
    ds_read_b64_tr_b16 a[178:179], v8 offset:33792
    v_cvt_pk_bf16_f32 v140, v144, v145
    v_mfma_f32_16x16x32_bf16 a[152:155], a[212:215], v[172:175], a[152:155]
    v_exp_f32 v146, v146
    v_mfma_f32_16x16x32_bf16 a[156:159], a[216:219], v[172:175], a[156:159]
    ds_read_b64_tr_b16 a[180:181], v8 offset:34816
    ds_read_b64_tr_b16 a[182:183], v8 offset:35840
    v_mfma_f32_16x16x32_bf16 a[156:159], a[220:223], v[168:171], a[156:159]
    v_exp_f32 v147, v147
    v_smfmac_f32_16x16x64_bf16 v[252:255], v[132:135], v[168:175], v0
    ds_read_b64_tr_b16 a[184:185], v9 offset:34816
    v_cvt_pk_bf16_f32 v141, v146, v147
    v_mfma_f32_16x16x32_bf16 v[152:155], v[184:187], v[48:51], v[116:119]
    v_exp_f32 v148, v148
    v_mfma_f32_16x16x32_bf16 v[152:155], v[188:191], v[52:55], v[152:155]
    ds_read_b64_tr_b16 a[186:187], v9 offset:35840
    ds_read_b64_tr_b16 a[188:189], v9 offset:32768
    v_mfma_f32_16x16x32_bf16 v[152:155], v[192:195], v[56:59], v[152:155]
    v_exp_f32 v149, v149
    v_mfma_f32_16x16x32_bf16 v[152:155], v[196:199], v[60:63], v[152:155]
    ds_read_b64_tr_b16 a[190:191], v9 offset:33792
    v_cvt_pk_bf16_f32 v142, v148, v149
    v_mfma_f32_16x16x32_bf16 v[156:159], v[200:203], v[60:63], v[116:119]
    v_exp_f32 v150, v150
    v_mfma_f32_16x16x32_bf16 v[156:159], v[204:207], v[56:59], v[156:159]
    ds_read_b64_tr_b16 a[192:193], v10 offset:32768
    ds_read_b64_tr_b16 a[194:195], v10 offset:33792
    v_mfma_f32_16x16x32_bf16 v[156:159], v[208:211], v[52:55], v[156:159]
    v_exp_f32 v151, v151
    v_mfma_f32_16x16x32_bf16 v[156:159], v[212:215], v[48:51], v[156:159]
    ds_read_b64_tr_b16 a[196:197], v10 offset:34816
    v_cvt_pk_bf16_f32 v143, v150, v151
    v_mfma_f32_16x16x32_bf16 v[160:163], v[216:219], v[48:51], v[116:119]
    ds_read_b64_tr_b16 a[198:199], v10 offset:35840
    ds_read_b64_tr_b16 a[200:201], v11 offset:34816
    v_mfma_f32_16x16x32_bf16 v[160:163], v[220:223], v[52:55], v[160:163]
    v_exp_f32 v152, v152
    v_mfma_f32_16x16x32_bf16 v[160:163], v[224:227], v[56:59], v[160:163]
    ds_read_b64_tr_b16 a[202:203], v11 offset:35840
    ds_read_b64_tr_b16 a[204:205], v11 offset:32768
    v_mfma_f32_16x16x32_bf16 v[160:163], v[228:231], v[60:63], v[160:163]
    v_exp_f32 v153, v153
    v_mfma_f32_16x16x32_bf16 v[164:167], v[232:235], v[60:63], v[116:119]
    ds_read_b64_tr_b16 a[206:207], v11 offset:33792
    v_cvt_pk_bf16_f32 v152, v152, v153
    v_mfma_f32_16x16x32_bf16 v[164:167], v[236:239], v[56:59], v[164:167]
    v_exp_f32 v154, v154
    v_mfma_f32_16x16x32_bf16 v[164:167], v[240:243], v[52:55], v[164:167]
    ds_read_b64_tr_b16 a[208:209], v12 offset:32768
    ds_read_b64_tr_b16 a[210:211], v12 offset:33792
    v_mfma_f32_16x16x32_bf16 v[164:167], v[244:247], v[48:51], v[164:167]
    s_waitcnt lgkmcnt(7)
    v_exp_f32 v155, v155
    v_mfma_f32_16x16x32_bf16 a[0:3], a[160:163], v[136:139], a[0:3]
    ds_read_b64_tr_b16 a[212:213], v12 offset:34816
    v_cvt_pk_bf16_f32 v153, v154, v155
    v_mfma_f32_16x16x32_bf16 a[0:3], a[164:167], v[140:143], a[0:3]
    v_exp_f32 v156, v156
    v_mfma_f32_16x16x32_bf16 a[4:7], a[168:171], v[140:143], a[4:7]
    ds_read_b64_tr_b16 a[214:215], v12 offset:35840
    ds_read_b64_tr_b16 a[216:217], v13 offset:34816
    v_mfma_f32_16x16x32_bf16 a[4:7], a[172:175], v[136:139], a[4:7]
    v_exp_f32 v157, v157
    v_mfma_f32_16x16x32_bf16 a[8:11], a[176:179], v[136:139], a[8:11]
    ds_read_b64_tr_b16 a[218:219], v13 offset:35840
    v_cvt_pk_bf16_f32 v154, v156, v157
    v_mfma_f32_16x16x32_bf16 a[8:11], a[180:183], v[140:143], a[8:11]
    v_exp_f32 v158, v158
    v_mfma_f32_16x16x32_bf16 a[12:15], a[184:187], v[140:143], a[12:15]
    ds_read_b64_tr_b16 a[220:221], v13 offset:32768
    ds_read_b64_tr_b16 a[222:223], v13 offset:33792
    v_mfma_f32_16x16x32_bf16 a[12:15], a[188:191], v[136:139], a[12:15]
    v_exp_f32 v159, v159
    v_mfma_f32_16x16x32_bf16 a[16:19], a[192:195], v[136:139], a[16:19]
    s_waitcnt lgkmcnt(5)
    v_cvt_pk_bf16_f32 v155, v158, v159
    v_mfma_f32_16x16x32_bf16 a[16:19], a[196:199], v[140:143], a[16:19]
    v_exp_f32 v160, v160
    v_mfma_f32_16x16x32_bf16 a[20:23], a[200:203], v[140:143], a[20:23]
    v_mfma_f32_16x16x32_bf16 a[20:23], a[204:207], v[136:139], a[20:23]
    v_exp_f32 v161, v161
    v_mfma_f32_16x16x32_bf16 a[24:27], a[208:211], v[136:139], a[24:27]
    s_waitcnt lgkmcnt(2)
    v_cvt_pk_bf16_f32 v156, v160, v161
    v_mfma_f32_16x16x32_bf16 a[24:27], a[212:215], v[140:143], a[24:27]
    v_exp_f32 v162, v162
    v_mfma_f32_16x16x32_bf16 a[28:31], a[216:219], v[140:143], a[28:31]
    s_waitcnt lgkmcnt(0)
    v_mfma_f32_16x16x32_bf16 a[28:31], a[220:223], v[136:139], a[28:31]
    v_exp_f32 v163, v163
    v_smfmac_f32_16x16x64_bf16 v[20:23], v[132:135], v[136:143], v0
    v_cvt_pk_bf16_f32 v157, v162, v163
    v_mfma_f32_16x16x32_bf16 v[136:139], v[184:187], v[64:67], v[120:123]
    v_exp_f32 v164, v164
    v_mfma_f32_16x16x32_bf16 v[136:139], v[188:191], v[68:71], v[136:139]
    v_mfma_f32_16x16x32_bf16 v[136:139], v[192:195], v[72:75], v[136:139]
    v_exp_f32 v165, v165
    v_mfma_f32_16x16x32_bf16 v[136:139], v[196:199], v[76:79], v[136:139]
    v_cvt_pk_bf16_f32 v158, v164, v165
    v_mfma_f32_16x16x32_bf16 v[140:143], v[200:203], v[76:79], v[120:123]
    v_exp_f32 v166, v166
    v_mfma_f32_16x16x32_bf16 v[140:143], v[204:207], v[72:75], v[140:143]
    v_mfma_f32_16x16x32_bf16 v[140:143], v[208:211], v[68:71], v[140:143]
    v_exp_f32 v167, v167
    v_mfma_f32_16x16x32_bf16 v[140:143], v[212:215], v[64:67], v[140:143]
    v_cvt_pk_bf16_f32 v159, v166, v167
    v_mfma_f32_16x16x32_bf16 v[144:147], v[216:219], v[64:67], v[120:123]
    v_mfma_f32_16x16x32_bf16 v[144:147], v[220:223], v[68:71], v[144:147]
    v_exp_f32 v136, v136
    v_mfma_f32_16x16x32_bf16 v[144:147], v[224:227], v[72:75], v[144:147]
    v_mfma_f32_16x16x32_bf16 v[144:147], v[228:231], v[76:79], v[144:147]
    v_exp_f32 v137, v137
    v_mfma_f32_16x16x32_bf16 v[148:151], v[232:235], v[76:79], v[120:123]
    v_cvt_pk_bf16_f32 v136, v136, v137
    v_mfma_f32_16x16x32_bf16 v[148:151], v[236:239], v[72:75], v[148:151]
    v_exp_f32 v138, v138
    v_mfma_f32_16x16x32_bf16 v[148:151], v[240:243], v[68:71], v[148:151]
    v_mfma_f32_16x16x32_bf16 v[148:151], v[244:247], v[64:67], v[148:151]
    v_exp_f32 v139, v139
    v_mfma_f32_16x16x32_bf16 a[32:35], a[160:163], v[152:155], a[32:35]
    v_cvt_pk_bf16_f32 v137, v138, v139
    v_mfma_f32_16x16x32_bf16 a[32:35], a[164:167], v[156:159], a[32:35]
    v_exp_f32 v140, v140
    v_mfma_f32_16x16x32_bf16 a[36:39], a[168:171], v[156:159], a[36:39]
    v_mfma_f32_16x16x32_bf16 a[36:39], a[172:175], v[152:155], a[36:39]
    v_exp_f32 v141, v141
    v_mfma_f32_16x16x32_bf16 a[40:43], a[176:179], v[152:155], a[40:43]
    v_cvt_pk_bf16_f32 v138, v140, v141
    v_mfma_f32_16x16x32_bf16 a[40:43], a[180:183], v[156:159], a[40:43]
    v_exp_f32 v142, v142
    v_mfma_f32_16x16x32_bf16 a[44:47], a[184:187], v[156:159], a[44:47]
    v_mfma_f32_16x16x32_bf16 a[44:47], a[188:191], v[152:155], a[44:47]
    v_exp_f32 v143, v143
    v_mfma_f32_16x16x32_bf16 a[48:51], a[192:195], v[152:155], a[48:51]
    v_cvt_pk_bf16_f32 v139, v142, v143
    v_mfma_f32_16x16x32_bf16 a[48:51], a[196:199], v[156:159], a[48:51]
    v_exp_f32 v144, v144
    v_mfma_f32_16x16x32_bf16 a[52:55], a[200:203], v[156:159], a[52:55]
    v_mfma_f32_16x16x32_bf16 a[52:55], a[204:207], v[152:155], a[52:55]
    v_exp_f32 v145, v145
    v_mfma_f32_16x16x32_bf16 a[56:59], a[208:211], v[152:155], a[56:59]
    v_cvt_pk_bf16_f32 v140, v144, v145
    v_mfma_f32_16x16x32_bf16 a[56:59], a[212:215], v[156:159], a[56:59]
    v_exp_f32 v146, v146
    v_mfma_f32_16x16x32_bf16 a[60:63], a[216:219], v[156:159], a[60:63]
    v_mfma_f32_16x16x32_bf16 a[60:63], a[220:223], v[152:155], a[60:63]
    v_exp_f32 v147, v147
    v_smfmac_f32_16x16x64_bf16 v[24:27], v[132:135], v[152:159], v0
    v_cvt_pk_bf16_f32 v141, v146, v147
    v_mfma_f32_16x16x32_bf16 v[152:155], v[184:187], v[80:83], v[124:127]
    v_exp_f32 v148, v148
    v_mfma_f32_16x16x32_bf16 v[152:155], v[188:191], v[84:87], v[152:155]
    v_mfma_f32_16x16x32_bf16 v[152:155], v[192:195], v[88:91], v[152:155]
    v_exp_f32 v149, v149
    v_mfma_f32_16x16x32_bf16 v[152:155], v[196:199], v[92:95], v[152:155]
    v_cvt_pk_bf16_f32 v142, v148, v149
    v_mfma_f32_16x16x32_bf16 v[156:159], v[200:203], v[92:95], v[124:127]
    v_exp_f32 v150, v150
    v_mfma_f32_16x16x32_bf16 v[156:159], v[204:207], v[88:91], v[156:159]
    v_mfma_f32_16x16x32_bf16 v[156:159], v[208:211], v[84:87], v[156:159]
    v_exp_f32 v151, v151
    v_mfma_f32_16x16x32_bf16 v[156:159], v[212:215], v[80:83], v[156:159]
    v_cvt_pk_bf16_f32 v143, v150, v151
    v_mfma_f32_16x16x32_bf16 v[160:163], v[216:219], v[80:83], v[124:127]
    v_mfma_f32_16x16x32_bf16 v[160:163], v[220:223], v[84:87], v[160:163]
    v_exp_f32 v152, v152
    v_mfma_f32_16x16x32_bf16 v[160:163], v[224:227], v[88:91], v[160:163]
    v_mfma_f32_16x16x32_bf16 v[160:163], v[228:231], v[92:95], v[160:163]
    v_exp_f32 v153, v153
    v_mfma_f32_16x16x32_bf16 v[164:167], v[232:235], v[92:95], v[124:127]
    v_cvt_pk_bf16_f32 v152, v152, v153
    v_mfma_f32_16x16x32_bf16 v[164:167], v[236:239], v[88:91], v[164:167]
    v_exp_f32 v154, v154
    v_mfma_f32_16x16x32_bf16 v[164:167], v[240:243], v[84:87], v[164:167]
    v_mfma_f32_16x16x32_bf16 v[164:167], v[244:247], v[80:83], v[164:167]
    v_exp_f32 v155, v155
    v_mfma_f32_16x16x32_bf16 a[64:67], a[160:163], v[136:139], a[64:67]
    v_cvt_pk_bf16_f32 v153, v154, v155
    v_mfma_f32_16x16x32_bf16 a[64:67], a[164:167], v[140:143], a[64:67]
    v_exp_f32 v156, v156
    v_mfma_f32_16x16x32_bf16 a[68:71], a[168:171], v[140:143], a[68:71]
    v_mfma_f32_16x16x32_bf16 a[68:71], a[172:175], v[136:139], a[68:71]
    v_exp_f32 v157, v157
    v_mfma_f32_16x16x32_bf16 a[72:75], a[176:179], v[136:139], a[72:75]
    v_cvt_pk_bf16_f32 v154, v156, v157
    v_mfma_f32_16x16x32_bf16 a[72:75], a[180:183], v[140:143], a[72:75]
    v_exp_f32 v158, v158
    v_mfma_f32_16x16x32_bf16 a[76:79], a[184:187], v[140:143], a[76:79]
    v_mfma_f32_16x16x32_bf16 a[76:79], a[188:191], v[136:139], a[76:79]
    v_exp_f32 v159, v159
    v_mfma_f32_16x16x32_bf16 a[80:83], a[192:195], v[136:139], a[80:83]
    v_cvt_pk_bf16_f32 v155, v158, v159
    v_mfma_f32_16x16x32_bf16 a[80:83], a[196:199], v[140:143], a[80:83]
    s_waitcnt lgkmcnt(0)
    v_exp_f32 v160, v160
    v_mfma_f32_16x16x32_bf16 a[84:87], a[200:203], v[140:143], a[84:87]
    s_barrier
    v_mfma_f32_16x16x32_bf16 a[84:87], a[204:207], v[136:139], a[84:87]
    v_exp_f32 v161, v161
    v_mfma_f32_16x16x32_bf16 a[88:91], a[208:211], v[136:139], a[88:91]
    v_cvt_pk_bf16_f32 v156, v160, v161
    v_mfma_f32_16x16x32_bf16 a[88:91], a[212:215], v[140:143], a[88:91]
    v_exp_f32 v162, v162
    v_mfma_f32_16x16x32_bf16 a[92:95], a[216:219], v[140:143], a[92:95]
    v_mfma_f32_16x16x32_bf16 a[92:95], a[220:223], v[136:139], a[92:95]
    v_exp_f32 v163, v163
    v_smfmac_f32_16x16x64_bf16 v[28:31], v[132:135], v[136:143], v0
    v_cvt_pk_bf16_f32 v157, v162, v163
    v_mfma_f32_16x16x32_bf16 v[168:171], v[184:187], v[96:99], v[128:131]
    v_exp_f32 v164, v164
    v_mfma_f32_16x16x32_bf16 v[168:171], v[188:191], v[100:103], v[168:171]
    ds_read_b128 v[184:187], v2
    v_mfma_f32_16x16x32_bf16 v[168:171], v[192:195], v[104:107], v[168:171]
    v_exp_f32 v165, v165
    v_mfma_f32_16x16x32_bf16 v[168:171], v[196:199], v[108:111], v[168:171]
    ds_read_b128 v[188:191], v3
    v_cvt_pk_bf16_f32 v158, v164, v165
    v_mfma_f32_16x16x32_bf16 v[172:175], v[200:203], v[108:111], v[128:131]
    v_exp_f32 v166, v166
    v_mfma_f32_16x16x32_bf16 v[172:175], v[204:207], v[104:107], v[172:175]
    ds_read_b128 v[192:195], v4
    v_mfma_f32_16x16x32_bf16 v[172:175], v[208:211], v[100:103], v[172:175]
    v_exp_f32 v167, v167
    v_mfma_f32_16x16x32_bf16 v[172:175], v[212:215], v[96:99], v[172:175]
    ds_read_b128 v[196:199], v5
    v_cvt_pk_bf16_f32 v159, v166, v167
    v_mfma_f32_16x16x32_bf16 v[176:179], v[216:219], v[96:99], v[128:131]
    ds_read_b128 v[200:203], v5 offset:1024
    v_mfma_f32_16x16x32_bf16 v[176:179], v[220:223], v[100:103], v[176:179]
    v_exp_f32 v168, v168
    v_mfma_f32_16x16x32_bf16 v[176:179], v[224:227], v[104:107], v[176:179]
    ds_read_b128 v[204:207], v4 offset:1024
    v_mfma_f32_16x16x32_bf16 v[176:179], v[228:231], v[108:111], v[176:179]
    v_exp_f32 v169, v169
    v_mfma_f32_16x16x32_bf16 v[180:183], v[232:235], v[108:111], v[128:131]
    ds_read_b128 v[208:211], v3 offset:1024
    v_cvt_pk_bf16_f32 v168, v168, v169
    v_mfma_f32_16x16x32_bf16 v[180:183], v[236:239], v[104:107], v[180:183]
    v_exp_f32 v170, v170
    v_mfma_f32_16x16x32_bf16 v[180:183], v[240:243], v[100:103], v[180:183]
    ds_read_b128 v[212:215], v2 offset:1024
    v_mfma_f32_16x16x32_bf16 v[180:183], v[244:247], v[96:99], v[180:183]
    v_exp_f32 v171, v171
    v_mfma_f32_16x16x32_bf16 a[96:99], a[160:163], v[152:155], a[96:99]
    ds_read_b128 v[216:219], v2 offset:2048
    v_cvt_pk_bf16_f32 v169, v170, v171
    v_mfma_f32_16x16x32_bf16 a[96:99], a[164:167], v[156:159], a[96:99]
    v_exp_f32 v172, v172
    v_mfma_f32_16x16x32_bf16 a[100:103], a[168:171], v[156:159], a[100:103]
    ds_read_b128 v[220:223], v3 offset:2048
    v_mfma_f32_16x16x32_bf16 a[100:103], a[172:175], v[152:155], a[100:103]
    v_exp_f32 v173, v173
    v_mfma_f32_16x16x32_bf16 a[104:107], a[176:179], v[152:155], a[104:107]
    ds_read_b128 v[224:227], v4 offset:2048
    v_cvt_pk_bf16_f32 v170, v172, v173
    v_mfma_f32_16x16x32_bf16 a[104:107], a[180:183], v[156:159], a[104:107]
    v_exp_f32 v174, v174
    v_mfma_f32_16x16x32_bf16 a[108:111], a[184:187], v[156:159], a[108:111]
    ds_read_b128 v[228:231], v5 offset:2048
    v_mfma_f32_16x16x32_bf16 a[108:111], a[188:191], v[152:155], a[108:111]
    v_exp_f32 v175, v175
    v_mfma_f32_16x16x32_bf16 a[112:115], a[192:195], v[152:155], a[112:115]
    ds_read_b128 v[232:235], v5 offset:3072
    v_cvt_pk_bf16_f32 v171, v174, v175
    v_mfma_f32_16x16x32_bf16 a[112:115], a[196:199], v[156:159], a[112:115]
    v_exp_f32 v176, v176
    v_mfma_f32_16x16x32_bf16 a[116:119], a[200:203], v[156:159], a[116:119]
    ds_read_b128 v[236:239], v4 offset:3072
    v_mfma_f32_16x16x32_bf16 a[116:119], a[204:207], v[152:155], a[116:119]
    v_exp_f32 v177, v177
    v_mfma_f32_16x16x32_bf16 a[120:123], a[208:211], v[152:155], a[120:123]
    ds_read_b128 v[240:243], v3 offset:3072
    v_cvt_pk_bf16_f32 v172, v176, v177
    v_mfma_f32_16x16x32_bf16 a[120:123], a[212:215], v[156:159], a[120:123]
    v_exp_f32 v178, v178
    v_mfma_f32_16x16x32_bf16 a[124:127], a[216:219], v[156:159], a[124:127]
    ds_read_b128 v[244:247], v2 offset:3072
    v_mfma_f32_16x16x32_bf16 a[124:127], a[220:223], v[152:155], a[124:127]
    v_exp_f32 v179, v179
    v_smfmac_f32_16x16x64_bf16 v[248:251], v[132:135], v[152:159], v0
    s_waitcnt lgkmcnt(3)
    v_cvt_pk_bf16_f32 v173, v178, v179
    v_mfma_f32_16x16x32_bf16 v[136:139], v[184:187], v[32:35], v[112:115]
    v_exp_f32 v180, v180
    v_mfma_f32_16x16x32_bf16 v[136:139], v[188:191], v[36:39], v[136:139]
    v_mfma_f32_16x16x32_bf16 v[136:139], v[192:195], v[40:43], v[136:139]
    v_exp_f32 v181, v181
    v_mfma_f32_16x16x32_bf16 v[136:139], v[196:199], v[44:47], v[136:139]
    v_cvt_pk_bf16_f32 v174, v180, v181
    v_mfma_f32_16x16x32_bf16 v[140:143], v[200:203], v[44:47], v[112:115]
    s_add_u32 s37, s37, 1
    v_exp_f32 v182, v182
    v_mfma_f32_16x16x32_bf16 v[140:143], v[204:207], v[40:43], v[140:143]
    v_mfma_f32_16x16x32_bf16 v[140:143], v[208:211], v[36:39], v[140:143]
    v_exp_f32 v183, v183
    v_mfma_f32_16x16x32_bf16 v[140:143], v[212:215], v[32:35], v[140:143]
    v_cvt_pk_bf16_f32 v175, v182, v183
    s_branch L_loop5_0
L_last5:
    s_waitcnt lgkmcnt(0)
    v_mfma_f32_16x16x32_bf16 v[144:147], v[216:219], v[32:35], v[112:115]
    s_add_u32 s55, s36, 65536
    v_mfma_f32_16x16x32_bf16 v[144:147], v[220:223], v[36:39], v[144:147]
    buffer_store_dwordx4 a[240:243], v18, s[20:23], s55 offen sc1 nt
    v_exp_f32 v136, v136
    v_mfma_f32_16x16x32_bf16 v[144:147], v[224:227], v[40:43], v[144:147]
    buffer_store_dwordx4 a[244:247], v18, s[20:23], s55 offen offset:1024 sc1 nt
    v_mfma_f32_16x16x32_bf16 v[144:147], v[228:231], v[44:47], v[144:147]
    buffer_store_dwordx4 a[248:251], v18, s[20:23], s55 offen offset:2048 sc1 nt
    v_exp_f32 v137, v137
    v_mfma_f32_16x16x32_bf16 v[148:151], v[232:235], v[44:47], v[112:115]
    buffer_store_dwordx4 a[252:255], v18, s[20:23], s55 offen offset:3072 sc1 nt
    v_cvt_pk_bf16_f32 v136, v136, v137
    v_mfma_f32_16x16x32_bf16 v[148:151], v[236:239], v[40:43], v[148:151]
    s_add_u32 s20, s20, 77824
    v_exp_f32 v138, v138
    v_mfma_f32_16x16x32_bf16 v[148:151], v[240:243], v[36:39], v[148:151]
    s_addc_u32 s21, s21, 0
    v_mfma_f32_16x16x32_bf16 v[148:151], v[244:247], v[32:35], v[148:151]
    s_lshl_b32 s40, s47, 14
    v_exp_f32 v139, v139
    v_mfma_f32_16x16x32_bf16 a[128:131], a[160:163], v[168:171], a[128:131]
    s_add_u32 s41, s40, 4096
    ds_read_b64_tr_b16 a[160:161], v6 offset:16384
    v_cvt_pk_bf16_f32 v137, v138, v139
    v_mfma_f32_16x16x32_bf16 a[128:131], a[164:167], v[172:175], a[128:131]
    s_add_u32 s42, s40, 8192
    v_exp_f32 v140, v140
    v_mfma_f32_16x16x32_bf16 a[132:135], a[168:171], v[172:175], a[132:135]
    s_add_u32 s43, s40, 12288
    ds_read_b64_tr_b16 a[162:163], v6 offset:17408
    ds_read_b64_tr_b16 a[164:165], v6 offset:18432
    v_mfma_f32_16x16x32_bf16 a[132:135], a[172:175], v[168:171], a[132:135]
    s_mov_b64 s[56:57], 0
    v_exp_f32 v141, v141
    v_mfma_f32_16x16x32_bf16 a[136:139], a[176:179], v[168:171], a[136:139]
    s_and_b32 s54, s47, 1
    ds_read_b64_tr_b16 a[166:167], v6 offset:19456
    v_cvt_pk_bf16_f32 v138, v140, v141
    v_mfma_f32_16x16x32_bf16 a[136:139], a[180:183], v[172:175], a[136:139]
    s_lshl_b32 s54, s54, 15
    v_exp_f32 v142, v142
    v_mfma_f32_16x16x32_bf16 a[140:143], a[184:187], v[172:175], a[140:143]
    s_lshr_b32 s52, s47, 1
    ds_read_b64_tr_b16 a[168:169], v7 offset:18432
    ds_read_b64_tr_b16 a[170:171], v7 offset:19456
    v_mfma_f32_16x16x32_bf16 a[140:143], a[188:191], v[168:171], a[140:143]
    s_mul_i32 s52, s52, 49152
    v_exp_f32 v143, v143
    v_mfma_f32_16x16x32_bf16 a[144:147], a[192:195], v[168:171], a[144:147]
    s_add_u32 s54, s54, s52
    ds_read_b64_tr_b16 a[172:173], v7 offset:16384
    v_cvt_pk_bf16_f32 v139, v142, v143
    v_mfma_f32_16x16x32_bf16 a[144:147], a[196:199], v[172:175], a[144:147]
    s_mov_b32 s52, 98288
    v_exp_f32 v144, v144
    v_mfma_f32_16x16x32_bf16 a[148:151], a[200:203], v[172:175], a[148:151]
    ds_read_b64_tr_b16 a[174:175], v7 offset:17408
    ds_read_b64_tr_b16 a[176:177], v8 offset:16384
    v_mfma_f32_16x16x32_bf16 a[148:151], a[204:207], v[168:171], a[148:151]
    v_exp_f32 v145, v145
    v_mfma_f32_16x16x32_bf16 a[152:155], a[208:211], v[168:171], a[152:155]
    ds_read_b64_tr_b16 a[178:179], v8 offset:17408
    v_cvt_pk_bf16_f32 v140, v144, v145
    v_mfma_f32_16x16x32_bf16 a[152:155], a[212:215], v[172:175], a[152:155]
    v_exp_f32 v146, v146
    v_mfma_f32_16x16x32_bf16 a[156:159], a[216:219], v[172:175], a[156:159]
    ds_read_b64_tr_b16 a[180:181], v8 offset:18432
    ds_read_b64_tr_b16 a[182:183], v8 offset:19456
    v_mfma_f32_16x16x32_bf16 a[156:159], a[220:223], v[168:171], a[156:159]
    v_exp_f32 v147, v147
    v_smfmac_f32_16x16x64_bf16 v[252:255], v[132:135], v[168:175], v0
    ds_read_b64_tr_b16 a[184:185], v9 offset:18432
    v_cvt_pk_bf16_f32 v141, v146, v147
    v_mfma_f32_16x16x32_bf16 v[152:155], v[184:187], v[48:51], v[116:119]
    v_exp_f32 v148, v148
    v_mfma_f32_16x16x32_bf16 v[152:155], v[188:191], v[52:55], v[152:155]
    ds_read_b64_tr_b16 a[186:187], v9 offset:19456
    ds_read_b64_tr_b16 a[188:189], v9 offset:16384
    v_mfma_f32_16x16x32_bf16 v[152:155], v[192:195], v[56:59], v[152:155]
    v_exp_f32 v149, v149
    v_mfma_f32_16x16x32_bf16 v[152:155], v[196:199], v[60:63], v[152:155]
    ds_read_b64_tr_b16 a[190:191], v9 offset:17408
    v_cvt_pk_bf16_f32 v142, v148, v149
    v_mfma_f32_16x16x32_bf16 v[156:159], v[200:203], v[60:63], v[116:119]
    v_exp_f32 v150, v150
    v_mfma_f32_16x16x32_bf16 v[156:159], v[204:207], v[56:59], v[156:159]
    ds_read_b64_tr_b16 a[192:193], v10 offset:16384
    ds_read_b64_tr_b16 a[194:195], v10 offset:17408
    v_mfma_f32_16x16x32_bf16 v[156:159], v[208:211], v[52:55], v[156:159]
    v_exp_f32 v151, v151
    v_mfma_f32_16x16x32_bf16 v[156:159], v[212:215], v[48:51], v[156:159]
    ds_read_b64_tr_b16 a[196:197], v10 offset:18432
    v_cvt_pk_bf16_f32 v143, v150, v151
    v_mfma_f32_16x16x32_bf16 v[160:163], v[216:219], v[48:51], v[116:119]
    ds_read_b64_tr_b16 a[198:199], v10 offset:19456
    ds_read_b64_tr_b16 a[200:201], v11 offset:18432
    v_mfma_f32_16x16x32_bf16 v[160:163], v[220:223], v[52:55], v[160:163]
    v_exp_f32 v152, v152
    v_mfma_f32_16x16x32_bf16 v[160:163], v[224:227], v[56:59], v[160:163]
    ds_read_b64_tr_b16 a[202:203], v11 offset:19456
    ds_read_b64_tr_b16 a[204:205], v11 offset:16384
    v_mfma_f32_16x16x32_bf16 v[160:163], v[228:231], v[60:63], v[160:163]
    v_exp_f32 v153, v153
    v_mfma_f32_16x16x32_bf16 v[164:167], v[232:235], v[60:63], v[116:119]
    ds_read_b64_tr_b16 a[206:207], v11 offset:17408
    v_cvt_pk_bf16_f32 v152, v152, v153
    v_mfma_f32_16x16x32_bf16 v[164:167], v[236:239], v[56:59], v[164:167]
    v_exp_f32 v154, v154
    v_mfma_f32_16x16x32_bf16 v[164:167], v[240:243], v[52:55], v[164:167]
    ds_read_b64_tr_b16 a[208:209], v12 offset:16384
    ds_read_b64_tr_b16 a[210:211], v12 offset:17408
    v_mfma_f32_16x16x32_bf16 v[164:167], v[244:247], v[48:51], v[164:167]
    s_waitcnt lgkmcnt(7)
    v_exp_f32 v155, v155
    v_mfma_f32_16x16x32_bf16 a[0:3], a[160:163], v[136:139], a[0:3]
    ds_read_b64_tr_b16 a[212:213], v12 offset:18432
    v_cvt_pk_bf16_f32 v153, v154, v155
    v_mfma_f32_16x16x32_bf16 a[0:3], a[164:167], v[140:143], a[0:3]
    v_exp_f32 v156, v156
    v_mfma_f32_16x16x32_bf16 a[4:7], a[168:171], v[140:143], a[4:7]
    ds_read_b64_tr_b16 a[214:215], v12 offset:19456
    ds_read_b64_tr_b16 a[216:217], v13 offset:18432
    v_mfma_f32_16x16x32_bf16 a[4:7], a[172:175], v[136:139], a[4:7]
    v_exp_f32 v157, v157
    v_mfma_f32_16x16x32_bf16 a[8:11], a[176:179], v[136:139], a[8:11]
    ds_read_b64_tr_b16 a[218:219], v13 offset:19456
    v_cvt_pk_bf16_f32 v154, v156, v157
    v_mfma_f32_16x16x32_bf16 a[8:11], a[180:183], v[140:143], a[8:11]
    v_exp_f32 v158, v158
    v_mfma_f32_16x16x32_bf16 a[12:15], a[184:187], v[140:143], a[12:15]
    ds_read_b64_tr_b16 a[220:221], v13 offset:16384
    ds_read_b64_tr_b16 a[222:223], v13 offset:17408
    v_mfma_f32_16x16x32_bf16 a[12:15], a[188:191], v[136:139], a[12:15]
    v_exp_f32 v159, v159
    v_mfma_f32_16x16x32_bf16 a[16:19], a[192:195], v[136:139], a[16:19]
    s_waitcnt lgkmcnt(5)
    v_cvt_pk_bf16_f32 v155, v158, v159
    v_mfma_f32_16x16x32_bf16 a[16:19], a[196:199], v[140:143], a[16:19]
    v_exp_f32 v160, v160
    v_mfma_f32_16x16x32_bf16 a[20:23], a[200:203], v[140:143], a[20:23]
    v_mfma_f32_16x16x32_bf16 a[20:23], a[204:207], v[136:139], a[20:23]
    v_exp_f32 v161, v161
    v_mfma_f32_16x16x32_bf16 a[24:27], a[208:211], v[136:139], a[24:27]
    s_waitcnt lgkmcnt(2)
    v_cvt_pk_bf16_f32 v156, v160, v161
    v_mfma_f32_16x16x32_bf16 a[24:27], a[212:215], v[140:143], a[24:27]
    v_exp_f32 v162, v162
    v_mfma_f32_16x16x32_bf16 a[28:31], a[216:219], v[140:143], a[28:31]
    s_waitcnt lgkmcnt(0)
    v_mfma_f32_16x16x32_bf16 a[28:31], a[220:223], v[136:139], a[28:31]
    v_exp_f32 v163, v163
    v_smfmac_f32_16x16x64_bf16 v[20:23], v[132:135], v[136:143], v0
    v_cvt_pk_bf16_f32 v157, v162, v163
    v_mfma_f32_16x16x32_bf16 v[136:139], v[184:187], v[64:67], v[120:123]
    v_exp_f32 v164, v164
    v_mfma_f32_16x16x32_bf16 v[136:139], v[188:191], v[68:71], v[136:139]
    v_mfma_f32_16x16x32_bf16 v[136:139], v[192:195], v[72:75], v[136:139]
    v_exp_f32 v165, v165
    v_mfma_f32_16x16x32_bf16 v[136:139], v[196:199], v[76:79], v[136:139]
    v_cvt_pk_bf16_f32 v158, v164, v165
    v_mfma_f32_16x16x32_bf16 v[140:143], v[200:203], v[76:79], v[120:123]
    v_exp_f32 v166, v166
    v_mfma_f32_16x16x32_bf16 v[140:143], v[204:207], v[72:75], v[140:143]
    v_mfma_f32_16x16x32_bf16 v[140:143], v[208:211], v[68:71], v[140:143]
    v_exp_f32 v167, v167
    v_mfma_f32_16x16x32_bf16 v[140:143], v[212:215], v[64:67], v[140:143]
    v_cvt_pk_bf16_f32 v159, v166, v167
    v_add_f32 v20, v20, v21
    v_rcp_f32 v112, v20
    v_cmp_ngt_f32 vcc, s62, v20
    v_add_u32 v114, s54, v16
    v_add_u32 v118, s54, v17
    v_xor_b32 v115, 32, v114
    v_xor_b32 v116, 64, v114
    v_xor_b32 v117, 96, v114
    v_xor_b32 v119, 64, v118
    s_or_b64 s[56:57], s[56:57], vcc
    v_accvgpr_read_b32 v32, a0
    v_accvgpr_read_b32 v33, a1
    v_accvgpr_read_b32 v34, a2
    v_accvgpr_read_b32 v35, a3
    v_pk_mul_f32 v[32:33], v[32:33], v[112:113] op_sel_hi:[1,0]
    v_pk_mul_f32 v[34:35], v[34:35], v[112:113] op_sel_hi:[1,0]
    v_cvt_pk_bf16_f32 v32, v32, v33
    v_cvt_pk_bf16_f32 v33, v34, v35
    v_mfma_f32_16x16x32_bf16 v[144:147], v[216:219], v[64:67], v[120:123]
    ds_write_b64 v114, v[32:33] offset:0
    v_accvgpr_read_b32 v36, a4
    v_accvgpr_read_b32 v37, a5
    v_accvgpr_read_b32 v38, a6
    v_accvgpr_read_b32 v39, a7
    v_pk_mul_f32 v[36:37], v[36:37], v[112:113] op_sel_hi:[1,0]
    v_pk_mul_f32 v[38:39], v[38:39], v[112:113] op_sel_hi:[1,0]
    v_cvt_pk_bf16_f32 v36, v36, v37
    v_cvt_pk_bf16_f32 v37, v38, v39
    v_mfma_f32_16x16x32_bf16 v[144:147], v[220:223], v[68:71], v[144:147]
    ds_write_b64 v115, v[36:37] offset:0
    v_exp_f32 v136, v136
    v_accvgpr_read_b32 v40, a8
    v_accvgpr_read_b32 v41, a9
    v_accvgpr_read_b32 v42, a10
    v_accvgpr_read_b32 v43, a11
    v_pk_mul_f32 v[40:41], v[40:41], v[112:113] op_sel_hi:[1,0]
    v_pk_mul_f32 v[42:43], v[42:43], v[112:113] op_sel_hi:[1,0]
    v_cvt_pk_bf16_f32 v40, v40, v41
    v_cvt_pk_bf16_f32 v41, v42, v43
    v_mfma_f32_16x16x32_bf16 v[144:147], v[224:227], v[72:75], v[144:147]
    ds_write_b64 v116, v[40:41] offset:0
    v_accvgpr_read_b32 v44, a12
    v_accvgpr_read_b32 v45, a13
    v_accvgpr_read_b32 v46, a14
    v_accvgpr_read_b32 v47, a15
    v_pk_mul_f32 v[44:45], v[44:45], v[112:113] op_sel_hi:[1,0]
    v_pk_mul_f32 v[46:47], v[46:47], v[112:113] op_sel_hi:[1,0]
    v_cvt_pk_bf16_f32 v44, v44, v45
    v_cvt_pk_bf16_f32 v45, v46, v47
    v_mfma_f32_16x16x32_bf16 v[144:147], v[228:231], v[76:79], v[144:147]
    ds_write_b64 v117, v[44:45] offset:0
    v_exp_f32 v137, v137
    v_accvgpr_read_b32 v32, a16
    v_accvgpr_read_b32 v33, a17
    v_accvgpr_read_b32 v34, a18
    v_accvgpr_read_b32 v35, a19
    v_pk_mul_f32 v[32:33], v[32:33], v[112:113] op_sel_hi:[1,0]
    v_pk_mul_f32 v[34:35], v[34:35], v[112:113] op_sel_hi:[1,0]
    v_cvt_pk_bf16_f32 v32, v32, v33
    v_cvt_pk_bf16_f32 v33, v34, v35
    v_mfma_f32_16x16x32_bf16 v[148:151], v[232:235], v[76:79], v[120:123]
    ds_write_b64 v114, v[32:33] offset:128
    v_cvt_pk_bf16_f32 v136, v136, v137
    v_accvgpr_read_b32 v36, a20
    v_accvgpr_read_b32 v37, a21
    v_accvgpr_read_b32 v38, a22
    v_accvgpr_read_b32 v39, a23
    v_pk_mul_f32 v[36:37], v[36:37], v[112:113] op_sel_hi:[1,0]
    v_pk_mul_f32 v[38:39], v[38:39], v[112:113] op_sel_hi:[1,0]
    v_cvt_pk_bf16_f32 v36, v36, v37
    v_cvt_pk_bf16_f32 v37, v38, v39
    v_mfma_f32_16x16x32_bf16 v[148:151], v[236:239], v[72:75], v[148:151]
    ds_write_b64 v115, v[36:37] offset:128
    v_exp_f32 v138, v138
    v_accvgpr_read_b32 v40, a24
    v_accvgpr_read_b32 v41, a25
    v_accvgpr_read_b32 v42, a26
    v_accvgpr_read_b32 v43, a27
    v_pk_mul_f32 v[40:41], v[40:41], v[112:113] op_sel_hi:[1,0]
    v_pk_mul_f32 v[42:43], v[42:43], v[112:113] op_sel_hi:[1,0]
    v_cvt_pk_bf16_f32 v40, v40, v41
    v_cvt_pk_bf16_f32 v41, v42, v43
    v_mfma_f32_16x16x32_bf16 v[148:151], v[240:243], v[68:71], v[148:151]
    ds_write_b64 v116, v[40:41] offset:128
    v_accvgpr_read_b32 v44, a28
    v_accvgpr_read_b32 v45, a29
    v_accvgpr_read_b32 v46, a30
    v_accvgpr_read_b32 v47, a31
    v_pk_mul_f32 v[44:45], v[44:45], v[112:113] op_sel_hi:[1,0]
    v_pk_mul_f32 v[46:47], v[46:47], v[112:113] op_sel_hi:[1,0]
    v_cvt_pk_bf16_f32 v44, v44, v45
    v_cvt_pk_bf16_f32 v45, v46, v47
    v_mfma_f32_16x16x32_bf16 v[148:151], v[244:247], v[64:67], v[148:151]
    ds_write_b64 v117, v[44:45] offset:128
    ds_read_b128 v[48:51], v118 offset:0
    ds_read_b128 v[52:55], v119 offset:1024
    ds_read_b128 v[56:59], v118 offset:2048
    ds_read_b128 v[60:63], v119 offset:3072
    v_exp_f32 v139, v139
    v_mfma_f32_16x16x32_bf16 a[32:35], a[160:163], v[152:155], a[32:35]
    v_cvt_pk_bf16_f32 v137, v138, v139
    v_mfma_f32_16x16x32_bf16 a[32:35], a[164:167], v[156:159], a[32:35]
    v_exp_f32 v140, v140
    v_mfma_f32_16x16x32_bf16 a[36:39], a[168:171], v[156:159], a[36:39]
    v_mfma_f32_16x16x32_bf16 a[36:39], a[172:175], v[152:155], a[36:39]
    v_exp_f32 v141, v141
    v_mfma_f32_16x16x32_bf16 a[40:43], a[176:179], v[152:155], a[40:43]
    v_cvt_pk_bf16_f32 v138, v140, v141
    v_mfma_f32_16x16x32_bf16 a[40:43], a[180:183], v[156:159], a[40:43]
    v_exp_f32 v142, v142
    v_mfma_f32_16x16x32_bf16 a[44:47], a[184:187], v[156:159], a[44:47]
    v_mfma_f32_16x16x32_bf16 a[44:47], a[188:191], v[152:155], a[44:47]
    s_waitcnt lgkmcnt(0)
    buffer_store_dwordx4 v[48:51], v18, s[20:23], s40 offen sc1 nt
    buffer_store_dwordx4 v[52:55], v18, s[20:23], s41 offen sc1 nt
    buffer_store_dwordx4 v[56:59], v18, s[20:23], s42 offen sc1 nt
    buffer_store_dwordx4 v[60:63], v18, s[20:23], s43 offen sc1 nt
    v_exp_f32 v143, v143
    v_mfma_f32_16x16x32_bf16 a[48:51], a[192:195], v[152:155], a[48:51]
    v_cvt_pk_bf16_f32 v139, v142, v143
    v_mfma_f32_16x16x32_bf16 a[48:51], a[196:199], v[156:159], a[48:51]
    v_exp_f32 v144, v144
    v_mfma_f32_16x16x32_bf16 a[52:55], a[200:203], v[156:159], a[52:55]
    v_mfma_f32_16x16x32_bf16 a[52:55], a[204:207], v[152:155], a[52:55]
    v_exp_f32 v145, v145
    v_mfma_f32_16x16x32_bf16 a[56:59], a[208:211], v[152:155], a[56:59]
    v_cvt_pk_bf16_f32 v140, v144, v145
    v_mfma_f32_16x16x32_bf16 a[56:59], a[212:215], v[156:159], a[56:59]
    v_exp_f32 v146, v146
    v_mfma_f32_16x16x32_bf16 a[60:63], a[216:219], v[156:159], a[60:63]
    v_mfma_f32_16x16x32_bf16 a[60:63], a[220:223], v[152:155], a[60:63]
    v_exp_f32 v147, v147
    v_smfmac_f32_16x16x64_bf16 v[24:27], v[132:135], v[152:159], v0
    v_cvt_pk_bf16_f32 v141, v146, v147
    v_mfma_f32_16x16x32_bf16 v[152:155], v[184:187], v[80:83], v[124:127]
    v_exp_f32 v148, v148
    v_mfma_f32_16x16x32_bf16 v[152:155], v[188:191], v[84:87], v[152:155]
    v_mfma_f32_16x16x32_bf16 v[152:155], v[192:195], v[88:91], v[152:155]
    v_exp_f32 v149, v149
    v_mfma_f32_16x16x32_bf16 v[152:155], v[196:199], v[92:95], v[152:155]
    v_cvt_pk_bf16_f32 v142, v148, v149
    v_mfma_f32_16x16x32_bf16 v[156:159], v[200:203], v[92:95], v[124:127]
    v_exp_f32 v150, v150
    v_mfma_f32_16x16x32_bf16 v[156:159], v[204:207], v[88:91], v[156:159]
    v_mfma_f32_16x16x32_bf16 v[156:159], v[208:211], v[84:87], v[156:159]
    v_exp_f32 v151, v151
    v_mfma_f32_16x16x32_bf16 v[156:159], v[212:215], v[80:83], v[156:159]
    v_cvt_pk_bf16_f32 v143, v150, v151
    v_add_f32 v24, v24, v25
    v_rcp_f32 v112, v24
    v_cmp_ngt_f32 vcc, s62, v24
    s_or_b64 s[56:57], s[56:57], vcc
    v_accvgpr_read_b32 v32, a32
    v_accvgpr_read_b32 v33, a33
    v_accvgpr_read_b32 v34, a34
    v_accvgpr_read_b32 v35, a35
    v_pk_mul_f32 v[32:33], v[32:33], v[112:113] op_sel_hi:[1,0]
    v_pk_mul_f32 v[34:35], v[34:35], v[112:113] op_sel_hi:[1,0]
    v_cvt_pk_bf16_f32 v32, v32, v33
    v_cvt_pk_bf16_f32 v33, v34, v35
    v_mfma_f32_16x16x32_bf16 v[160:163], v[216:219], v[80:83], v[124:127]
    ds_write_b64 v114, v[32:33] offset:0
    v_accvgpr_read_b32 v36, a36
    v_accvgpr_read_b32 v37, a37
    v_accvgpr_read_b32 v38, a38
    v_accvgpr_read_b32 v39, a39
    v_pk_mul_f32 v[36:37], v[36:37], v[112:113] op_sel_hi:[1,0]
    v_pk_mul_f32 v[38:39], v[38:39], v[112:113] op_sel_hi:[1,0]
    v_cvt_pk_bf16_f32 v36, v36, v37
    v_cvt_pk_bf16_f32 v37, v38, v39
    v_mfma_f32_16x16x32_bf16 v[160:163], v[220:223], v[84:87], v[160:163]
    ds_write_b64 v115, v[36:37] offset:0
    v_exp_f32 v152, v152
    v_accvgpr_read_b32 v40, a40
    v_accvgpr_read_b32 v41, a41
    v_accvgpr_read_b32 v42, a42
    v_accvgpr_read_b32 v43, a43
    v_pk_mul_f32 v[40:41], v[40:41], v[112:113] op_sel_hi:[1,0]
    v_pk_mul_f32 v[42:43], v[42:43], v[112:113] op_sel_hi:[1,0]
    v_cvt_pk_bf16_f32 v40, v40, v41
    v_cvt_pk_bf16_f32 v41, v42, v43
    v_mfma_f32_16x16x32_bf16 v[160:163], v[224:227], v[88:91], v[160:163]
    ds_write_b64 v116, v[40:41] offset:0
    v_accvgpr_read_b32 v44, a44
    v_accvgpr_read_b32 v45, a45
    v_accvgpr_read_b32 v46, a46
    v_accvgpr_read_b32 v47, a47
    v_pk_mul_f32 v[44:45], v[44:45], v[112:113] op_sel_hi:[1,0]
    v_pk_mul_f32 v[46:47], v[46:47], v[112:113] op_sel_hi:[1,0]
    v_cvt_pk_bf16_f32 v44, v44, v45
    v_cvt_pk_bf16_f32 v45, v46, v47
    v_mfma_f32_16x16x32_bf16 v[160:163], v[228:231], v[92:95], v[160:163]
    ds_write_b64 v117, v[44:45] offset:0
    v_exp_f32 v153, v153
    v_accvgpr_read_b32 v32, a48
    v_accvgpr_read_b32 v33, a49
    v_accvgpr_read_b32 v34, a50
    v_accvgpr_read_b32 v35, a51
    v_pk_mul_f32 v[32:33], v[32:33], v[112:113] op_sel_hi:[1,0]
    v_pk_mul_f32 v[34:35], v[34:35], v[112:113] op_sel_hi:[1,0]
    v_cvt_pk_bf16_f32 v32, v32, v33
    v_cvt_pk_bf16_f32 v33, v34, v35
    v_mfma_f32_16x16x32_bf16 v[164:167], v[232:235], v[92:95], v[124:127]
    ds_write_b64 v114, v[32:33] offset:128
    v_cvt_pk_bf16_f32 v152, v152, v153
    v_accvgpr_read_b32 v36, a52
    v_accvgpr_read_b32 v37, a53
    v_accvgpr_read_b32 v38, a54
    v_accvgpr_read_b32 v39, a55
    v_pk_mul_f32 v[36:37], v[36:37], v[112:113] op_sel_hi:[1,0]
    v_pk_mul_f32 v[38:39], v[38:39], v[112:113] op_sel_hi:[1,0]
    v_cvt_pk_bf16_f32 v36, v36, v37
    v_cvt_pk_bf16_f32 v37, v38, v39
    v_mfma_f32_16x16x32_bf16 v[164:167], v[236:239], v[88:91], v[164:167]
    ds_write_b64 v115, v[36:37] offset:128
    v_exp_f32 v154, v154
    v_accvgpr_read_b32 v40, a56
    v_accvgpr_read_b32 v41, a57
    v_accvgpr_read_b32 v42, a58
    v_accvgpr_read_b32 v43, a59
    v_pk_mul_f32 v[40:41], v[40:41], v[112:113] op_sel_hi:[1,0]
    v_pk_mul_f32 v[42:43], v[42:43], v[112:113] op_sel_hi:[1,0]
    v_cvt_pk_bf16_f32 v40, v40, v41
    v_cvt_pk_bf16_f32 v41, v42, v43
    v_mfma_f32_16x16x32_bf16 v[164:167], v[240:243], v[84:87], v[164:167]
    ds_write_b64 v116, v[40:41] offset:128
    v_accvgpr_read_b32 v44, a60
    v_accvgpr_read_b32 v45, a61
    v_accvgpr_read_b32 v46, a62
    v_accvgpr_read_b32 v47, a63
    v_pk_mul_f32 v[44:45], v[44:45], v[112:113] op_sel_hi:[1,0]
    v_pk_mul_f32 v[46:47], v[46:47], v[112:113] op_sel_hi:[1,0]
    v_cvt_pk_bf16_f32 v44, v44, v45
    v_cvt_pk_bf16_f32 v45, v46, v47
    v_mfma_f32_16x16x32_bf16 v[164:167], v[244:247], v[80:83], v[164:167]
    ds_write_b64 v117, v[44:45] offset:128
    ds_read_b128 v[48:51], v118 offset:0
    ds_read_b128 v[52:55], v119 offset:1024
    ds_read_b128 v[56:59], v118 offset:2048
    ds_read_b128 v[60:63], v119 offset:3072
    v_exp_f32 v155, v155
    v_mfma_f32_16x16x32_bf16 a[64:67], a[160:163], v[136:139], a[64:67]
    v_cvt_pk_bf16_f32 v153, v154, v155
    v_mfma_f32_16x16x32_bf16 a[64:67], a[164:167], v[140:143], a[64:67]
    v_exp_f32 v156, v156
    v_mfma_f32_16x16x32_bf16 a[68:71], a[168:171], v[140:143], a[68:71]
    v_mfma_f32_16x16x32_bf16 a[68:71], a[172:175], v[136:139], a[68:71]
    v_exp_f32 v157, v157
    v_mfma_f32_16x16x32_bf16 a[72:75], a[176:179], v[136:139], a[72:75]
    v_cvt_pk_bf16_f32 v154, v156, v157
    v_mfma_f32_16x16x32_bf16 a[72:75], a[180:183], v[140:143], a[72:75]
    v_exp_f32 v158, v158
    v_mfma_f32_16x16x32_bf16 a[76:79], a[184:187], v[140:143], a[76:79]
    v_mfma_f32_16x16x32_bf16 a[76:79], a[188:191], v[136:139], a[76:79]
    s_waitcnt lgkmcnt(0)
    buffer_store_dwordx4 v[48:51], v18, s[20:23], s40 offen offset:1024 sc1 nt
    buffer_store_dwordx4 v[52:55], v18, s[20:23], s41 offen offset:1024 sc1 nt
    buffer_store_dwordx4 v[56:59], v18, s[20:23], s42 offen offset:1024 sc1 nt
    buffer_store_dwordx4 v[60:63], v18, s[20:23], s43 offen offset:1024 sc1 nt
    v_exp_f32 v159, v159
    v_mfma_f32_16x16x32_bf16 a[80:83], a[192:195], v[136:139], a[80:83]
    v_cvt_pk_bf16_f32 v155, v158, v159
    v_mfma_f32_16x16x32_bf16 a[80:83], a[196:199], v[140:143], a[80:83]
    v_exp_f32 v160, v160
    v_mfma_f32_16x16x32_bf16 a[84:87], a[200:203], v[140:143], a[84:87]
    v_mfma_f32_16x16x32_bf16 a[84:87], a[204:207], v[136:139], a[84:87]
    v_exp_f32 v161, v161
    v_mfma_f32_16x16x32_bf16 a[88:91], a[208:211], v[136:139], a[88:91]
    v_cvt_pk_bf16_f32 v156, v160, v161
    v_mfma_f32_16x16x32_bf16 a[88:91], a[212:215], v[140:143], a[88:91]
    v_exp_f32 v162, v162
    v_mfma_f32_16x16x32_bf16 a[92:95], a[216:219], v[140:143], a[92:95]
    v_mfma_f32_16x16x32_bf16 a[92:95], a[220:223], v[136:139], a[92:95]
    v_exp_f32 v163, v163
    v_smfmac_f32_16x16x64_bf16 v[28:31], v[132:135], v[136:143], v0
    v_cvt_pk_bf16_f32 v157, v162, v163
    v_mfma_f32_16x16x32_bf16 v[168:171], v[184:187], v[96:99], v[128:131]
    v_exp_f32 v164, v164
    v_mfma_f32_16x16x32_bf16 v[168:171], v[188:191], v[100:103], v[168:171]
    v_mfma_f32_16x16x32_bf16 v[168:171], v[192:195], v[104:107], v[168:171]
    v_exp_f32 v165, v165
    v_mfma_f32_16x16x32_bf16 v[168:171], v[196:199], v[108:111], v[168:171]
    v_cvt_pk_bf16_f32 v158, v164, v165
    v_mfma_f32_16x16x32_bf16 v[172:175], v[200:203], v[108:111], v[128:131]
    v_exp_f32 v166, v166
    v_mfma_f32_16x16x32_bf16 v[172:175], v[204:207], v[104:107], v[172:175]
    v_mfma_f32_16x16x32_bf16 v[172:175], v[208:211], v[100:103], v[172:175]
    v_exp_f32 v167, v167
    v_mfma_f32_16x16x32_bf16 v[172:175], v[212:215], v[96:99], v[172:175]
    v_cvt_pk_bf16_f32 v159, v166, v167
    v_add_f32 v28, v28, v29
    v_rcp_f32 v112, v28
    v_cmp_ngt_f32 vcc, s62, v28
    s_or_b64 s[56:57], s[56:57], vcc
    v_accvgpr_read_b32 v32, a64
    v_accvgpr_read_b32 v33, a65
    v_accvgpr_read_b32 v34, a66
    v_accvgpr_read_b32 v35, a67
    v_pk_mul_f32 v[32:33], v[32:33], v[112:113] op_sel_hi:[1,0]
    v_pk_mul_f32 v[34:35], v[34:35], v[112:113] op_sel_hi:[1,0]
    v_cvt_pk_bf16_f32 v32, v32, v33
    v_cvt_pk_bf16_f32 v33, v34, v35
    v_mfma_f32_16x16x32_bf16 v[176:179], v[216:219], v[96:99], v[128:131]
    ds_write_b64 v114, v[32:33] offset:0
    v_accvgpr_read_b32 v36, a68
    v_accvgpr_read_b32 v37, a69
    v_accvgpr_read_b32 v38, a70
    v_accvgpr_read_b32 v39, a71
    v_pk_mul_f32 v[36:37], v[36:37], v[112:113] op_sel_hi:[1,0]
    v_pk_mul_f32 v[38:39], v[38:39], v[112:113] op_sel_hi:[1,0]
    v_cvt_pk_bf16_f32 v36, v36, v37
    v_cvt_pk_bf16_f32 v37, v38, v39
    v_mfma_f32_16x16x32_bf16 v[176:179], v[220:223], v[100:103], v[176:179]
    ds_write_b64 v115, v[36:37] offset:0
    v_exp_f32 v168, v168
    v_accvgpr_read_b32 v40, a72
    v_accvgpr_read_b32 v41, a73
    v_accvgpr_read_b32 v42, a74
    v_accvgpr_read_b32 v43, a75
    v_pk_mul_f32 v[40:41], v[40:41], v[112:113] op_sel_hi:[1,0]
    v_pk_mul_f32 v[42:43], v[42:43], v[112:113] op_sel_hi:[1,0]
    v_cvt_pk_bf16_f32 v40, v40, v41
    v_cvt_pk_bf16_f32 v41, v42, v43
    v_mfma_f32_16x16x32_bf16 v[176:179], v[224:227], v[104:107], v[176:179]
    ds_write_b64 v116, v[40:41] offset:0
    v_accvgpr_read_b32 v44, a76
    v_accvgpr_read_b32 v45, a77
    v_accvgpr_read_b32 v46, a78
    v_accvgpr_read_b32 v47, a79
    v_pk_mul_f32 v[44:45], v[44:45], v[112:113] op_sel_hi:[1,0]
    v_pk_mul_f32 v[46:47], v[46:47], v[112:113] op_sel_hi:[1,0]
    v_cvt_pk_bf16_f32 v44, v44, v45
    v_cvt_pk_bf16_f32 v45, v46, v47
    v_mfma_f32_16x16x32_bf16 v[176:179], v[228:231], v[108:111], v[176:179]
    ds_write_b64 v117, v[44:45] offset:0
    v_exp_f32 v169, v169
    v_accvgpr_read_b32 v32, a80
    v_accvgpr_read_b32 v33, a81
    v_accvgpr_read_b32 v34, a82
    v_accvgpr_read_b32 v35, a83
    v_pk_mul_f32 v[32:33], v[32:33], v[112:113] op_sel_hi:[1,0]
    v_pk_mul_f32 v[34:35], v[34:35], v[112:113] op_sel_hi:[1,0]
    v_cvt_pk_bf16_f32 v32, v32, v33
    v_cvt_pk_bf16_f32 v33, v34, v35
    v_mfma_f32_16x16x32_bf16 v[180:183], v[232:235], v[108:111], v[128:131]
    ds_write_b64 v114, v[32:33] offset:128
    v_cvt_pk_bf16_f32 v168, v168, v169
    v_accvgpr_read_b32 v36, a84
    v_accvgpr_read_b32 v37, a85
    v_accvgpr_read_b32 v38, a86
    v_accvgpr_read_b32 v39, a87
    v_pk_mul_f32 v[36:37], v[36:37], v[112:113] op_sel_hi:[1,0]
    v_pk_mul_f32 v[38:39], v[38:39], v[112:113] op_sel_hi:[1,0]
    v_cvt_pk_bf16_f32 v36, v36, v37
    v_cvt_pk_bf16_f32 v37, v38, v39
    v_mfma_f32_16x16x32_bf16 v[180:183], v[236:239], v[104:107], v[180:183]
    ds_write_b64 v115, v[36:37] offset:128
    v_exp_f32 v170, v170
    v_accvgpr_read_b32 v40, a88
    v_accvgpr_read_b32 v41, a89
    v_accvgpr_read_b32 v42, a90
    v_accvgpr_read_b32 v43, a91
    v_pk_mul_f32 v[40:41], v[40:41], v[112:113] op_sel_hi:[1,0]
    v_pk_mul_f32 v[42:43], v[42:43], v[112:113] op_sel_hi:[1,0]
    v_cvt_pk_bf16_f32 v40, v40, v41
    v_cvt_pk_bf16_f32 v41, v42, v43
    v_mfma_f32_16x16x32_bf16 v[180:183], v[240:243], v[100:103], v[180:183]
    ds_write_b64 v116, v[40:41] offset:128
    v_accvgpr_read_b32 v44, a92
    v_accvgpr_read_b32 v45, a93
    v_accvgpr_read_b32 v46, a94
    v_accvgpr_read_b32 v47, a95
    v_pk_mul_f32 v[44:45], v[44:45], v[112:113] op_sel_hi:[1,0]
    v_pk_mul_f32 v[46:47], v[46:47], v[112:113] op_sel_hi:[1,0]
    v_cvt_pk_bf16_f32 v44, v44, v45
    v_cvt_pk_bf16_f32 v45, v46, v47
    v_mfma_f32_16x16x32_bf16 v[180:183], v[244:247], v[96:99], v[180:183]
    ds_write_b64 v117, v[44:45] offset:128
    ds_read_b128 v[48:51], v118 offset:0
    ds_read_b128 v[52:55], v119 offset:1024
    ds_read_b128 v[56:59], v118 offset:2048
    ds_read_b128 v[60:63], v119 offset:3072
    v_exp_f32 v171, v171
    v_mfma_f32_16x16x32_bf16 a[96:99], a[160:163], v[152:155], a[96:99]
    v_cvt_pk_bf16_f32 v169, v170, v171
    v_mfma_f32_16x16x32_bf16 a[96:99], a[164:167], v[156:159], a[96:99]
    v_exp_f32 v172, v172
    v_mfma_f32_16x16x32_bf16 a[100:103], a[168:171], v[156:159], a[100:103]
    v_mfma_f32_16x16x32_bf16 a[100:103], a[172:175], v[152:155], a[100:103]
    v_exp_f32 v173, v173
    v_mfma_f32_16x16x32_bf16 a[104:107], a[176:179], v[152:155], a[104:107]
    v_cvt_pk_bf16_f32 v170, v172, v173
    v_mfma_f32_16x16x32_bf16 a[104:107], a[180:183], v[156:159], a[104:107]
    v_exp_f32 v174, v174
    v_mfma_f32_16x16x32_bf16 a[108:111], a[184:187], v[156:159], a[108:111]
    v_mfma_f32_16x16x32_bf16 a[108:111], a[188:191], v[152:155], a[108:111]
    s_waitcnt lgkmcnt(0)
    buffer_store_dwordx4 v[48:51], v18, s[20:23], s40 offen offset:2048 sc1 nt
    buffer_store_dwordx4 v[52:55], v18, s[20:23], s41 offen offset:2048 sc1 nt
    buffer_store_dwordx4 v[56:59], v18, s[20:23], s42 offen offset:2048 sc1 nt
    buffer_store_dwordx4 v[60:63], v18, s[20:23], s43 offen offset:2048 sc1 nt
    v_exp_f32 v175, v175
    v_mfma_f32_16x16x32_bf16 a[112:115], a[192:195], v[152:155], a[112:115]
    v_cvt_pk_bf16_f32 v171, v174, v175
    v_mfma_f32_16x16x32_bf16 a[112:115], a[196:199], v[156:159], a[112:115]
    v_exp_f32 v176, v176
    v_mfma_f32_16x16x32_bf16 a[116:119], a[200:203], v[156:159], a[116:119]
    v_mfma_f32_16x16x32_bf16 a[116:119], a[204:207], v[152:155], a[116:119]
    v_exp_f32 v177, v177
    v_mfma_f32_16x16x32_bf16 a[120:123], a[208:211], v[152:155], a[120:123]
    v_cvt_pk_bf16_f32 v172, v176, v177
    v_mfma_f32_16x16x32_bf16 a[120:123], a[212:215], v[156:159], a[120:123]
    v_exp_f32 v178, v178
    v_mfma_f32_16x16x32_bf16 a[124:127], a[216:219], v[156:159], a[124:127]
    v_mfma_f32_16x16x32_bf16 a[124:127], a[220:223], v[152:155], a[124:127]
    v_exp_f32 v179, v179
    v_smfmac_f32_16x16x64_bf16 v[248:251], v[132:135], v[152:159], v0
    v_cvt_pk_bf16_f32 v173, v178, v179
    v_exp_f32 v180, v180
    s_nop 0
    v_exp_f32 v181, v181
    s_nop 0
    v_cvt_pk_bf16_f32 v174, v180, v181
    s_nop 0
    v_exp_f32 v182, v182
    s_nop 0
    v_exp_f32 v183, v183
    s_nop 0
    v_cvt_pk_bf16_f32 v175, v182, v183
    s_nop 0
    s_nop 1
    v_smfmac_f32_16x16x64_bf16 v[252:255], v[132:135], v[168:175], v0
    v_add_f32 v248, v248, v249
    v_rcp_f32 v112, v248
    v_cmp_ngt_f32 vcc, s62, v248
    s_or_b64 s[56:57], s[56:57], vcc
    v_accvgpr_read_b32 v32, a96
    v_accvgpr_read_b32 v33, a97
    v_accvgpr_read_b32 v34, a98
    v_accvgpr_read_b32 v35, a99
    v_pk_mul_f32 v[32:33], v[32:33], v[112:113] op_sel_hi:[1,0]
    v_pk_mul_f32 v[34:35], v[34:35], v[112:113] op_sel_hi:[1,0]
    v_cvt_pk_bf16_f32 v32, v32, v33
    v_cvt_pk_bf16_f32 v33, v34, v35
    v_mfma_f32_16x16x32_bf16 a[128:131], a[160:163], v[168:171], a[128:131]
    ds_write_b64 v114, v[32:33] offset:0
    v_mfma_f32_16x16x32_bf16 a[128:131], a[164:167], v[172:175], a[128:131]
    v_accvgpr_read_b32 v36, a100
    v_accvgpr_read_b32 v37, a101
    v_accvgpr_read_b32 v38, a102
    v_accvgpr_read_b32 v39, a103
    v_pk_mul_f32 v[36:37], v[36:37], v[112:113] op_sel_hi:[1,0]
    v_pk_mul_f32 v[38:39], v[38:39], v[112:113] op_sel_hi:[1,0]
    v_cvt_pk_bf16_f32 v36, v36, v37
    v_cvt_pk_bf16_f32 v37, v38, v39
    v_mfma_f32_16x16x32_bf16 a[132:135], a[168:171], v[172:175], a[132:135]
    ds_write_b64 v115, v[36:37] offset:0
    v_mfma_f32_16x16x32_bf16 a[132:135], a[172:175], v[168:171], a[132:135]
    v_accvgpr_read_b32 v40, a104
    v_accvgpr_read_b32 v41, a105
    v_accvgpr_read_b32 v42, a106
    v_accvgpr_read_b32 v43, a107
    v_pk_mul_f32 v[40:41], v[40:41], v[112:113] op_sel_hi:[1,0]
    v_pk_mul_f32 v[42:43], v[42:43], v[112:113] op_sel_hi:[1,0]
    v_cvt_pk_bf16_f32 v40, v40, v41
    v_cvt_pk_bf16_f32 v41, v42, v43
    v_mfma_f32_16x16x32_bf16 a[136:139], a[176:179], v[168:171], a[136:139]
    ds_write_b64 v116, v[40:41] offset:0
    v_mfma_f32_16x16x32_bf16 a[136:139], a[180:183], v[172:175], a[136:139]
    v_accvgpr_read_b32 v44, a108
    v_accvgpr_read_b32 v45, a109
    v_accvgpr_read_b32 v46, a110
    v_accvgpr_read_b32 v47, a111
    v_pk_mul_f32 v[44:45], v[44:45], v[112:113] op_sel_hi:[1,0]
    v_pk_mul_f32 v[46:47], v[46:47], v[112:113] op_sel_hi:[1,0]
    v_cvt_pk_bf16_f32 v44, v44, v45
    v_cvt_pk_bf16_f32 v45, v46, v47
    v_mfma_f32_16x16x32_bf16 a[140:143], a[184:187], v[172:175], a[140:143]
    ds_write_b64 v117, v[44:45] offset:0
    v_mfma_f32_16x16x32_bf16 a[140:143], a[188:191], v[168:171], a[140:143]
    v_accvgpr_read_b32 v32, a112
    v_accvgpr_read_b32 v33, a113
    v_accvgpr_read_b32 v34, a114
    v_accvgpr_read_b32 v35, a115
    v_pk_mul_f32 v[32:33], v[32:33], v[112:113] op_sel_hi:[1,0]
    v_pk_mul_f32 v[34:35], v[34:35], v[112:113] op_sel_hi:[1,0]
    v_cvt_pk_bf16_f32 v32, v32, v33
    v_cvt_pk_bf16_f32 v33, v34, v35
    v_mfma_f32_16x16x32_bf16 a[144:147], a[192:195], v[168:171], a[144:147]
    ds_write_b64 v114, v[32:33] offset:128
    v_mfma_f32_16x16x32_bf16 a[144:147], a[196:199], v[172:175], a[144:147]
    v_accvgpr_read_b32 v36, a116
    v_accvgpr_read_b32 v37, a117
    v_accvgpr_read_b32 v38, a118
    v_accvgpr_read_b32 v39, a119
    v_pk_mul_f32 v[36:37], v[36:37], v[112:113] op_sel_hi:[1,0]
    v_pk_mul_f32 v[38:39], v[38:39], v[112:113] op_sel_hi:[1,0]
    v_cvt_pk_bf16_f32 v36, v36, v37
    v_cvt_pk_bf16_f32 v37, v38, v39
    v_mfma_f32_16x16x32_bf16 a[148:151], a[200:203], v[172:175], a[148:151]
    ds_write_b64 v115, v[36:37] offset:128
    v_mfma_f32_16x16x32_bf16 a[148:151], a[204:207], v[168:171], a[148:151]
    v_accvgpr_read_b32 v40, a120
    v_accvgpr_read_b32 v41, a121
    v_accvgpr_read_b32 v42, a122
    v_accvgpr_read_b32 v43, a123
    v_pk_mul_f32 v[40:41], v[40:41], v[112:113] op_sel_hi:[1,0]
    v_pk_mul_f32 v[42:43], v[42:43], v[112:113] op_sel_hi:[1,0]
    v_cvt_pk_bf16_f32 v40, v40, v41
    v_cvt_pk_bf16_f32 v41, v42, v43
    v_mfma_f32_16x16x32_bf16 a[152:155], a[208:211], v[168:171], a[152:155]
    ds_write_b64 v116, v[40:41] offset:128
    v_mfma_f32_16x16x32_bf16 a[152:155], a[212:215], v[172:175], a[152:155]
    v_accvgpr_read_b32 v44, a124
    v_accvgpr_read_b32 v45, a125
    v_accvgpr_read_b32 v46, a126
    v_accvgpr_read_b32 v47, a127
    v_pk_mul_f32 v[44:45], v[44:45], v[112:113] op_sel_hi:[1,0]
    v_pk_mul_f32 v[46:47], v[46:47], v[112:113] op_sel_hi:[1,0]
    v_cvt_pk_bf16_f32 v44, v44, v45
    v_cvt_pk_bf16_f32 v45, v46, v47
    v_mfma_f32_16x16x32_bf16 a[156:159], a[216:219], v[172:175], a[156:159]
    ds_write_b64 v117, v[44:45] offset:128
    ds_read_b128 v[48:51], v118 offset:0
    ds_read_b128 v[52:55], v119 offset:1024
    ds_read_b128 v[56:59], v118 offset:2048
    ds_read_b128 v[60:63], v119 offset:3072
    v_mfma_f32_16x16x32_bf16 a[156:159], a[220:223], v[168:171], a[156:159]
    v_add_f32 v252, v252, v253
    v_rcp_f32 v112, v252
    v_cmp_ngt_f32 vcc, s62, v252
    s_or_b64 s[56:57], s[56:57], vcc
    v_accvgpr_read_b32 v32, a128
    v_accvgpr_read_b32 v33, a129
    v_accvgpr_read_b32 v34, a130
    v_accvgpr_read_b32 v35, a131
    v_pk_mul_f32 v[32:33], v[32:33], v[112:113] op_sel_hi:[1,0]
    v_pk_mul_f32 v[34:35], v[34:35], v[112:113] op_sel_hi:[1,0]
    v_cvt_pk_bf16_f32 v32, v32, v33
    v_cvt_pk_bf16_f32 v33, v34, v35
    v_accvgpr_read_b32 v36, a132
    v_accvgpr_read_b32 v37, a133
    v_accvgpr_read_b32 v38, a134
    v_accvgpr_read_b32 v39, a135
    v_pk_mul_f32 v[36:37], v[36:37], v[112:113] op_sel_hi:[1,0]
    v_pk_mul_f32 v[38:39], v[38:39], v[112:113] op_sel_hi:[1,0]
    v_cvt_pk_bf16_f32 v36, v36, v37
    v_cvt_pk_bf16_f32 v37, v38, v39
    v_accvgpr_read_b32 v40, a136
    v_accvgpr_read_b32 v41, a137
    v_accvgpr_read_b32 v42, a138
    v_accvgpr_read_b32 v43, a139
    v_pk_mul_f32 v[40:41], v[40:41], v[112:113] op_sel_hi:[1,0]
    v_pk_mul_f32 v[42:43], v[42:43], v[112:113] op_sel_hi:[1,0]
    v_cvt_pk_bf16_f32 v40, v40, v41
    v_cvt_pk_bf16_f32 v41, v42, v43
    v_accvgpr_read_b32 v44, a140
    v_accvgpr_read_b32 v45, a141
    v_accvgpr_read_b32 v46, a142
    v_accvgpr_read_b32 v47, a143
    v_pk_mul_f32 v[44:45], v[44:45], v[112:113] op_sel_hi:[1,0]
    v_pk_mul_f32 v[46:47], v[46:47], v[112:113] op_sel_hi:[1,0]
    v_cvt_pk_bf16_f32 v44, v44, v45
    v_cvt_pk_bf16_f32 v45, v46, v47
    s_waitcnt lgkmcnt(0)
    buffer_store_dwordx4 v[48:51], v18, s[20:23], s40 offen offset:3072 sc1 nt
    buffer_store_dwordx4 v[52:55], v18, s[20:23], s41 offen offset:3072 sc1 nt
    buffer_store_dwordx4 v[56:59], v18, s[20:23], s42 offen offset:3072 sc1 nt
    buffer_store_dwordx4 v[60:63], v18, s[20:23], s43 offen offset:3072 sc1 nt
    ds_write_b64 v114, v[32:33] offset:0
    ds_write_b64 v115, v[36:37] offset:0
    ds_write_b64 v116, v[40:41] offset:0
    ds_write_b64 v117, v[44:45] offset:0
    v_accvgpr_read_b32 v32, a144
    v_accvgpr_read_b32 v33, a145
    v_accvgpr_read_b32 v34, a146
    v_accvgpr_read_b32 v35, a147
    v_pk_mul_f32 v[32:33], v[32:33], v[112:113] op_sel_hi:[1,0]
    v_pk_mul_f32 v[34:35], v[34:35], v[112:113] op_sel_hi:[1,0]
    v_cvt_pk_bf16_f32 v32, v32, v33
    v_cvt_pk_bf16_f32 v33, v34, v35
    v_accvgpr_read_b32 v36, a148
    v_accvgpr_read_b32 v37, a149
    v_accvgpr_read_b32 v38, a150
    v_accvgpr_read_b32 v39, a151
    v_pk_mul_f32 v[36:37], v[36:37], v[112:113] op_sel_hi:[1,0]
    v_pk_mul_f32 v[38:39], v[38:39], v[112:113] op_sel_hi:[1,0]
    v_cvt_pk_bf16_f32 v36, v36, v37
    v_cvt_pk_bf16_f32 v37, v38, v39
    v_accvgpr_read_b32 v40, a152
    v_accvgpr_read_b32 v41, a153
    v_accvgpr_read_b32 v42, a154
    v_accvgpr_read_b32 v43, a155
    v_pk_mul_f32 v[40:41], v[40:41], v[112:113] op_sel_hi:[1,0]
    v_pk_mul_f32 v[42:43], v[42:43], v[112:113] op_sel_hi:[1,0]
    v_cvt_pk_bf16_f32 v40, v40, v41
    v_cvt_pk_bf16_f32 v41, v42, v43
    v_accvgpr_read_b32 v44, a156
    v_accvgpr_read_b32 v45, a157
    v_accvgpr_read_b32 v46, a158
    v_accvgpr_read_b32 v47, a159
    v_pk_mul_f32 v[44:45], v[44:45], v[112:113] op_sel_hi:[1,0]
    v_pk_mul_f32 v[46:47], v[46:47], v[112:113] op_sel_hi:[1,0]
    v_cvt_pk_bf16_f32 v44, v44, v45
    v_cvt_pk_bf16_f32 v45, v46, v47
    ds_write_b64 v114, v[32:33] offset:128
    ds_write_b64 v115, v[36:37] offset:128
    ds_write_b64 v116, v[40:41] offset:128
    ds_write_b64 v117, v[44:45] offset:128
    ds_read_b128 v[48:51], v118 offset:0
    ds_read_b128 v[52:55], v119 offset:1024
    ds_read_b128 v[56:59], v118 offset:2048
    ds_read_b128 v[60:63], v119 offset:3072
    s_waitcnt lgkmcnt(3)
    buffer_store_dwordx4 v[48:51], v18, s[20:23], s55 offen sc1 nt
    s_waitcnt lgkmcnt(2)
    buffer_store_dwordx4 v[52:55], v18, s[20:23], s55 offen offset:1024 sc1 nt
    s_waitcnt lgkmcnt(1)
    buffer_store_dwordx4 v[56:59], v18, s[20:23], s55 offen offset:2048 sc1 nt
    s_waitcnt lgkmcnt(0)
    buffer_store_dwordx4 v[60:63], v18, s[20:23], s55 offen offset:3072 sc1 nt
    s_cmp_lg_u64 s[56:57], 0
    s_cselect_b32 s54, 2, 0
    s_or_b32 s45, s45, s54
    s_branch L_epidone
L_out5:
    s_cmp_lt_u32 s37, 16
    s_cbranch_scc1 L_last5
    v_smfmac_f32_16x16x64_bf16 v[252:255], v[132:135], v[168:175], v0
    v_xor_b32 v180, 0, v14
    v_xor_b32 v181, 64, v14
    v_xor_b32 v182, 128, v14
    v_xor_b32 v183, 192, v14
    v_mfma_f32_16x16x32_bf16 a[128:131], a[160:163], v[168:171], a[128:131]
    ds_read_b128 v[32:35], v180
    ds_read_b128 v[36:39], v181
    v_mfma_f32_16x16x32_bf16 a[128:131], a[164:167], v[172:175], a[128:131]
    ds_read_b128 v[40:43], v182
    ds_read_b128 v[44:47], v183
    v_mfma_f32_16x16x32_bf16 a[132:135], a[168:171], v[172:175], a[132:135]
    ds_read_b128 v[48:51], v180 offset:1024
    ds_read_b128 v[52:55], v181 offset:1024
    v_mfma_f32_16x16x32_bf16 a[132:135], a[172:175], v[168:171], a[132:135]
    ds_read_b128 v[56:59], v182 offset:1024
    ds_read_b128 v[60:63], v183 offset:1024
    v_mfma_f32_16x16x32_bf16 a[136:139], a[176:179], v[168:171], a[136:139]
    ds_read_b128 v[64:67], v180 offset:2048
    ds_read_b128 v[68:71], v181 offset:2048
    v_mfma_f32_16x16x32_bf16 a[136:139], a[180:183], v[172:175], a[136:139]
    ds_read_b128 v[72:75], v182 offset:2048
    ds_read_b128 v[76:79], v183 offset:2048
    v_mfma_f32_16x16x32_bf16 a[140:143], a[184:187], v[172:175], a[140:143]
    ds_read_b128 v[80:83], v180 offset:3072
    ds_read_b128 v[84:87], v181 offset:3072
    v_mfma_f32_16x16x32_bf16 a[140:143], a[188:191], v[168:171], a[140:143]
    ds_read_b128 v[88:91], v182 offset:3072
    ds_read_b128 v[92:95], v183 offset:3072
    v_mfma_f32_16x16x32_bf16 a[144:147], a[192:195], v[168:171], a[144:147]
    v_mov_b32 v132, 0
    v_mov_b32 v133, 0
    v_mov_b32 v134, 0
    v_mov_b32 v135, 0
    v_add_f32 v20, v20, v21
    v_mfma_f32_16x16x32_bf16 a[144:147], a[196:199], v[172:175], a[144:147]
    v_add_f32 v24, v24, v25
    v_add_f32 v28, v28, v29
    v_add_f32 v248, v248, v249
    v_add_f32 v252, v252, v253
    v_rcp_f32 v112, v20
    v_mfma_f32_16x16x32_bf16 a[148:151], a[200:203], v[172:175], a[148:151]
    v_rcp_f32 v114, v24
    v_rcp_f32 v116, v28
    v_rcp_f32 v118, v248
    v_rcp_f32 v120, v252
    v_cmp_ngt_f32 s[56:57], s62, v20
    v_mfma_f32_16x16x32_bf16 a[148:151], a[204:207], v[168:171], a[148:151]
    v_cmp_ngt_f32 vcc, s62, v24
    s_or_b64 s[56:57], s[56:57], vcc
    v_cmp_ngt_f32 vcc, s62, v28
    s_or_b64 s[56:57], s[56:57], vcc
    v_cmp_ngt_f32 vcc, s62, v248
    v_mfma_f32_16x16x32_bf16 a[152:155], a[208:211], v[168:171], a[152:155]
    s_or_b64 s[56:57], s[56:57], vcc
    v_cmp_ngt_f32 vcc, s62, v252
    s_or_b64 s[56:57], s[56:57], vcc
    s_cmp_lg_u64 s[56:57], 0
    s_cselect_b32 s54, 1, 0
    v_mfma_f32_16x16x32_bf16 a[152:155], a[212:215], v[172:175], a[152:155]
    s_lshl_b32 s54, s54, s64
    s_cmp_eq_u32 s46, 0
    s_cselect_b32 s54, s54, 0
    s_or_b32 s45, s45, s54
    s_add_u32 s55, s36, 65536
    v_mfma_f32_16x16x32_bf16 a[156:159], a[216:219], v[172:175], a[156:159]
    s_lshl_b32 s54, s3, 1
    s_add_u32 s54, s54, s64
    s_mul_i32 s54, s54, 77824
    s_add_u32 s20, s10, s54
    s_addc_u32 s21, s11, 0
    v_mfma_f32_16x16x32_bf16 a[156:159], a[220:223], v[168:171], a[156:159]
    s_waitcnt vmcnt(0)
    s_mov_b32 s49, 1
    s_branch L_trans
L_ent4:
    s_cmp_eq_u32 s49, 0
    s_cbranch_scc0 L_loop4_1
.p2align 6
L_loop4_0:
    v_mfma_f32_16x16x32_bf16 v[144:147], v[216:219], v[32:35], v[112:115]
    s_waitcnt lgkmcnt(0)
    v_mfma_f32_16x16x32_bf16 v[144:147], v[220:223], v[36:39], v[144:147]
    v_exp_f32 v136, v136
    v_mfma_f32_16x16x32_bf16 v[144:147], v[224:227], v[40:43], v[144:147]
    v_mfma_f32_16x16x32_bf16 v[144:147], v[228:231], v[44:47], v[144:147]
    v_exp_f32 v137, v137
    v_mfma_f32_16x16x32_bf16 v[148:151], v[232:235], v[44:47], v[112:115]
    v_cvt_pk_bf16_f32 v136, v136, v137
    v_mfma_f32_16x16x32_bf16 v[148:151], v[236:239], v[40:43], v[148:151]
    v_exp_f32 v138, v138
    v_mfma_f32_16x16x32_bf16 v[148:151], v[240:243], v[36:39], v[148:151]
    v_mfma_f32_16x16x32_bf16 v[148:151], v[244:247], v[32:35], v[148:151]
    v_exp_f32 v139, v139
    v_mfma_f32_16x16x32_bf16 a[96:99], a[160:163], v[168:171], a[96:99]
    ds_read_b64_tr_b16 a[160:161], v6
    v_cvt_pk_bf16_f32 v137, v138, v139
    v_mfma_f32_16x16x32_bf16 a[96:99], a[164:167], v[172:175], a[96:99]
    v_exp_f32 v140, v140
    v_mfma_f32_16x16x32_bf16 a[100:103], a[168:171], v[172:175], a[100:103]
    ds_read_b64_tr_b16 a[162:163], v6 offset:1024
    ds_read_b64_tr_b16 a[164:165], v6 offset:2048
    v_mfma_f32_16x16x32_bf16 a[100:103], a[172:175], v[168:171], a[100:103]
    v_exp_f32 v141, v141
    v_mfma_f32_16x16x32_bf16 a[104:107], a[176:179], v[168:171], a[104:107]
    ds_read_b64_tr_b16 a[166:167], v6 offset:3072
    v_cvt_pk_bf16_f32 v138, v140, v141
    v_mfma_f32_16x16x32_bf16 a[104:107], a[180:183], v[172:175], a[104:107]
    v_exp_f32 v142, v142
    v_mfma_f32_16x16x32_bf16 a[108:111], a[184:187], v[172:175], a[108:111]
    ds_read_b64_tr_b16 a[168:169], v7 offset:2048
    ds_read_b64_tr_b16 a[170:171], v7 offset:3072
    v_mfma_f32_16x16x32_bf16 a[108:111], a[188:191], v[168:171], a[108:111]
    v_exp_f32 v143, v143
    v_mfma_f32_16x16x32_bf16 a[112:115], a[192:195], v[168:171], a[112:115]
    ds_read_b64_tr_b16 a[172:173], v7
    v_cvt_pk_bf16_f32 v139, v142, v143
    v_mfma_f32_16x16x32_bf16 a[112:115], a[196:199], v[172:175], a[112:115]
    v_exp_f32 v144, v144
    v_mfma_f32_16x16x32_bf16 a[116:119], a[200:203], v[172:175], a[116:119]
    s_lshr_b32 s54, s58, 2
    ds_read_b64_tr_b16 a[174:175], v7 offset:1024
    ds_read_b64_tr_b16 a[176:177], v8
    v_mfma_f32_16x16x32_bf16 a[116:119], a[204:207], v[168:171], a[116:119]
    s_mul_i32 s54, s54, 12288
    v_exp_f32 v145, v145
    v_mfma_f32_16x16x32_bf16 a[120:123], a[208:211], v[168:171], a[120:123]
    s_lshl_b32 s29, s58, 10
    ds_read_b64_tr_b16 a[178:179], v8 offset:1024
    v_cvt_pk_bf16_f32 v140, v144, v145
    v_mfma_f32_16x16x32_bf16 a[120:123], a[212:215], v[172:175], a[120:123]
    s_add_u32 s29, s29, s54
    v_exp_f32 v146, v146
    v_mfma_f32_16x16x32_bf16 a[124:127], a[216:219], v[172:175], a[124:127]
    s_add_u32 s58, s58, 4
    ds_read_b64_tr_b16 a[180:181], v8 offset:2048
    ds_read_b64_tr_b16 a[182:183], v8 offset:3072
    v_mfma_f32_16x16x32_bf16 a[124:127], a[220:223], v[168:171], a[124:127]
    s_cmp_lt_u32 s37, s31
    v_exp_f32 v147, v147
    v_smfmac_f32_16x16x64_bf16 v[248:251], v[132:135], v[168:175], v0
    s_cselect_b32 s14, s33, 0
    ds_read_b64_tr_b16 a[184:185], v9 offset:2048
    v_cvt_pk_bf16_f32 v141, v146, v147
    v_mfma_f32_16x16x32_bf16 v[152:155], v[184:187], v[48:51], v[116:119]
    s_mov_b32 s18, s14
    v_exp_f32 v148, v148
    v_mfma_f32_16x16x32_bf16 v[152:155], v[188:191], v[52:55], v[152:155]
    ds_read_b64_tr_b16 a[186:187], v9 offset:3072
    ds_read_b64_tr_b16 a[188:189], v9
    v_mfma_f32_16x16x32_bf16 v[152:155], v[192:195], v[56:59], v[152:155]
    v_exp_f32 v149, v149
    v_mfma_f32_16x16x32_bf16 v[152:155], v[196:199], v[60:63], v[152:155]
    ds_read_b64_tr_b16 a[190:191], v9 offset:1024
    v_cvt_pk_bf16_f32 v142, v148, v149
    v_mfma_f32_16x16x32_bf16 v[156:159], v[200:203], v[60:63], v[116:119]
    v_exp_f32 v150, v150
    v_mfma_f32_16x16x32_bf16 v[156:159], v[204:207], v[56:59], v[156:159]
    ds_read_b64_tr_b16 a[192:193], v10
    ds_read_b64_tr_b16 a[194:195], v10 offset:1024
    v_mfma_f32_16x16x32_bf16 v[156:159], v[208:211], v[52:55], v[156:159]
    v_exp_f32 v151, v151
    v_mfma_f32_16x16x32_bf16 v[156:159], v[212:215], v[48:51], v[156:159]
    ds_read_b64_tr_b16 a[196:197], v10 offset:2048
    v_cvt_pk_bf16_f32 v143, v150, v151
    v_mfma_f32_16x16x32_bf16 v[160:163], v[216:219], v[48:51], v[116:119]
    ds_read_b64_tr_b16 a[198:199], v10 offset:3072
    ds_read_b64_tr_b16 a[200:201], v11 offset:2048
    v_mfma_f32_16x16x32_bf16 v[160:163], v[220:223], v[52:55], v[160:163]
    v_exp_f32 v152, v152
    v_mfma_f32_16x16x32_bf16 v[160:163], v[224:227], v[56:59], v[160:163]
    ds_read_b64_tr_b16 a[202:203], v11 offset:3072
    ds_read_b64_tr_b16 a[204:205], v11
    v_mfma_f32_16x16x32_bf16 v[160:163], v[228:231], v[60:63], v[160:163]
    v_exp_f32 v153, v153
    v_mfma_f32_16x16x32_bf16 v[164:167], v[232:235], v[60:63], v[116:119]
    ds_read_b64_tr_b16 a[206:207], v11 offset:1024
    v_cvt_pk_bf16_f32 v152, v152, v153
    v_mfma_f32_16x16x32_bf16 v[164:167], v[236:239], v[56:59], v[164:167]
    v_exp_f32 v154, v154
    v_mfma_f32_16x16x32_bf16 v[164:167], v[240:243], v[52:55], v[164:167]
    ds_read_b64_tr_b16 a[208:209], v12
    ds_read_b64_tr_b16 a[210:211], v12 offset:1024
    v_mfma_f32_16x16x32_bf16 v[164:167], v[244:247], v[48:51], v[164:167]
    s_waitcnt lgkmcnt(7)
    v_exp_f32 v155, v155
    v_mfma_f32_16x16x32_bf16 a[0:3], a[160:163], v[136:139], a[0:3]
    ds_read_b64_tr_b16 a[212:213], v12 offset:2048
    v_cvt_pk_bf16_f32 v153, v154, v155
    v_mfma_f32_16x16x32_bf16 a[0:3], a[164:167], v[140:143], a[0:3]
    v_exp_f32 v156, v156
    v_mfma_f32_16x16x32_bf16 a[4:7], a[168:171], v[140:143], a[4:7]
    ds_read_b64_tr_b16 a[214:215], v12 offset:3072
    ds_read_b64_tr_b16 a[216:217], v13 offset:2048
    v_mfma_f32_16x16x32_bf16 a[4:7], a[172:175], v[136:139], a[4:7]
    v_exp_f32 v157, v157
    v_mfma_f32_16x16x32_bf16 a[8:11], a[176:179], v[136:139], a[8:11]
    ds_read_b64_tr_b16 a[218:219], v13 offset:3072
    v_cvt_pk_bf16_f32 v154, v156, v157
    v_mfma_f32_16x16x32_bf16 a[8:11], a[180:183], v[140:143], a[8:11]
    v_exp_f32 v158, v158
    v_mfma_f32_16x16x32_bf16 a[12:15], a[184:187], v[140:143], a[12:15]
    ds_read_b64_tr_b16 a[220:221], v13
    ds_read_b64_tr_b16 a[222:223], v13 offset:1024
    v_mfma_f32_16x16x32_bf16 a[12:15], a[188:191], v[136:139], a[12:15]
    v_exp_f32 v159, v159
    v_mfma_f32_16x16x32_bf16 a[16:19], a[192:195], v[136:139], a[16:19]
    s_waitcnt lgkmcnt(5)
    v_cvt_pk_bf16_f32 v155, v158, v159
    v_mfma_f32_16x16x32_bf16 a[16:19], a[196:199], v[140:143], a[16:19]
    v_exp_f32 v160, v160
    v_mfma_f32_16x16x32_bf16 a[20:23], a[200:203], v[140:143], a[20:23]
    v_mfma_f32_16x16x32_bf16 a[20:23], a[204:207], v[136:139], a[20:23]
    v_exp_f32 v161, v161
    v_mfma_f32_16x16x32_bf16 a[24:27], a[208:211], v[136:139], a[24:27]
    s_waitcnt lgkmcnt(2)
    v_cvt_pk_bf16_f32 v156, v160, v161
    v_mfma_f32_16x16x32_bf16 a[24:27], a[212:215], v[140:143], a[24:27]
    v_exp_f32 v162, v162
    v_mfma_f32_16x16x32_bf16 a[28:31], a[216:219], v[140:143], a[28:31]
    s_waitcnt lgkmcnt(0)
    v_mfma_f32_16x16x32_bf16 a[28:31], a[220:223], v[136:139], a[28:31]
    s_waitcnt vmcnt(32) lgkmcnt(0)
    s_cmp_lt_u32 s37, s44
    s_cbranch_scc1 L_odd40
    s_waitcnt vmcnt(8)
L_odd40:
    v_exp_f32 v163, v163
    v_smfmac_f32_16x16x64_bf16 v[20:23], v[132:135], v[136:143], v0
    s_barrier
    v_cvt_pk_bf16_f32 v157, v162, v163
    v_mfma_f32_16x16x32_bf16 v[136:139], v[184:187], v[64:67], v[120:123]
    s_sub_u32 s54, s37, 0
    s_cmp_ge_u32 s54, s32
    s_cbranch_scc1 L_noq40
    s_add_u32 m0, s29, 98304
    s_nop 0
    buffer_load_dwordx4 v100, s[24:27], s29 offen nt lds
    buffer_load_dwordx4 v100, s[24:27], s29 offen offset:1024 nt lds
    buffer_load_dwordx4 v100, s[24:27], s29 offen offset:2048 nt lds
    buffer_load_dwordx4 v100, s[24:27], s29 offen offset:3072 nt lds
    s_add_u32 m0, s29, 102400
    s_nop 0
    buffer_load_dwordx4 v101, s[24:27], s29 offen nt lds
    buffer_load_dwordx4 v101, s[24:27], s29 offen offset:1024 nt lds
    buffer_load_dwordx4 v101, s[24:27], s29 offen offset:2048 nt lds
    buffer_load_dwordx4 v101, s[24:27], s29 offen offset:3072 nt lds
    s_add_u32 m0, s29, 106496
    s_nop 0
    buffer_load_dwordx4 v102, s[24:27], s29 offen nt lds
    buffer_load_dwordx4 v102, s[24:27], s29 offen offset:1024 nt lds
    buffer_load_dwordx4 v102, s[24:27], s29 offen offset:2048 nt lds
    buffer_load_dwordx4 v102, s[24:27], s29 offen offset:3072 nt lds
    s_add_u32 m0, s29, 110592
    s_nop 0
    buffer_load_dwordx4 v103, s[24:27], s29 offen nt lds
    buffer_load_dwordx4 v103, s[24:27], s29 offen offset:1024 nt lds
    buffer_load_dwordx4 v103, s[24:27], s29 offen offset:2048 nt lds
    buffer_load_dwordx4 v103, s[24:27], s29 offen offset:3072 nt lds
L_noq40:
    v_exp_f32 v164, v164
    v_mfma_f32_16x16x32_bf16 v[136:139], v[188:191], v[68:71], v[136:139]
    s_mov_b32 m0, 0
    s_add_u32 s38, s28, 0
    v_mfma_f32_16x16x32_bf16 v[136:139], v[192:195], v[72:75], v[136:139]
    buffer_load_dwordx4 v108, s[12:15], s38 offen nt lds
    v_exp_f32 v165, v165
    v_mfma_f32_16x16x32_bf16 v[136:139], v[196:199], v[76:79], v[136:139]
    s_mov_b32 m0, 1024
    s_add_u32 s38, s28, 16384
    v_cvt_pk_bf16_f32 v158, v164, v165
    v_mfma_f32_16x16x32_bf16 v[140:143], v[200:203], v[76:79], v[120:123]
    buffer_load_dwordx4 v108, s[12:15], s38 offen nt lds
    v_exp_f32 v166, v166
    v_mfma_f32_16x16x32_bf16 v[140:143], v[204:207], v[72:75], v[140:143]
    s_mov_b32 m0, 2048
    s_add_u32 s38, s28, 32768
    v_mfma_f32_16x16x32_bf16 v[140:143], v[208:211], v[68:71], v[140:143]
    buffer_load_dwordx4 v108, s[12:15], s38 offen nt lds
    v_exp_f32 v167, v167
    v_mfma_f32_16x16x32_bf16 v[140:143], v[212:215], v[64:67], v[140:143]
    s_mov_b32 m0, 3072
    s_add_u32 s38, s28, 49152
    v_cvt_pk_bf16_f32 v159, v166, v167
    v_mfma_f32_16x16x32_bf16 v[144:147], v[216:219], v[64:67], v[120:123]
    buffer_load_dwordx4 v108, s[12:15], s38 offen nt lds
    v_mfma_f32_16x16x32_bf16 v[144:147], v[220:223], v[68:71], v[144:147]
    s_mov_b32 m0, 4096
    s_add_u32 s38, s28, 65536
    v_exp_f32 v136, v136
    v_mfma_f32_16x16x32_bf16 v[144:147], v[224:227], v[72:75], v[144:147]
    buffer_load_dwordx4 v109, s[12:15], s38 offen nt lds
    v_mfma_f32_16x16x32_bf16 v[144:147], v[228:231], v[76:79], v[144:147]
    s_mov_b32 m0, 5120
    s_add_u32 s38, s28, 81920
    v_exp_f32 v137, v137
    v_mfma_f32_16x16x32_bf16 v[148:151], v[232:235], v[76:79], v[120:123]
    buffer_load_dwordx4 v109, s[12:15], s38 offen nt lds
    v_cvt_pk_bf16_f32 v136, v136, v137
    v_mfma_f32_16x16x32_bf16 v[148:151], v[236:239], v[72:75], v[148:151]
    s_mov_b32 m0, 6144
    s_add_u32 s38, s28, 98304
    v_exp_f32 v138, v138
    v_mfma_f32_16x16x32_bf16 v[148:151], v[240:243], v[68:71], v[148:151]
    buffer_load_dwordx4 v109, s[12:15], s38 offen nt lds
    v_mfma_f32_16x16x32_bf16 v[148:151], v[244:247], v[64:67], v[148:151]
    s_mov_b32 m0, 7168
    s_add_u32 s38, s28, 114688
    v_exp_f32 v139, v139
    v_mfma_f32_16x16x32_bf16 a[32:35], a[160:163], v[152:155], a[32:35]
    buffer_load_dwordx4 v109, s[12:15], s38 offen nt lds
    v_cvt_pk_bf16_f32 v137, v138, v139
    v_mfma_f32_16x16x32_bf16 a[32:35], a[164:167], v[156:159], a[32:35]
    s_mov_b32 m0, 8192
    s_add_u32 s38, s28, 131072
    v_exp_f32 v140, v140
    v_mfma_f32_16x16x32_bf16 a[36:39], a[168:171], v[156:159], a[36:39]
    buffer_load_dwordx4 v110, s[12:15], s38 offen nt lds
    v_mfma_f32_16x16x32_bf16 a[36:39], a[172:175], v[152:155], a[36:39]
    s_mov_b32 m0, 9216
    s_add_u32 s38, s28, 147456
    v_exp_f32 v141, v141
    v_mfma_f32_16x16x32_bf16 a[40:43], a[176:179], v[152:155], a[40:43]
    buffer_load_dwordx4 v110, s[12:15], s38 offen nt lds
    v_cvt_pk_bf16_f32 v138, v140, v141
    v_mfma_f32_16x16x32_bf16 a[40:43], a[180:183], v[156:159], a[40:43]
    s_mov_b32 m0, 10240
    s_add_u32 s38, s28, 163840
    v_exp_f32 v142, v142
    v_mfma_f32_16x16x32_bf16 a[44:47], a[184:187], v[156:159], a[44:47]
    buffer_load_dwordx4 v110, s[12:15], s38 offen nt lds
    v_mfma_f32_16x16x32_bf16 a[44:47], a[188:191], v[152:155], a[44:47]
    s_mov_b32 m0, 11264
    s_add_u32 s38, s28, 180224
    v_exp_f32 v143, v143
    v_mfma_f32_16x16x32_bf16 a[48:51], a[192:195], v[152:155], a[48:51]
    buffer_load_dwordx4 v110, s[12:15], s38 offen nt lds
    v_cvt_pk_bf16_f32 v139, v142, v143
    v_mfma_f32_16x16x32_bf16 a[48:51], a[196:199], v[156:159], a[48:51]
    s_mov_b32 m0, 12288
    s_add_u32 s38, s28, 196608
    v_exp_f32 v144, v144
    v_mfma_f32_16x16x32_bf16 a[52:55], a[200:203], v[156:159], a[52:55]
    buffer_load_dwordx4 v111, s[12:15], s38 offen nt lds
    v_mfma_f32_16x16x32_bf16 a[52:55], a[204:207], v[152:155], a[52:55]
    s_mov_b32 m0, 13312
    s_add_u32 s38, s28, 212992
    v_exp_f32 v145, v145
    v_mfma_f32_16x16x32_bf16 a[56:59], a[208:211], v[152:155], a[56:59]
    buffer_load_dwordx4 v111, s[12:15], s38 offen nt lds
    v_cvt_pk_bf16_f32 v140, v144, v145
    v_mfma_f32_16x16x32_bf16 a[56:59], a[212:215], v[156:159], a[56:59]
    s_mov_b32 m0, 14336
    s_add_u32 s38, s28, 229376
    v_exp_f32 v146, v146
    v_mfma_f32_16x16x32_bf16 a[60:63], a[216:219], v[156:159], a[60:63]
    buffer_load_dwordx4 v111, s[12:15], s38 offen nt lds
    v_mfma_f32_16x16x32_bf16 a[60:63], a[220:223], v[152:155], a[60:63]
    s_mov_b32 m0, 15360
    s_add_u32 s38, s28, 245760
    v_exp_f32 v147, v147
    v_smfmac_f32_16x16x64_bf16 v[24:27], v[132:135], v[152:159], v0
    buffer_load_dwordx4 v111, s[12:15], s38 offen nt lds
    v_cvt_pk_bf16_f32 v141, v146, v147
    v_mfma_f32_16x16x32_bf16 v[168:171], v[184:187], v[80:83], v[124:127]
    s_mov_b32 m0, 49152
    s_add_u32 s38, s28, 0
    v_exp_f32 v148, v148
    v_mfma_f32_16x16x32_bf16 v[168:171], v[188:191], v[84:87], v[168:171]
    buffer_load_dwordx4 v108, s[16:19], s38 offen nt lds
    ds_read_b128 v[184:187], v2 offset:16384
    v_mfma_f32_16x16x32_bf16 v[168:171], v[192:195], v[88:91], v[168:171]
    s_mov_b32 m0, 50176
    s_add_u32 s38, s28, 16384
    v_exp_f32 v149, v149
    v_mfma_f32_16x16x32_bf16 v[168:171], v[196:199], v[92:95], v[168:171]
    buffer_load_dwordx4 v108, s[16:19], s38 offen nt lds
    ds_read_b128 v[188:191], v3 offset:16384
    v_cvt_pk_bf16_f32 v142, v148, v149
    v_mfma_f32_16x16x32_bf16 v[172:175], v[200:203], v[92:95], v[124:127]
    s_mov_b32 m0, 51200
    s_add_u32 s38, s28, 32768
    v_exp_f32 v150, v150
    v_mfma_f32_16x16x32_bf16 v[172:175], v[204:207], v[88:91], v[172:175]
    buffer_load_dwordx4 v108, s[16:19], s38 offen nt lds
    ds_read_b128 v[192:195], v4 offset:16384
    v_mfma_f32_16x16x32_bf16 v[172:175], v[208:211], v[84:87], v[172:175]
    s_mov_b32 m0, 52224
    s_add_u32 s38, s28, 49152
    v_exp_f32 v151, v151
    v_mfma_f32_16x16x32_bf16 v[172:175], v[212:215], v[80:83], v[172:175]
    buffer_load_dwordx4 v108, s[16:19], s38 offen nt lds
    ds_read_b128 v[196:199], v5 offset:16384
    v_cvt_pk_bf16_f32 v143, v150, v151
    v_mfma_f32_16x16x32_bf16 v[176:179], v[216:219], v[80:83], v[124:127]
    s_mov_b32 m0, 53248
    s_add_u32 s38, s28, 65536
    ds_read_b128 v[200:203], v5 offset:17408
    v_mfma_f32_16x16x32_bf16 v[176:179], v[220:223], v[84:87], v[176:179]
    buffer_load_dwordx4 v109, s[16:19], s38 offen nt lds
    v_exp_f32 v168, v168
    v_mfma_f32_16x16x32_bf16 v[176:179], v[224:227], v[88:91], v[176:179]
    s_mov_b32 m0, 54272
    s_add_u32 s38, s28, 81920
    ds_read_b128 v[204:207], v4 offset:17408
    v_mfma_f32_16x16x32_bf16 v[176:179], v[228:231], v[92:95], v[176:179]
    buffer_load_dwordx4 v109, s[16:19], s38 offen nt lds
    v_exp_f32 v169, v169
    v_mfma_f32_16x16x32_bf16 v[180:183], v[232:235], v[92:95], v[124:127]
    s_mov_b32 m0, 55296
    s_add_u32 s38, s28, 98304
    ds_read_b128 v[208:211], v3 offset:17408
    v_cvt_pk_bf16_f32 v168, v168, v169
    v_mfma_f32_16x16x32_bf16 v[180:183], v[236:239], v[88:91], v[180:183]
    buffer_load_dwordx4 v109, s[16:19], s38 offen nt lds
    v_exp_f32 v170, v170
    v_mfma_f32_16x16x32_bf16 v[180:183], v[240:243], v[84:87], v[180:183]
    s_mov_b32 m0, 56320
    s_add_u32 s38, s28, 114688
    ds_read_b128 v[212:215], v2 offset:17408
    v_mfma_f32_16x16x32_bf16 v[180:183], v[244:247], v[80:83], v[180:183]
    buffer_load_dwordx4 v109, s[16:19], s38 offen nt lds
    v_exp_f32 v171, v171
    v_mfma_f32_16x16x32_bf16 a[64:67], a[160:163], v[136:139], a[64:67]
    s_mov_b32 m0, 57344
    s_add_u32 s38, s28, 131072
    ds_read_b128 v[216:219], v2 offset:18432
    v_cvt_pk_bf16_f32 v169, v170, v171
    v_mfma_f32_16x16x32_bf16 a[64:67], a[164:167], v[140:143], a[64:67]
    buffer_load_dwordx4 v110, s[16:19], s38 offen nt lds
    v_exp_f32 v172, v172
    v_mfma_f32_16x16x32_bf16 a[68:71], a[168:171], v[140:143], a[68:71]
    s_mov_b32 m0, 58368
    s_add_u32 s38, s28, 147456
    ds_read_b128 v[220:223], v3 offset:18432
    v_mfma_f32_16x16x32_bf16 a[68:71], a[172:175], v[136:139], a[68:71]
    buffer_load_dwordx4 v110, s[16:19], s38 offen nt lds
    v_exp_f32 v173, v173
    v_mfma_f32_16x16x32_bf16 a[72:75], a[176:179], v[136:139], a[72:75]
    s_mov_b32 m0, 59392
    s_add_u32 s38, s28, 163840
    ds_read_b128 v[224:227], v4 offset:18432
    v_cvt_pk_bf16_f32 v170, v172, v173
    v_mfma_f32_16x16x32_bf16 a[72:75], a[180:183], v[140:143], a[72:75]
    buffer_load_dwordx4 v110, s[16:19], s38 offen nt lds
    v_exp_f32 v174, v174
    v_mfma_f32_16x16x32_bf16 a[76:79], a[184:187], v[140:143], a[76:79]
    s_mov_b32 m0, 60416
    s_add_u32 s38, s28, 180224
    ds_read_b128 v[228:231], v5 offset:18432
    v_mfma_f32_16x16x32_bf16 a[76:79], a[188:191], v[136:139], a[76:79]
    buffer_load_dwordx4 v110, s[16:19], s38 offen nt lds
    v_exp_f32 v175, v175
    v_mfma_f32_16x16x32_bf16 a[80:83], a[192:195], v[136:139], a[80:83]
    s_mov_b32 m0, 61440
    s_add_u32 s38, s28, 196608
    ds_read_b128 v[232:235], v5 offset:19456
    v_cvt_pk_bf16_f32 v171, v174, v175
    v_mfma_f32_16x16x32_bf16 a[80:83], a[196:199], v[140:143], a[80:83]
    buffer_load_dwordx4 v111, s[16:19], s38 offen nt lds
    v_exp_f32 v176, v176
    v_mfma_f32_16x16x32_bf16 a[84:87], a[200:203], v[140:143], a[84:87]
    s_mov_b32 m0, 62464
    s_add_u32 s38, s28, 212992
    ds_read_b128 v[236:239], v4 offset:19456
    v_mfma_f32_16x16x32_bf16 a[84:87], a[204:207], v[136:139], a[84:87]
    buffer_load_dwordx4 v111, s[16:19], s38 offen nt lds
    v_exp_f32 v177, v177
    v_mfma_f32_16x16x32_bf16 a[88:91], a[208:211], v[136:139], a[88:91]
    s_mov_b32 m0, 63488
    s_add_u32 s38, s28, 229376
    ds_read_b128 v[240:243], v3 offset:19456
    v_cvt_pk_bf16_f32 v172, v176, v177
    v_mfma_f32_16x16x32_bf16 a[88:91], a[212:215], v[140:143], a[88:91]
    buffer_load_dwordx4 v111, s[16:19], s38 offen nt lds
    v_exp_f32 v178, v178
    v_mfma_f32_16x16x32_bf16 a[92:95], a[216:219], v[140:143], a[92:95]
    s_mov_b32 m0, 64512
    s_add_u32 s38, s28, 245760
    ds_read_b128 v[244:247], v2 offset:19456
    v_mfma_f32_16x16x32_bf16 a[92:95], a[220:223], v[136:139], a[92:95]
    s_or_b32 s28, s28, 0xffffc3ff
    buffer_load_dwordx4 v111, s[16:19], s38 offen nt lds
    v_exp_f32 v179, v179
    v_smfmac_f32_16x16x64_bf16 v[28:31], v[132:135], v[136:143], v0
    s_waitcnt lgkmcnt(3)
    s_add_u32 s28, s28, 1
    v_cvt_pk_bf16_f32 v173, v178, v179
    v_mfma_f32_16x16x32_bf16 v[136:139], v[184:187], v[32:35], v[112:115]
    s_and_b32 s28, s28, 0x3c00
    v_exp_f32 v180, v180
    v_mfma_f32_16x16x32_bf16 v[136:139], v[188:191], v[36:39], v[136:139]
    s_add_u32 s30, s30, 16384
    v_mfma_f32_16x16x32_bf16 v[136:139], v[192:195], v[40:43], v[136:139]
    s_and_b32 s55, s30, 262144
    v_exp_f32 v181, v181
    v_mfma_f32_16x16x32_bf16 v[136:139], v[196:199], v[44:47], v[136:139]
    s_or_b32 s28, s28, s55
    v_cvt_pk_bf16_f32 v174, v180, v181
    v_mfma_f32_16x16x32_bf16 v[140:143], v[200:203], v[44:47], v[112:115]
    s_add_u32 s37, s37, 1
    v_exp_f32 v182, v182
    v_mfma_f32_16x16x32_bf16 v[140:143], v[204:207], v[40:43], v[140:143]
    v_mfma_f32_16x16x32_bf16 v[140:143], v[208:211], v[36:39], v[140:143]
    s_cmp_ge_u32 s37, s53
    v_exp_f32 v183, v183
    v_mfma_f32_16x16x32_bf16 v[140:143], v[212:215], v[32:35], v[140:143]
    v_cvt_pk_bf16_f32 v175, v182, v183
    s_cbranch_scc1 L_out4
L_loop4_1:
    v_mfma_f32_16x16x32_bf16 v[144:147], v[216:219], v[32:35], v[112:115]
    s_waitcnt lgkmcnt(0)
    v_mfma_f32_16x16x32_bf16 v[144:147], v[220:223], v[36:39], v[144:147]
    v_exp_f32 v136, v136
    v_mfma_f32_16x16x32_bf16 v[144:147], v[224:227], v[40:43], v[144:147]
    v_mfma_f32_16x16x32_bf16 v[144:147], v[228:231], v[44:47], v[144:147]
    v_exp_f32 v137, v137
    v_mfma_f32_16x16x32_bf16 v[148:151], v[232:235], v[44:47], v[112:115]
    v_cvt_pk_bf16_f32 v136, v136, v137
    v_mfma_f32_16x16x32_bf16 v[148:151], v[236:239], v[40:43], v[148:151]
    v_exp_f32 v138, v138
    v_mfma_f32_16x16x32_bf16 v[148:151], v[240:243], v[36:39], v[148:151]
    v_mfma_f32_16x16x32_bf16 v[148:151], v[244:247], v[32:35], v[148:151]
    v_exp_f32 v139, v139
    v_mfma_f32_16x16x32_bf16 a[96:99], a[160:163], v[168:171], a[96:99]
    ds_read_b64_tr_b16 a[160:161], v6 offset:16384
    v_cvt_pk_bf16_f32 v137, v138, v139
    v_mfma_f32_16x16x32_bf16 a[96:99], a[164:167], v[172:175], a[96:99]
    v_exp_f32 v140, v140
    v_mfma_f32_16x16x32_bf16 a[100:103], a[168:171], v[172:175], a[100:103]
    ds_read_b64_tr_b16 a[162:163], v6 offset:17408
    ds_read_b64_tr_b16 a[164:165], v6 offset:18432
    v_mfma_f32_16x16x32_bf16 a[100:103], a[172:175], v[168:171], a[100:103]
    v_exp_f32 v141, v141
    v_mfma_f32_16x16x32_bf16 a[104:107], a[176:179], v[168:171], a[104:107]
    ds_read_b64_tr_b16 a[166:167], v6 offset:19456
    v_cvt_pk_bf16_f32 v138, v140, v141
    v_mfma_f32_16x16x32_bf16 a[104:107], a[180:183], v[172:175], a[104:107]
    v_exp_f32 v142, v142
    v_mfma_f32_16x16x32_bf16 a[108:111], a[184:187], v[172:175], a[108:111]
    ds_read_b64_tr_b16 a[168:169], v7 offset:18432
    ds_read_b64_tr_b16 a[170:171], v7 offset:19456
    v_mfma_f32_16x16x32_bf16 a[108:111], a[188:191], v[168:171], a[108:111]
    v_exp_f32 v143, v143
    v_mfma_f32_16x16x32_bf16 a[112:115], a[192:195], v[168:171], a[112:115]
    ds_read_b64_tr_b16 a[172:173], v7 offset:16384
    v_cvt_pk_bf16_f32 v139, v142, v143
    v_mfma_f32_16x16x32_bf16 a[112:115], a[196:199], v[172:175], a[112:115]
    v_exp_f32 v144, v144
    v_mfma_f32_16x16x32_bf16 a[116:119], a[200:203], v[172:175], a[116:119]
    s_lshr_b32 s54, s58, 2
    ds_read_b64_tr_b16 a[174:175], v7 offset:17408
    ds_read_b64_tr_b16 a[176:177], v8 offset:16384
    v_mfma_f32_16x16x32_bf16 a[116:119], a[204:207], v[168:171], a[116:119]
    s_mul_i32 s54, s54, 12288
    v_exp_f32 v145, v145
    v_mfma_f32_16x16x32_bf16 a[120:123], a[208:211], v[168:171], a[120:123]
    s_lshl_b32 s29, s58, 10
    ds_read_b64_tr_b16 a[178:179], v8 offset:17408
    v_cvt_pk_bf16_f32 v140, v144, v145
    v_mfma_f32_16x16x32_bf16 a[120:123], a[212:215], v[172:175], a[120:123]
    s_add_u32 s29, s29, s54
    v_exp_f32 v146, v146
    v_mfma_f32_16x16x32_bf16 a[124:127], a[216:219], v[172:175], a[124:127]
    s_add_u32 s58, s58, 4
    ds_read_b64_tr_b16 a[180:181], v8 offset:18432
    ds_read_b64_tr_b16 a[182:183], v8 offset:19456
    v_mfma_f32_16x16x32_bf16 a[124:127], a[220:223], v[168:171], a[124:127]
    s_cmp_lt_u32 s37, s31
    v_exp_f32 v147, v147
    v_smfmac_f32_16x16x64_bf16 v[248:251], v[132:135], v[168:175], v0
    s_cselect_b32 s14, s33, 0
    ds_read_b64_tr_b16 a[184:185], v9 offset:18432
    v_cvt_pk_bf16_f32 v141, v146, v147
    v_mfma_f32_16x16x32_bf16 v[152:155], v[184:187], v[48:51], v[116:119]
    s_mov_b32 s18, s14
    v_exp_f32 v148, v148
    v_mfma_f32_16x16x32_bf16 v[152:155], v[188:191], v[52:55], v[152:155]
    ds_read_b64_tr_b16 a[186:187], v9 offset:19456
    ds_read_b64_tr_b16 a[188:189], v9 offset:16384
    v_mfma_f32_16x16x32_bf16 v[152:155], v[192:195], v[56:59], v[152:155]
    v_exp_f32 v149, v149
    v_mfma_f32_16x16x32_bf16 v[152:155], v[196:199], v[60:63], v[152:155]
    ds_read_b64_tr_b16 a[190:191], v9 offset:17408
    v_cvt_pk_bf16_f32 v142, v148, v149
    v_mfma_f32_16x16x32_bf16 v[156:159], v[200:203], v[60:63], v[116:119]
    v_exp_f32 v150, v150
    v_mfma_f32_16x16x32_bf16 v[156:159], v[204:207], v[56:59], v[156:159]
    ds_read_b64_tr_b16 a[192:193], v10 offset:16384
    ds_read_b64_tr_b16 a[194:195], v10 offset:17408
    v_mfma_f32_16x16x32_bf16 v[156:159], v[208:211], v[52:55], v[156:159]
    v_exp_f32 v151, v151
    v_mfma_f32_16x16x32_bf16 v[156:159], v[212:215], v[48:51], v[156:159]
    ds_read_b64_tr_b16 a[196:197], v10 offset:18432
    v_cvt_pk_bf16_f32 v143, v150, v151
    v_mfma_f32_16x16x32_bf16 v[160:163], v[216:219], v[48:51], v[116:119]
    ds_read_b64_tr_b16 a[198:199], v10 offset:19456
    ds_read_b64_tr_b16 a[200:201], v11 offset:18432
    v_mfma_f32_16x16x32_bf16 v[160:163], v[220:223], v[52:55], v[160:163]
    v_exp_f32 v152, v152
    v_mfma_f32_16x16x32_bf16 v[160:163], v[224:227], v[56:59], v[160:163]
    ds_read_b64_tr_b16 a[202:203], v11 offset:19456
    ds_read_b64_tr_b16 a[204:205], v11 offset:16384
    v_mfma_f32_16x16x32_bf16 v[160:163], v[228:231], v[60:63], v[160:163]
    v_exp_f32 v153, v153
    v_mfma_f32_16x16x32_bf16 v[164:167], v[232:235], v[60:63], v[116:119]
    ds_read_b64_tr_b16 a[206:207], v11 offset:17408
    v_cvt_pk_bf16_f32 v152, v152, v153
    v_mfma_f32_16x16x32_bf16 v[164:167], v[236:239], v[56:59], v[164:167]
    v_exp_f32 v154, v154
    v_mfma_f32_16x16x32_bf16 v[164:167], v[240:243], v[52:55], v[164:167]
    ds_read_b64_tr_b16 a[208:209], v12 offset:16384
    ds_read_b64_tr_b16 a[210:211], v12 offset:17408
    v_mfma_f32_16x16x32_bf16 v[164:167], v[244:247], v[48:51], v[164:167]
    s_waitcnt lgkmcnt(7)
    v_exp_f32 v155, v155
    v_mfma_f32_16x16x32_bf16 a[0:3], a[160:163], v[136:139], a[0:3]
    ds_read_b64_tr_b16 a[212:213], v12 offset:18432
    v_cvt_pk_bf16_f32 v153, v154, v155
    v_mfma_f32_16x16x32_bf16 a[0:3], a[164:167], v[140:143], a[0:3]
    v_exp_f32 v156, v156
    v_mfma_f32_16x16x32_bf16 a[4:7], a[168:171], v[140:143], a[4:7]
    ds_read_b64_tr_b16 a[214:215], v12 offset:19456
    ds_read_b64_tr_b16 a[216:217], v13 offset:18432
    v_mfma_f32_16x16x32_bf16 a[4:7], a[172:175], v[136:139], a[4:7]
    v_exp_f32 v157, v157
    v_mfma_f32_16x16x32_bf16 a[8:11], a[176:179], v[136:139], a[8:11]
    ds_read_b64_tr_b16 a[218:219], v13 offset:19456
    v_cvt_pk_bf16_f32 v154, v156, v157
    v_mfma_f32_16x16x32_bf16 a[8:11], a[180:183], v[140:143], a[8:11]
    v_exp_f32 v158, v158
    v_mfma_f32_16x16x32_bf16 a[12:15], a[184:187], v[140:143], a[12:15]
    ds_read_b64_tr_b16 a[220:221], v13 offset:16384
    ds_read_b64_tr_b16 a[222:223], v13 offset:17408
    v_mfma_f32_16x16x32_bf16 a[12:15], a[188:191], v[136:139], a[12:15]
    v_exp_f32 v159, v159
    v_mfma_f32_16x16x32_bf16 a[16:19], a[192:195], v[136:139], a[16:19]
    s_waitcnt lgkmcnt(5)
    v_cvt_pk_bf16_f32 v155, v158, v159
    v_mfma_f32_16x16x32_bf16 a[16:19], a[196:199], v[140:143], a[16:19]
    v_exp_f32 v160, v160
    v_mfma_f32_16x16x32_bf16 a[20:23], a[200:203], v[140:143], a[20:23]
    v_mfma_f32_16x16x32_bf16 a[20:23], a[204:207], v[136:139], a[20:23]
    v_exp_f32 v161, v161
    v_mfma_f32_16x16x32_bf16 a[24:27], a[208:211], v[136:139], a[24:27]
    s_waitcnt lgkmcnt(2)
    v_cvt_pk_bf16_f32 v156, v160, v161
    v_mfma_f32_16x16x32_bf16 a[24:27], a[212:215], v[140:143], a[24:27]
    v_exp_f32 v162, v162
    v_mfma_f32_16x16x32_bf16 a[28:31], a[216:219], v[140:143], a[28:31]
    s_waitcnt lgkmcnt(0)
    v_mfma_f32_16x16x32_bf16 a[28:31], a[220:223], v[136:139], a[28:31]
    s_waitcnt vmcnt(32) lgkmcnt(0)
    s_cmp_lt_u32 s37, s44
    s_cbranch_scc1 L_odd41
    s_waitcnt vmcnt(8)
L_odd41:
    v_exp_f32 v163, v163
    v_smfmac_f32_16x16x64_bf16 v[20:23], v[132:135], v[136:143], v0
    s_barrier
    v_cvt_pk_bf16_f32 v157, v162, v163
    v_mfma_f32_16x16x32_bf16 v[136:139], v[184:187], v[64:67], v[120:123]
    s_sub_u32 s54, s37, 0
    s_cmp_ge_u32 s54, s32
    s_cbranch_scc1 L_noq41
    s_add_u32 m0, s29, 98304
    s_nop 0
    buffer_load_dwordx4 v100, s[24:27], s29 offen nt lds
    buffer_load_dwordx4 v100, s[24:27], s29 offen offset:1024 nt lds
    buffer_load_dwordx4 v100, s[24:27], s29 offen offset:2048 nt lds
    buffer_load_dwordx4 v100, s[24:27], s29 offen offset:3072 nt lds
    s_add_u32 m0, s29, 102400
    s_nop 0
    buffer_load_dwordx4 v101, s[24:27], s29 offen nt lds
    buffer_load_dwordx4 v101, s[24:27], s29 offen offset:1024 nt lds
    buffer_load_dwordx4 v101, s[24:27], s29 offen offset:2048 nt lds
    buffer_load_dwordx4 v101, s[24:27], s29 offen offset:3072 nt lds
    s_add_u32 m0, s29, 106496
    s_nop 0
    buffer_load_dwordx4 v102, s[24:27], s29 offen nt lds
    buffer_load_dwordx4 v102, s[24:27], s29 offen offset:1024 nt lds
    buffer_load_dwordx4 v102, s[24:27], s29 offen offset:2048 nt lds
    buffer_load_dwordx4 v102, s[24:27], s29 offen offset:3072 nt lds
    s_add_u32 m0, s29, 110592
    s_nop 0
    buffer_load_dwordx4 v103, s[24:27], s29 offen nt lds
    buffer_load_dwordx4 v103, s[24:27], s29 offen offset:1024 nt lds
    buffer_load_dwordx4 v103, s[24:27], s29 offen offset:2048 nt lds
    buffer_load_dwordx4 v103, s[24:27], s29 offen offset:3072 nt lds
L_noq41:
    v_exp_f32 v164, v164
    v_mfma_f32_16x16x32_bf16 v[136:139], v[188:191], v[68:71], v[136:139]
    s_mov_b32 m0, 16384
    s_add_u32 s38, s28, 0
    v_mfma_f32_16x16x32_bf16 v[136:139], v[192:195], v[72:75], v[136:139]
    buffer_load_dwordx4 v108, s[12:15], s38 offen nt lds
    v_exp_f32 v165, v165
    v_mfma_f32_16x16x32_bf16 v[136:139], v[196:199], v[76:79], v[136:139]
    s_mov_b32 m0, 17408
    s_add_u32 s38, s28, 16384
    v_cvt_pk_bf16_f32 v158, v164, v165
    v_mfma_f32_16x16x32_bf16 v[140:143], v[200:203], v[76:79], v[120:123]
    buffer_load_dwordx4 v108, s[12:15], s38 offen nt lds
    v_exp_f32 v166, v166
    v_mfma_f32_16x16x32_bf16 v[140:143], v[204:207], v[72:75], v[140:143]
    s_mov_b32 m0, 18432
    s_add_u32 s38, s28, 32768
    v_mfma_f32_16x16x32_bf16 v[140:143], v[208:211], v[68:71], v[140:143]
    buffer_load_dwordx4 v108, s[12:15], s38 offen nt lds
    v_exp_f32 v167, v167
    v_mfma_f32_16x16x32_bf16 v[140:143], v[212:215], v[64:67], v[140:143]
    s_mov_b32 m0, 19456
    s_add_u32 s38, s28, 49152
    v_cvt_pk_bf16_f32 v159, v166, v167
    v_mfma_f32_16x16x32_bf16 v[144:147], v[216:219], v[64:67], v[120:123]
    buffer_load_dwordx4 v108, s[12:15], s38 offen nt lds
    v_mfma_f32_16x16x32_bf16 v[144:147], v[220:223], v[68:71], v[144:147]
    s_mov_b32 m0, 20480
    s_add_u32 s38, s28, 65536
    v_exp_f32 v136, v136
    v_mfma_f32_16x16x32_bf16 v[144:147], v[224:227], v[72:75], v[144:147]
    buffer_load_dwordx4 v109, s[12:15], s38 offen nt lds
    v_mfma_f32_16x16x32_bf16 v[144:147], v[228:231], v[76:79], v[144:147]
    s_mov_b32 m0, 21504
    s_add_u32 s38, s28, 81920
    v_exp_f32 v137, v137
    v_mfma_f32_16x16x32_bf16 v[148:151], v[232:235], v[76:79], v[120:123]
    buffer_load_dwordx4 v109, s[12:15], s38 offen nt lds
    v_cvt_pk_bf16_f32 v136, v136, v137
    v_mfma_f32_16x16x32_bf16 v[148:151], v[236:239], v[72:75], v[148:151]
    s_mov_b32 m0, 22528
    s_add_u32 s38, s28, 98304
    v_exp_f32 v138, v138
    v_mfma_f32_16x16x32_bf16 v[148:151], v[240:243], v[68:71], v[148:151]
    buffer_load_dwordx4 v109, s[12:15], s38 offen nt lds
    v_mfma_f32_16x16x32_bf16 v[148:151], v[244:247], v[64:67], v[148:151]
    s_mov_b32 m0, 23552
    s_add_u32 s38, s28, 114688
    v_exp_f32 v139, v139
    v_mfma_f32_16x16x32_bf16 a[32:35], a[160:163], v[152:155], a[32:35]
    buffer_load_dwordx4 v109, s[12:15], s38 offen nt lds
    v_cvt_pk_bf16_f32 v137, v138, v139
    v_mfma_f32_16x16x32_bf16 a[32:35], a[164:167], v[156:159], a[32:35]
    s_mov_b32 m0, 24576
    s_add_u32 s38, s28, 131072
    v_exp_f32 v140, v140
    v_mfma_f32_16x16x32_bf16 a[36:39], a[168:171], v[156:159], a[36:39]
    buffer_load_dwordx4 v110, s[12:15], s38 offen nt lds
    v_mfma_f32_16x16x32_bf16 a[36:39], a[172:175], v[152:155], a[36:39]
    s_mov_b32 m0, 25600
    s_add_u32 s38, s28, 147456
    v_exp_f32 v141, v141
    v_mfma_f32_16x16x32_bf16 a[40:43], a[176:179], v[152:155], a[40:43]
    buffer_load_dwordx4 v110, s[12:15], s38 offen nt lds
    v_cvt_pk_bf16_f32 v138, v140, v141
    v_mfma_f32_16x16x32_bf16 a[40:43], a[180:183], v[156:159], a[40:43]
    s_mov_b32 m0, 26624
    s_add_u32 s38, s28, 163840
    v_exp_f32 v142, v142
    v_mfma_f32_16x16x32_bf16 a[44:47], a[184:187], v[156:159], a[44:47]
    buffer_load_dwordx4 v110, s[12:15], s38 offen nt lds
    v_mfma_f32_16x16x32_bf16 a[44:47], a[188:191], v[152:155], a[44:47]
    s_mov_b32 m0, 27648
    s_add_u32 s38, s28, 180224
    v_exp_f32 v143, v143
    v_mfma_f32_16x16x32_bf16 a[48:51], a[192:195], v[152:155], a[48:51]
    buffer_load_dwordx4 v110, s[12:15], s38 offen nt lds
    v_cvt_pk_bf16_f32 v139, v142, v143
    v_mfma_f32_16x16x32_bf16 a[48:51], a[196:199], v[156:159], a[48:51]
    s_mov_b32 m0, 28672
    s_add_u32 s38, s28, 196608
    v_exp_f32 v144, v144
    v_mfma_f32_16x16x32_bf16 a[52:55], a[200:203], v[156:159], a[52:55]
    buffer_load_dwordx4 v111, s[12:15], s38 offen nt lds
    v_mfma_f32_16x16x32_bf16 a[52:55], a[204:207], v[152:155], a[52:55]
    s_mov_b32 m0, 29696
    s_add_u32 s38, s28, 212992
    v_exp_f32 v145, v145
    v_mfma_f32_16x16x32_bf16 a[56:59], a[208:211], v[152:155], a[56:59]
    buffer_load_dwordx4 v111, s[12:15], s38 offen nt lds
    v_cvt_pk_bf16_f32 v140, v144, v145
    v_mfma_f32_16x16x32_bf16 a[56:59], a[212:215], v[156:159], a[56:59]
    s_mov_b32 m0, 30720
    s_add_u32 s38, s28, 229376
    v_exp_f32 v146, v146
    v_mfma_f32_16x16x32_bf16 a[60:63], a[216:219], v[156:159], a[60:63]
    buffer_load_dwordx4 v111, s[12:15], s38 offen nt lds
    v_mfma_f32_16x16x32_bf16 a[60:63], a[220:223], v[152:155], a[60:63]
    s_mov_b32 m0, 31744
    s_add_u32 s38, s28, 245760
    v_exp_f32 v147, v147
    v_smfmac_f32_16x16x64_bf16 v[24:27], v[132:135], v[152:159], v0
    buffer_load_dwordx4 v111, s[12:15], s38 offen nt lds
    v_cvt_pk_bf16_f32 v141, v146, v147
    v_mfma_f32_16x16x32_bf16 v[168:171], v[184:187], v[80:83], v[124:127]
    s_mov_b32 m0, 65536
    s_add_u32 s38, s28, 0
    v_exp_f32 v148, v148
    v_mfma_f32_16x16x32_bf16 v[168:171], v[188:191], v[84:87], v[168:171]
    buffer_load_dwordx4 v108, s[16:19], s38 offen nt lds
    ds_read_b128 v[184:187], v2 offset:32768
    v_mfma_f32_16x16x32_bf16 v[168:171], v[192:195], v[88:91], v[168:171]
    s_mov_b32 m0, 66560
    s_add_u32 s38, s28, 16384
    v_exp_f32 v149, v149
    v_mfma_f32_16x16x32_bf16 v[168:171], v[196:199], v[92:95], v[168:171]
    buffer_load_dwordx4 v108, s[16:19], s38 offen nt lds
    ds_read_b128 v[188:191], v3 offset:32768
    v_cvt_pk_bf16_f32 v142, v148, v149
    v_mfma_f32_16x16x32_bf16 v[172:175], v[200:203], v[92:95], v[124:127]
    s_mov_b32 m0, 67584
    s_add_u32 s38, s28, 32768
    v_exp_f32 v150, v150
    v_mfma_f32_16x16x32_bf16 v[172:175], v[204:207], v[88:91], v[172:175]
    buffer_load_dwordx4 v108, s[16:19], s38 offen nt lds
    ds_read_b128 v[192:195], v4 offset:32768
    v_mfma_f32_16x16x32_bf16 v[172:175], v[208:211], v[84:87], v[172:175]
    s_mov_b32 m0, 68608
    s_add_u32 s38, s28, 49152
    v_exp_f32 v151, v151
    v_mfma_f32_16x16x32_bf16 v[172:175], v[212:215], v[80:83], v[172:175]
    buffer_load_dwordx4 v108, s[16:19], s38 offen nt lds
    ds_read_b128 v[196:199], v5 offset:32768
    v_cvt_pk_bf16_f32 v143, v150, v151
    v_mfma_f32_16x16x32_bf16 v[176:179], v[216:219], v[80:83], v[124:127]
    s_mov_b32 m0, 69632
    s_add_u32 s38, s28, 65536
    ds_read_b128 v[200:203], v5 offset:33792
    v_mfma_f32_16x16x32_bf16 v[176:179], v[220:223], v[84:87], v[176:179]
    buffer_load_dwordx4 v109, s[16:19], s38 offen nt lds
    v_exp_f32 v168, v168
    v_mfma_f32_16x16x32_bf16 v[176:179], v[224:227], v[88:91], v[176:179]
    s_mov_b32 m0, 70656
    s_add_u32 s38, s28, 81920
    ds_read_b128 v[204:207], v4 offset:33792
    v_mfma_f32_16x16x32_bf16 v[176:179], v[228:231], v[92:95], v[176:179]
    buffer_load_dwordx4 v109, s[16:19], s38 offen nt lds
    v_exp_f32 v169, v169
    v_mfma_f32_16x16x32_bf16 v[180:183], v[232:235], v[92:95], v[124:127]
    s_mov_b32 m0, 71680
    s_add_u32 s38, s28, 98304
    ds_read_b128 v[208:211], v3 offset:33792
    v_cvt_pk_bf16_f32 v168, v168, v169
    v_mfma_f32_16x16x32_bf16 v[180:183], v[236:239], v[88:91], v[180:183]
    buffer_load_dwordx4 v109, s[16:19], s38 offen nt lds
    v_exp_f32 v170, v170
    v_mfma_f32_16x16x32_bf16 v[180:183], v[240:243], v[84:87], v[180:183]
    s_mov_b32 m0, 72704
    s_add_u32 s38, s28, 114688
    ds_read_b128 v[212:215], v2 offset:33792
    v_mfma_f32_16x16x32_bf16 v[180:183], v[244:247], v[80:83], v[180:183]
    buffer_load_dwordx4 v109, s[16:19], s38 offen nt lds
    v_exp_f32 v171, v171
    v_mfma_f32_16x16x32_bf16 a[64:67], a[160:163], v[136:139], a[64:67]
    s_mov_b32 m0, 73728
    s_add_u32 s38, s28, 131072
    ds_read_b128 v[216:219], v2 offset:34816
    v_cvt_pk_bf16_f32 v169, v170, v171
    v_mfma_f32_16x16x32_bf16 a[64:67], a[164:167], v[140:143], a[64:67]
    buffer_load_dwordx4 v110, s[16:19], s38 offen nt lds
    v_exp_f32 v172, v172
    v_mfma_f32_16x16x32_bf16 a[68:71], a[168:171], v[140:143], a[68:71]
    s_mov_b32 m0, 74752
    s_add_u32 s38, s28, 147456
    ds_read_b128 v[220:223], v3 offset:34816
    v_mfma_f32_16x16x32_bf16 a[68:71], a[172:175], v[136:139], a[68:71]
    buffer_load_dwordx4 v110, s[16:19], s38 offen nt lds
    v_exp_f32 v173, v173
    v_mfma_f32_16x16x32_bf16 a[72:75], a[176:179], v[136:139], a[72:75]
    s_mov_b32 m0, 75776
    s_add_u32 s38, s28, 163840
    ds_read_b128 v[224:227], v4 offset:34816
    v_cvt_pk_bf16_f32 v170, v172, v173
    v_mfma_f32_16x16x32_bf16 a[72:75], a[180:183], v[140:143], a[72:75]
    buffer_load_dwordx4 v110, s[16:19], s38 offen nt lds
    v_exp_f32 v174, v174
    v_mfma_f32_16x16x32_bf16 a[76:79], a[184:187], v[140:143], a[76:79]
    s_mov_b32 m0, 76800
    s_add_u32 s38, s28, 180224
    ds_read_b128 v[228:231], v5 offset:34816
    v_mfma_f32_16x16x32_bf16 a[76:79], a[188:191], v[136:139], a[76:79]
    buffer_load_dwordx4 v110, s[16:19], s38 offen nt lds
    v_exp_f32 v175, v175
    v_mfma_f32_16x16x32_bf16 a[80:83], a[192:195], v[136:139], a[80:83]
    s_mov_b32 m0, 77824
    s_add_u32 s38, s28, 196608
    ds_read_b128 v[232:235], v5 offset:35840
    v_cvt_pk_bf16_f32 v171, v174, v175
    v_mfma_f32_16x16x32_bf16 a[80:83], a[196:199], v[140:143], a[80:83]
    buffer_load_dwordx4 v111, s[16:19], s38 offen nt lds
    v_exp_f32 v176, v176
    v_mfma_f32_16x16x32_bf16 a[84:87], a[200:203], v[140:143], a[84:87]
    s_mov_b32 m0, 78848
    s_add_u32 s38, s28, 212992
    ds_read_b128 v[236:239], v4 offset:35840
    v_mfma_f32_16x16x32_bf16 a[84:87], a[204:207], v[136:139], a[84:87]
    buffer_load_dwordx4 v111, s[16:19], s38 offen nt lds
    v_exp_f32 v177, v177
    v_mfma_f32_16x16x32_bf16 a[88:91], a[208:211], v[136:139], a[88:91]
    s_mov_b32 m0, 79872
    s_add_u32 s38, s28, 229376
    ds_read_b128 v[240:243], v3 offset:35840
    v_cvt_pk_bf16_f32 v172, v176, v177
    v_mfma_f32_16x16x32_bf16 a[88:91], a[212:215], v[140:143], a[88:91]
    buffer_load_dwordx4 v111, s[16:19], s38 offen nt lds
    v_exp_f32 v178, v178
    v_mfma_f32_16x16x32_bf16 a[92:95], a[216:219], v[140:143], a[92:95]
    s_mov_b32 m0, 80896
    s_add_u32 s38, s28, 245760
    ds_read_b128 v[244:247], v2 offset:35840
    v_mfma_f32_16x16x32_bf16 a[92:95], a[220:223], v[136:139], a[92:95]
    s_or_b32 s28, s28, 0xffffc3ff
    buffer_load_dwordx4 v111, s[16:19], s38 offen nt lds
    v_exp_f32 v179, v179
    v_smfmac_f32_16x16x64_bf16 v[28:31], v[132:135], v[136:143], v0
    s_waitcnt lgkmcnt(3)
    s_add_u32 s28, s28, 1
    v_cvt_pk_bf16_f32 v173, v178, v179
    v_mfma_f32_16x16x32_bf16 v[136:139], v[184:187], v[32:35], v[112:115]
    s_and_b32 s28, s28, 0x3c00
    v_exp_f32 v180, v180
    v_mfma_f32_16x16x32_bf16 v[136:139], v[188:191], v[36:39], v[136:139]
    s_add_u32 s30, s30, 16384
    v_mfma_f32_16x16x32_bf16 v[136:139], v[192:195], v[40:43], v[136:139]
    s_and_b32 s55, s30, 262144
    v_exp_f32 v181, v181
    v_mfma_f32_16x16x32_bf16 v[136:139], v[196:199], v[44:47], v[136:139]
    s_or_b32 s28, s28, s55
    v_cvt_pk_bf16_f32 v174, v180, v181
    v_mfma_f32_16x16x32_bf16 v[140:143], v[200:203], v[44:47], v[112:115]
    s_add_u32 s37, s37, 1
    v_exp_f32 v182, v182
    v_mfma_f32_16x16x32_bf16 v[140:143], v[204:207], v[40:43], v[140:143]
    v_mfma_f32_16x16x32_bf16 v[140:143], v[208:211], v[36:39], v[140:143]
    s_cmp_eq_u32 s37, s35
    v_exp_f32 v183, v183
    v_mfma_f32_16x16x32_bf16 v[140:143], v[212:215], v[32:35], v[140:143]
    v_cvt_pk_bf16_f32 v175, v182, v183
    s_cbranch_scc1 L_drain
L_loop4_2:
    v_mfma_f32_16x16x32_bf16 v[144:147], v[216:219], v[32:35], v[112:115]
    s_waitcnt lgkmcnt(0)
    v_mfma_f32_16x16x32_bf16 v[144:147], v[220:223], v[36:39], v[144:147]
    v_exp_f32 v136, v136
    v_mfma_f32_16x16x32_bf16 v[144:147], v[224:227], v[40:43], v[144:147]
    v_mfma_f32_16x16x32_bf16 v[144:147], v[228:231], v[44:47], v[144:147]
    v_exp_f32 v137, v137
    v_mfma_f32_16x16x32_bf16 v[148:151], v[232:235], v[44:47], v[112:115]
    v_cvt_pk_bf16_f32 v136, v136, v137
    v_mfma_f32_16x16x32_bf16 v[148:151], v[236:239], v[40:43], v[148:151]
    v_exp_f32 v138, v138
    v_mfma_f32_16x16x32_bf16 v[148:151], v[240:243], v[36:39], v[148:151]
    v_mfma_f32_16x16x32_bf16 v[148:151], v[244:247], v[32:35], v[148:151]
    v_exp_f32 v139, v139
    v_mfma_f32_16x16x32_bf16 a[96:99], a[160:163], v[168:171], a[96:99]
    ds_read_b64_tr_b16 a[160:161], v6 offset:32768
    v_cvt_pk_bf16_f32 v137, v138, v139
    v_mfma_f32_16x16x32_bf16 a[96:99], a[164:167], v[172:175], a[96:99]
    v_exp_f32 v140, v140
    v_mfma_f32_16x16x32_bf16 a[100:103], a[168:171], v[172:175], a[100:103]
    ds_read_b64_tr_b16 a[162:163], v6 offset:33792
    ds_read_b64_tr_b16 a[164:165], v6 offset:34816
    v_mfma_f32_16x16x32_bf16 a[100:103], a[172:175], v[168:171], a[100:103]
    v_exp_f32 v141, v141
    v_mfma_f32_16x16x32_bf16 a[104:107], a[176:179], v[168:171], a[104:107]
    ds_read_b64_tr_b16 a[166:167], v6 offset:35840
    v_cvt_pk_bf16_f32 v138, v140, v141
    v_mfma_f32_16x16x32_bf16 a[104:107], a[180:183], v[172:175], a[104:107]
    v_exp_f32 v142, v142
    v_mfma_f32_16x16x32_bf16 a[108:111], a[184:187], v[172:175], a[108:111]
    ds_read_b64_tr_b16 a[168:169], v7 offset:34816
    ds_read_b64_tr_b16 a[170:171], v7 offset:35840
    v_mfma_f32_16x16x32_bf16 a[108:111], a[188:191], v[168:171], a[108:111]
    v_exp_f32 v143, v143
    v_mfma_f32_16x16x32_bf16 a[112:115], a[192:195], v[168:171], a[112:115]
    ds_read_b64_tr_b16 a[172:173], v7 offset:32768
    v_cvt_pk_bf16_f32 v139, v142, v143
    v_mfma_f32_16x16x32_bf16 a[112:115], a[196:199], v[172:175], a[112:115]
    v_exp_f32 v144, v144
    v_mfma_f32_16x16x32_bf16 a[116:119], a[200:203], v[172:175], a[116:119]
    s_lshr_b32 s54, s58, 2
    ds_read_b64_tr_b16 a[174:175], v7 offset:33792
    ds_read_b64_tr_b16 a[176:177], v8 offset:32768
    v_mfma_f32_16x16x32_bf16 a[116:119], a[204:207], v[168:171], a[116:119]
    s_mul_i32 s54, s54, 12288
    v_exp_f32 v145, v145
    v_mfma_f32_16x16x32_bf16 a[120:123], a[208:211], v[168:171], a[120:123]
    s_lshl_b32 s29, s58, 10
    ds_read_b64_tr_b16 a[178:179], v8 offset:33792
    v_cvt_pk_bf16_f32 v140, v144, v145
    v_mfma_f32_16x16x32_bf16 a[120:123], a[212:215], v[172:175], a[120:123]
    s_add_u32 s29, s29, s54
    v_exp_f32 v146, v146
    v_mfma_f32_16x16x32_bf16 a[124:127], a[216:219], v[172:175], a[124:127]
    s_add_u32 s58, s58, 4
    ds_read_b64_tr_b16 a[180:181], v8 offset:34816
    ds_read_b64_tr_b16 a[182:183], v8 offset:35840
    v_mfma_f32_16x16x32_bf16 a[124:127], a[220:223], v[168:171], a[124:127]
    s_cmp_lt_u32 s37, s31
    v_exp_f32 v147, v147
    v_smfmac_f32_16x16x64_bf16 v[248:251], v[132:135], v[168:175], v0
    s_cselect_b32 s14, s33, 0
    ds_read_b64_tr_b16 a[184:185], v9 offset:34816
    v_cvt_pk_bf16_f32 v141, v146, v147
    v_mfma_f32_16x16x32_bf16 v[152:155], v[184:187], v[48:51], v[116:119]
    s_mov_b32 s18, s14
    v_exp_f32 v148, v148
    v_mfma_f32_16x16x32_bf16 v[152:155], v[188:191], v[52:55], v[152:155]
    ds_read_b64_tr_b16 a[186:187], v9 offset:35840
    ds_read_b64_tr_b16 a[188:189], v9 offset:32768
    v_mfma_f32_16x16x32_bf16 v[152:155], v[192:195], v[56:59], v[152:155]
    v_exp_f32 v149, v149
    v_mfma_f32_16x16x32_bf16 v[152:155], v[196:199], v[60:63], v[152:155]
    ds_read_b64_tr_b16 a[190:191], v9 offset:33792
    v_cvt_pk_bf16_f32 v142, v148, v149
    v_mfma_f32_16x16x32_bf16 v[156:159], v[200:203], v[60:63], v[116:119]
    v_exp_f32 v150, v150
    v_mfma_f32_16x16x32_bf16 v[156:159], v[204:207], v[56:59], v[156:159]
    ds_read_b64_tr_b16 a[192:193], v10 offset:32768
    ds_read_b64_tr_b16 a[194:195], v10 offset:33792
    v_mfma_f32_16x16x32_bf16 v[156:159], v[208:211], v[52:55], v[156:159]
    v_exp_f32 v151, v151
    v_mfma_f32_16x16x32_bf16 v[156:159], v[212:215], v[48:51], v[156:159]
    ds_read_b64_tr_b16 a[196:197], v10 offset:34816
    v_cvt_pk_bf16_f32 v143, v150, v151
    v_mfma_f32_16x16x32_bf16 v[160:163], v[216:219], v[48:51], v[116:119]
    ds_read_b64_tr_b16 a[198:199], v10 offset:35840
    ds_read_b64_tr_b16 a[200:201], v11 offset:34816
    v_mfma_f32_16x16x32_bf16 v[160:163], v[220:223], v[52:55], v[160:163]
    v_exp_f32 v152, v152
    v_mfma_f32_16x16x32_bf16 v[160:163], v[224:227], v[56:59], v[160:163]
    ds_read_b64_tr_b16 a[202:203], v11 offset:35840
    ds_read_b64_tr_b16 a[204:205], v11 offset:32768
    v_mfma_f32_16x16x32_bf16 v[160:163], v[228:231], v[60:63], v[160:163]
    v_exp_f32 v153, v153
    v_mfma_f32_16x16x32_bf16 v[164:167], v[232:235], v[60:63], v[116:119]
    ds_read_b64_tr_b16 a[206:207], v11 offset:33792
    v_cvt_pk_bf16_f32 v152, v152, v153
    v_mfma_f32_16x16x32_bf16 v[164:167], v[236:239], v[56:59], v[164:167]
    v_exp_f32 v154, v154
    v_mfma_f32_16x16x32_bf16 v[164:167], v[240:243], v[52:55], v[164:167]
    ds_read_b64_tr_b16 a[208:209], v12 offset:32768
    ds_read_b64_tr_b16 a[210:211], v12 offset:33792
    v_mfma_f32_16x16x32_bf16 v[164:167], v[244:247], v[48:51], v[164:167]
    s_waitcnt lgkmcnt(7)
    v_exp_f32 v155, v155
    v_mfma_f32_16x16x32_bf16 a[0:3], a[160:163], v[136:139], a[0:3]
    ds_read_b64_tr_b16 a[212:213], v12 offset:34816
    v_cvt_pk_bf16_f32 v153, v154, v155
    v_mfma_f32_16x16x32_bf16 a[0:3], a[164:167], v[140:143], a[0:3]
    v_exp_f32 v156, v156
    v_mfma_f32_16x16x32_bf16 a[4:7], a[168:171], v[140:143], a[4:7]
    ds_read_b64_tr_b16 a[214:215], v12 offset:35840
    ds_read_b64_tr_b16 a[216:217], v13 offset:34816
    v_mfma_f32_16x16x32_bf16 a[4:7], a[172:175], v[136:139], a[4:7]
    v_exp_f32 v157, v157
    v_mfma_f32_16x16x32_bf16 a[8:11], a[176:179], v[136:139], a[8:11]
    ds_read_b64_tr_b16 a[218:219], v13 offset:35840
    v_cvt_pk_bf16_f32 v154, v156, v157
    v_mfma_f32_16x16x32_bf16 a[8:11], a[180:183], v[140:143], a[8:11]
    v_exp_f32 v158, v158
    v_mfma_f32_16x16x32_bf16 a[12:15], a[184:187], v[140:143], a[12:15]
    ds_read_b64_tr_b16 a[220:221], v13 offset:32768
    ds_read_b64_tr_b16 a[222:223], v13 offset:33792
    v_mfma_f32_16x16x32_bf16 a[12:15], a[188:191], v[136:139], a[12:15]
    v_exp_f32 v159, v159
    v_mfma_f32_16x16x32_bf16 a[16:19], a[192:195], v[136:139], a[16:19]
    s_waitcnt lgkmcnt(5)
    v_cvt_pk_bf16_f32 v155, v158, v159
    v_mfma_f32_16x16x32_bf16 a[16:19], a[196:199], v[140:143], a[16:19]
    v_exp_f32 v160, v160
    v_mfma_f32_16x16x32_bf16 a[20:23], a[200:203], v[140:143], a[20:23]
    v_mfma_f32_16x16x32_bf16 a[20:23], a[204:207], v[136:139], a[20:23]
    v_exp_f32 v161, v161
    v_mfma_f32_16x16x32_bf16 a[24:27], a[208:211], v[136:139], a[24:27]
    s_waitcnt lgkmcnt(2)
    v_cvt_pk_bf16_f32 v156, v160, v161
    v_mfma_f32_16x16x32_bf16 a[24:27], a[212:215], v[140:143], a[24:27]
    v_exp_f32 v162, v162
    v_mfma_f32_16x16x32_bf16 a[28:31], a[216:219], v[140:143], a[28:31]
    s_waitcnt lgkmcnt(0)
    v_mfma_f32_16x16x32_bf16 a[28:31], a[220:223], v[136:139], a[28:31]
    s_waitcnt vmcnt(32) lgkmcnt(0)
    s_cmp_lt_u32 s37, s44
    s_cbranch_scc1 L_odd42
    s_waitcnt vmcnt(8)
L_odd42:
    v_exp_f32 v163, v163
    v_smfmac_f32_16x16x64_bf16 v[20:23], v[132:135], v[136:143], v0
    s_barrier
    v_cvt_pk_bf16_f32 v157, v162, v163
    v_mfma_f32_16x16x32_bf16 v[136:139], v[184:187], v[64:67], v[120:123]
    s_sub_u32 s54, s37, 0
    s_cmp_ge_u32 s54, s32
    s_cbranch_scc1 L_noq42
    s_add_u32 m0, s29, 98304
    s_nop 0
    buffer_load_dwordx4 v100, s[24:27], s29 offen nt lds
    buffer_load_dwordx4 v100, s[24:27], s29 offen offset:1024 nt lds
    buffer_load_dwordx4 v100, s[24:27], s29 offen offset:2048 nt lds
    buffer_load_dwordx4 v100, s[24:27], s29 offen offset:3072 nt lds
    s_add_u32 m0, s29, 102400
    s_nop 0
    buffer_load_dwordx4 v101, s[24:27], s29 offen nt lds
    buffer_load_dwordx4 v101, s[24:27], s29 offen offset:1024 nt lds
    buffer_load_dwordx4 v101, s[24:27], s29 offen offset:2048 nt lds
    buffer_load_dwordx4 v101, s[24:27], s29 offen offset:3072 nt lds
    s_add_u32 m0, s29, 106496
    s_nop 0
    buffer_load_dwordx4 v102, s[24:27], s29 offen nt lds
    buffer_load_dwordx4 v102, s[24:27], s29 offen offset:1024 nt lds
    buffer_load_dwordx4 v102, s[24:27], s29 offen offset:2048 nt lds
    buffer_load_dwordx4 v102, s[24:27], s29 offen offset:3072 nt lds
    s_add_u32 m0, s29, 110592
    s_nop 0
    buffer_load_dwordx4 v103, s[24:27], s29 offen nt lds
    buffer_load_dwordx4 v103, s[24:27], s29 offen offset:1024 nt lds
    buffer_load_dwordx4 v103, s[24:27], s29 offen offset:2048 nt lds
    buffer_load_dwordx4 v103, s[24:27], s29 offen offset:3072 nt lds
L_noq42:
    v_exp_f32 v164, v164
    v_mfma_f32_16x16x32_bf16 v[136:139], v[188:191], v[68:71], v[136:139]
    s_mov_b32 m0, 32768
    s_add_u32 s38, s28, 0
    v_mfma_f32_16x16x32_bf16 v[136:139], v[192:195], v[72:75], v[136:139]
    buffer_load_dwordx4 v108, s[12:15], s38 offen nt lds
    v_exp_f32 v165, v165
    v_mfma_f32_16x16x32_bf16 v[136:139], v[196:199], v[76:79], v[136:139]
    s_mov_b32 m0, 33792
    s_add_u32 s38, s28, 16384
    v_cvt_pk_bf16_f32 v158, v164, v165
    v_mfma_f32_16x16x32_bf16 v[140:143], v[200:203], v[76:79], v[120:123]
    buffer_load_dwordx4 v108, s[12:15], s38 offen nt lds
    v_exp_f32 v166, v166
    v_mfma_f32_16x16x32_bf16 v[140:143], v[204:207], v[72:75], v[140:143]
    s_mov_b32 m0, 34816
    s_add_u32 s38, s28, 32768
    v_mfma_f32_16x16x32_bf16 v[140:143], v[208:211], v[68:71], v[140:143]
    buffer_load_dwordx4 v108, s[12:15], s38 offen nt lds
    v_exp_f32 v167, v167
    v_mfma_f32_16x16x32_bf16 v[140:143], v[212:215], v[64:67], v[140:143]
    s_mov_b32 m0, 35840
    s_add_u32 s38, s28, 49152
    v_cvt_pk_bf16_f32 v159, v166, v167
    v_mfma_f32_16x16x32_bf16 v[144:147], v[216:219], v[64:67], v[120:123]
    buffer_load_dwordx4 v108, s[12:15], s38 offen nt lds
    v_mfma_f32_16x16x32_bf16 v[144:147], v[220:223], v[68:71], v[144:147]
    s_mov_b32 m0, 36864
    s_add_u32 s38, s28, 65536
    v_exp_f32 v136, v136
    v_mfma_f32_16x16x32_bf16 v[144:147], v[224:227], v[72:75], v[144:147]
    buffer_load_dwordx4 v109, s[12:15], s38 offen nt lds
    v_mfma_f32_16x16x32_bf16 v[144:147], v[228:231], v[76:79], v[144:147]
    s_mov_b32 m0, 37888
    s_add_u32 s38, s28, 81920
    v_exp_f32 v137, v137
    v_mfma_f32_16x16x32_bf16 v[148:151], v[232:235], v[76:79], v[120:123]
    buffer_load_dwordx4 v109, s[12:15], s38 offen nt lds
    v_cvt_pk_bf16_f32 v136, v136, v137
    v_mfma_f32_16x16x32_bf16 v[148:151], v[236:239], v[72:75], v[148:151]
    s_mov_b32 m0, 38912
    s_add_u32 s38, s28, 98304
    v_exp_f32 v138, v138
    v_mfma_f32_16x16x32_bf16 v[148:151], v[240:243], v[68:71], v[148:151]
    buffer_load_dwordx4 v109, s[12:15], s38 offen nt lds
    v_mfma_f32_16x16x32_bf16 v[148:151], v[244:247], v[64:67], v[148:151]
    s_mov_b32 m0, 39936
    s_add_u32 s38, s28, 114688
    v_exp_f32 v139, v139
    v_mfma_f32_16x16x32_bf16 a[32:35], a[160:163], v[152:155], a[32:35]
    buffer_load_dwordx4 v109, s[12:15], s38 offen nt lds
    v_cvt_pk_bf16_f32 v137, v138, v139
    v_mfma_f32_16x16x32_bf16 a[32:35], a[164:167], v[156:159], a[32:35]
    s_mov_b32 m0, 40960
    s_add_u32 s38, s28, 131072
    v_exp_f32 v140, v140
    v_mfma_f32_16x16x32_bf16 a[36:39], a[168:171], v[156:159], a[36:39]
    buffer_load_dwordx4 v110, s[12:15], s38 offen nt lds
    v_mfma_f32_16x16x32_bf16 a[36:39], a[172:175], v[152:155], a[36:39]
    s_mov_b32 m0, 41984
    s_add_u32 s38, s28, 147456
    v_exp_f32 v141, v141
    v_mfma_f32_16x16x32_bf16 a[40:43], a[176:179], v[152:155], a[40:43]
    buffer_load_dwordx4 v110, s[12:15], s38 offen nt lds
    v_cvt_pk_bf16_f32 v138, v140, v141
    v_mfma_f32_16x16x32_bf16 a[40:43], a[180:183], v[156:159], a[40:43]
    s_mov_b32 m0, 43008
    s_add_u32 s38, s28, 163840
    v_exp_f32 v142, v142
    v_mfma_f32_16x16x32_bf16 a[44:47], a[184:187], v[156:159], a[44:47]
    buffer_load_dwordx4 v110, s[12:15], s38 offen nt lds
    v_mfma_f32_16x16x32_bf16 a[44:47], a[188:191], v[152:155], a[44:47]
    s_mov_b32 m0, 44032
    s_add_u32 s38, s28, 180224
    v_exp_f32 v143, v143
    v_mfma_f32_16x16x32_bf16 a[48:51], a[192:195], v[152:155], a[48:51]
    buffer_load_dwordx4 v110, s[12:15], s38 offen nt lds
    v_cvt_pk_bf16_f32 v139, v142, v143
    v_mfma_f32_16x16x32_bf16 a[48:51], a[196:199], v[156:159], a[48:51]
    s_mov_b32 m0, 45056
    s_add_u32 s38, s28, 196608
    v_exp_f32 v144, v144
    v_mfma_f32_16x16x32_bf16 a[52:55], a[200:203], v[156:159], a[52:55]
    buffer_load_dwordx4 v111, s[12:15], s38 offen nt lds
    v_mfma_f32_16x16x32_bf16 a[52:55], a[204:207], v[152:155], a[52:55]
    s_mov_b32 m0, 46080
    s_add_u32 s38, s28, 212992
    v_exp_f32 v145, v145
    v_mfma_f32_16x16x32_bf16 a[56:59], a[208:211], v[152:155], a[56:59]
    buffer_load_dwordx4 v111, s[12:15], s38 offen nt lds
    v_cvt_pk_bf16_f32 v140, v144, v145
    v_mfma_f32_16x16x32_bf16 a[56:59], a[212:215], v[156:159], a[56:59]
    s_mov_b32 m0, 47104
    s_add_u32 s38, s28, 229376
    v_exp_f32 v146, v146
    v_mfma_f32_16x16x32_bf16 a[60:63], a[216:219], v[156:159], a[60:63]
    buffer_load_dwordx4 v111, s[12:15], s38 offen nt lds
    v_mfma_f32_16x16x32_bf16 a[60:63], a[220:223], v[152:155], a[60:63]
    s_mov_b32 m0, 48128
    s_add_u32 s38, s28, 245760
    v_exp_f32 v147, v147
    v_smfmac_f32_16x16x64_bf16 v[24:27], v[132:135], v[152:159], v0
    buffer_load_dwordx4 v111, s[12:15], s38 offen nt lds
    v_cvt_pk_bf16_f32 v141, v146, v147
    v_mfma_f32_16x16x32_bf16 v[168:171], v[184:187], v[80:83], v[124:127]
    s_mov_b32 m0, 81920
    s_add_u32 s38, s28, 0
    v_exp_f32 v148, v148
    v_mfma_f32_16x16x32_bf16 v[168:171], v[188:191], v[84:87], v[168:171]
    buffer_load_dwordx4 v108, s[16:19], s38 offen nt lds
    ds_read_b128 v[184:187], v2
    v_mfma_f32_16x16x32_bf16 v[168:171], v[192:195], v[88:91], v[168:171]
    s_mov_b32 m0, 82944
    s_add_u32 s38, s28, 16384
    v_exp_f32 v149, v149
    v_mfma_f32_16x16x32_bf16 v[168:171], v[196:199], v[92:95], v[168:171]
    buffer_load_dwordx4 v108, s[16:19], s38 offen nt lds
    ds_read_b128 v[188:191], v3
    v_cvt_pk_bf16_f32 v142, v148, v149
    v_mfma_f32_16x16x32_bf16 v[172:175], v[200:203], v[92:95], v[124:127]
    s_mov_b32 m0, 83968
    s_add_u32 s38, s28, 32768
    v_exp_f32 v150, v150
    v_mfma_f32_16x16x32_bf16 v[172:175], v[204:207], v[88:91], v[172:175]
    buffer_load_dwordx4 v108, s[16:19], s38 offen nt lds
    ds_read_b128 v[192:195], v4
    v_mfma_f32_16x16x32_bf16 v[172:175], v[208:211], v[84:87], v[172:175]
    s_mov_b32 m0, 84992
    s_add_u32 s38, s28, 49152
    v_exp_f32 v151, v151
    v_mfma_f32_16x16x32_bf16 v[172:175], v[212:215], v[80:83], v[172:175]
    buffer_load_dwordx4 v108, s[16:19], s38 offen nt lds
    ds_read_b128 v[196:199], v5
    v_cvt_pk_bf16_f32 v143, v150, v151
    v_mfma_f32_16x16x32_bf16 v[176:179], v[216:219], v[80:83], v[124:127]
    s_mov_b32 m0, 86016
    s_add_u32 s38, s28, 65536
    ds_read_b128 v[200:203], v5 offset:1024
    v_mfma_f32_16x16x32_bf16 v[176:179], v[220:223], v[84:87], v[176:179]
    buffer_load_dwordx4 v109, s[16:19], s38 offen nt lds
    v_exp_f32 v168, v168
    v_mfma_f32_16x16x32_bf16 v[176:179], v[224:227], v[88:91], v[176:179]
    s_mov_b32 m0, 87040
    s_add_u32 s38, s28, 81920
    ds_read_b128 v[204:207], v4 offset:1024
    v_mfma_f32_16x16x32_bf16 v[176:179], v[228:231], v[92:95], v[176:179]
    buffer_load_dwordx4 v109, s[16:19], s38 offen nt lds
    v_exp_f32 v169, v169
    v_mfma_f32_16x16x32_bf16 v[180:183], v[232:235], v[92:95], v[124:127]
    s_mov_b32 m0, 88064
    s_add_u32 s38, s28, 98304
    ds_read_b128 v[208:211], v3 offset:1024
    v_cvt_pk_bf16_f32 v168, v168, v169
    v_mfma_f32_16x16x32_bf16 v[180:183], v[236:239], v[88:91], v[180:183]
    buffer_load_dwordx4 v109, s[16:19], s38 offen nt lds
    v_exp_f32 v170, v170
    v_mfma_f32_16x16x32_bf16 v[180:183], v[240:243], v[84:87], v[180:183]
    s_mov_b32 m0, 89088
    s_add_u32 s38, s28, 114688
    ds_read_b128 v[212:215], v2 offset:1024
    v_mfma_f32_16x16x32_bf16 v[180:183], v[244:247], v[80:83], v[180:183]
    buffer_load_dwordx4 v109, s[16:19], s38 offen nt lds
    v_exp_f32 v171, v171
    v_mfma_f32_16x16x32_bf16 a[64:67], a[160:163], v[136:139], a[64:67]
    s_mov_b32 m0, 90112
    s_add_u32 s38, s28, 131072
    ds_read_b128 v[216:219], v2 offset:2048
    v_cvt_pk_bf16_f32 v169, v170, v171
    v_mfma_f32_16x16x32_bf16 a[64:67], a[164:167], v[140:143], a[64:67]
    buffer_load_dwordx4 v110, s[16:19], s38 offen nt lds
    v_exp_f32 v172, v172
    v_mfma_f32_16x16x32_bf16 a[68:71], a[168:171], v[140:143], a[68:71]
    s_mov_b32 m0, 91136
    s_add_u32 s38, s28, 147456
    ds_read_b128 v[220:223], v3 offset:2048
    v_mfma_f32_16x16x32_bf16 a[68:71], a[172:175], v[136:139], a[68:71]
    buffer_load_dwordx4 v110, s[16:19], s38 offen nt lds
    v_exp_f32 v173, v173
    v_mfma_f32_16x16x32_bf16 a[72:75], a[176:179], v[136:139], a[72:75]
    s_mov_b32 m0, 92160
    s_add_u32 s38, s28, 163840
    ds_read_b128 v[224:227], v4 offset:2048
    v_cvt_pk_bf16_f32 v170, v172, v173
    v_mfma_f32_16x16x32_bf16 a[72:75], a[180:183], v[140:143], a[72:75]
    buffer_load_dwordx4 v110, s[16:19], s38 offen nt lds
    v_exp_f32 v174, v174
    v_mfma_f32_16x16x32_bf16 a[76:79], a[184:187], v[140:143], a[76:79]
    s_mov_b32 m0, 93184
    s_add_u32 s38, s28, 180224
    ds_read_b128 v[228:231], v5 offset:2048
    v_mfma_f32_16x16x32_bf16 a[76:79], a[188:191], v[136:139], a[76:79]
    buffer_load_dwordx4 v110, s[16:19], s38 offen nt lds
    v_exp_f32 v175, v175
    v_mfma_f32_16x16x32_bf16 a[80:83], a[192:195], v[136:139], a[80:83]
    s_mov_b32 m0, 94208
    s_add_u32 s38, s28, 196608
    ds_read_b128 v[232:235], v5 offset:3072
    v_cvt_pk_bf16_f32 v171, v174, v175
    v_mfma_f32_16x16x32_bf16 a[80:83], a[196:199], v[140:143], a[80:83]
    buffer_load_dwordx4 v111, s[16:19], s38 offen nt lds
    v_exp_f32 v176, v176
    v_mfma_f32_16x16x32_bf16 a[84:87], a[200:203], v[140:143], a[84:87]
    s_mov_b32 m0, 95232
    s_add_u32 s38, s28, 212992
    ds_read_b128 v[236:239], v4 offset:3072
    v_mfma_f32_16x16x32_bf16 a[84:87], a[204:207], v[136:139], a[84:87]
    buffer_load_dwordx4 v111, s[16:19], s38 offen nt lds
    v_exp_f32 v177, v177
    v_mfma_f32_16x16x32_bf16 a[88:91], a[208:211], v[136:139], a[88:91]
    s_mov_b32 m0, 96256
    s_add_u32 s38, s28, 229376
    ds_read_b128 v[240:243], v3 offset:3072
    v_cvt_pk_bf16_f32 v172, v176, v177
    v_mfma_f32_16x16x32_bf16 a[88:91], a[212:215], v[140:143], a[88:91]
    buffer_load_dwordx4 v111, s[16:19], s38 offen nt lds
    v_exp_f32 v178, v178
    v_mfma_f32_16x16x32_bf16 a[92:95], a[216:219], v[140:143], a[92:95]
    s_mov_b32 m0, 97280
    s_add_u32 s38, s28, 245760
    ds_read_b128 v[244:247], v2 offset:3072
    v_mfma_f32_16x16x32_bf16 a[92:95], a[220:223], v[136:139], a[92:95]
    s_or_b32 s28, s28, 0xffffc3ff
    buffer_load_dwordx4 v111, s[16:19], s38 offen nt lds
    v_exp_f32 v179, v179
    v_smfmac_f32_16x16x64_bf16 v[28:31], v[132:135], v[136:143], v0
    s_waitcnt lgkmcnt(3)
    s_add_u32 s28, s28, 1
    v_cvt_pk_bf16_f32 v173, v178, v179
    v_mfma_f32_16x16x32_bf16 v[136:139], v[184:187], v[32:35], v[112:115]
    s_and_b32 s28, s28, 0x3c00
    v_exp_f32 v180, v180
    v_mfma_f32_16x16x32_bf16 v[136:139], v[188:191], v[36:39], v[136:139]
    s_add_u32 s30, s30, 16384
    v_mfma_f32_16x16x32_bf16 v[136:139], v[192:195], v[40:43], v[136:139]
    s_and_b32 s55, s30, 262144
    v_exp_f32 v181, v181
    v_mfma_f32_16x16x32_bf16 v[136:139], v[196:199], v[44:47], v[136:139]
    s_or_b32 s28, s28, s55
    v_cvt_pk_bf16_f32 v174, v180, v181
    v_mfma_f32_16x16x32_bf16 v[140:143], v[200:203], v[44:47], v[112:115]
    s_add_u32 s37, s37, 1
    v_exp_f32 v182, v182
    v_mfma_f32_16x16x32_bf16 v[140:143], v[204:207], v[40:43], v[140:143]
    v_mfma_f32_16x16x32_bf16 v[140:143], v[208:211], v[36:39], v[140:143]
    v_exp_f32 v183, v183
    v_mfma_f32_16x16x32_bf16 v[140:143], v[212:215], v[32:35], v[140:143]
    v_cvt_pk_bf16_f32 v175, v182, v183
    s_branch L_loop4_0
L_drain:
    v_mfma_f32_16x16x32_bf16 v[144:147], v[216:219], v[32:35], v[112:115]
    s_waitcnt lgkmcnt(0)
    v_mfma_f32_16x16x32_bf16 v[144:147], v[220:223], v[36:39], v[144:147]
    v_exp_f32 v136, v136
    v_mfma_f32_16x16x32_bf16 v[144:147], v[224:227], v[40:43], v[144:147]
    v_mfma_f32_16x16x32_bf16 v[144:147], v[228:231], v[44:47], v[144:147]
    v_exp_f32 v137, v137
    v_mfma_f32_16x16x32_bf16 v[148:151], v[232:235], v[44:47], v[112:115]
    v_cvt_pk_bf16_f32 v136, v136, v137
    v_mfma_f32_16x16x32_bf16 v[148:151], v[236:239], v[40:43], v[148:151]
    v_exp_f32 v138, v138
    v_mfma_f32_16x16x32_bf16 v[148:151], v[240:243], v[36:39], v[148:151]
    v_mfma_f32_16x16x32_bf16 v[148:151], v[244:247], v[32:35], v[148:151]
    v_exp_f32 v139, v139
    v_mfma_f32_16x16x32_bf16 a[96:99], a[160:163], v[168:171], a[96:99]
    ds_read_b64_tr_b16 a[160:161], v6 offset:32768
    v_cvt_pk_bf16_f32 v137, v138, v139
    v_mfma_f32_16x16x32_bf16 a[96:99], a[164:167], v[172:175], a[96:99]
    v_exp_f32 v140, v140
    v_mfma_f32_16x16x32_bf16 a[100:103], a[168:171], v[172:175], a[100:103]
    ds_read_b64_tr_b16 a[162:163], v6 offset:33792
    ds_read_b64_tr_b16 a[164:165], v6 offset:34816
    v_mfma_f32_16x16x32_bf16 a[100:103], a[172:175], v[168:171], a[100:103]
    v_exp_f32 v141, v141
    v_mfma_f32_16x16x32_bf16 a[104:107], a[176:179], v[168:171], a[104:107]
    ds_read_b64_tr_b16 a[166:167], v6 offset:35840
    v_cvt_pk_bf16_f32 v138, v140, v141
    v_mfma_f32_16x16x32_bf16 a[104:107], a[180:183], v[172:175], a[104:107]
    v_exp_f32 v142, v142
    v_mfma_f32_16x16x32_bf16 a[108:111], a[184:187], v[172:175], a[108:111]
    ds_read_b64_tr_b16 a[168:169], v7 offset:34816
    ds_read_b64_tr_b16 a[170:171], v7 offset:35840
    v_mfma_f32_16x16x32_bf16 a[108:111], a[188:191], v[168:171], a[108:111]
    v_exp_f32 v143, v143
    v_mfma_f32_16x16x32_bf16 a[112:115], a[192:195], v[168:171], a[112:115]
    ds_read_b64_tr_b16 a[172:173], v7 offset:32768
    v_cvt_pk_bf16_f32 v139, v142, v143
    v_mfma_f32_16x16x32_bf16 a[112:115], a[196:199], v[172:175], a[112:115]
    v_exp_f32 v144, v144
    v_mfma_f32_16x16x32_bf16 a[116:119], a[200:203], v[172:175], a[116:119]
    ds_read_b64_tr_b16 a[174:175], v7 offset:33792
    ds_read_b64_tr_b16 a[176:177], v8 offset:32768
    v_mfma_f32_16x16x32_bf16 a[116:119], a[204:207], v[168:171], a[116:119]
    v_exp_f32 v145, v145
    v_mfma_f32_16x16x32_bf16 a[120:123], a[208:211], v[168:171], a[120:123]
    ds_read_b64_tr_b16 a[178:179], v8 offset:33792
    v_cvt_pk_bf16_f32 v140, v144, v145
    v_mfma_f32_16x16x32_bf16 a[120:123], a[212:215], v[172:175], a[120:123]
    v_exp_f32 v146, v146
    v_mfma_f32_16x16x32_bf16 a[124:127], a[216:219], v[172:175], a[124:127]
    ds_read_b64_tr_b16 a[180:181], v8 offset:34816
    ds_read_b64_tr_b16 a[182:183], v8 offset:35840
    v_mfma_f32_16x16x32_bf16 a[124:127], a[220:223], v[168:171], a[124:127]
    v_exp_f32 v147, v147
    v_smfmac_f32_16x16x64_bf16 v[248:251], v[132:135], v[168:175], v0
    ds_read_b64_tr_b16 a[184:185], v9 offset:34816
    v_cvt_pk_bf16_f32 v141, v146, v147
    v_mfma_f32_16x16x32_bf16 v[152:155], v[184:187], v[48:51], v[116:119]
    v_exp_f32 v148, v148
    v_mfma_f32_16x16x32_bf16 v[152:155], v[188:191], v[52:55], v[152:155]
    ds_read_b64_tr_b16 a[186:187], v9 offset:35840
    ds_read_b64_tr_b16 a[188:189], v9 offset:32768
    v_mfma_f32_16x16x32_bf16 v[152:155], v[192:195], v[56:59], v[152:155]
    v_exp_f32 v149, v149
    v_mfma_f32_16x16x32_bf16 v[152:155], v[196:199], v[60:63], v[152:155]
    ds_read_b64_tr_b16 a[190:191], v9 offset:33792
    v_cvt_pk_bf16_f32 v142, v148, v149
    v_mfma_f32_16x16x32_bf16 v[156:159], v[200:203], v[60:63], v[116:119]
    v_exp_f32 v150, v150
    v_mfma_f32_16x16x32_bf16 v[156:159], v[204:207], v[56:59], v[156:159]
    ds_read_b64_tr_b16 a[192:193], v10 offset:32768
    ds_read_b64_tr_b16 a[194:195], v10 offset:33792
    v_mfma_f32_16x16x32_bf16 v[156:159], v[208:211], v[52:55], v[156:159]
    v_exp_f32 v151, v151
    v_mfma_f32_16x16x32_bf16 v[156:159], v[212:215], v[48:51], v[156:159]
    ds_read_b64_tr_b16 a[196:197], v10 offset:34816
    v_cvt_pk_bf16_f32 v143, v150, v151
    v_mfma_f32_16x16x32_bf16 v[160:163], v[216:219], v[48:51], v[116:119]
    ds_read_b64_tr_b16 a[198:199], v10 offset:35840
    ds_read_b64_tr_b16 a[200:201], v11 offset:34816
    v_mfma_f32_16x16x32_bf16 v[160:163], v[220:223], v[52:55], v[160:163]
    v_exp_f32 v152, v152
    v_mfma_f32_16x16x32_bf16 v[160:163], v[224:227], v[56:59], v[160:163]
    ds_read_b64_tr_b16 a[202:203], v11 offset:35840
    ds_read_b64_tr_b16 a[204:205], v11 offset:32768
    v_mfma_f32_16x16x32_bf16 v[160:163], v[228:231], v[60:63], v[160:163]
    v_exp_f32 v153, v153
    v_mfma_f32_16x16x32_bf16 v[164:167], v[232:235], v[60:63], v[116:119]
    ds_read_b64_tr_b16 a[206:207], v11 offset:33792
    v_cvt_pk_bf16_f32 v152, v152, v153
    v_mfma_f32_16x16x32_bf16 v[164:167], v[236:239], v[56:59], v[164:167]
    v_exp_f32 v154, v154
    v_mfma_f32_16x16x32_bf16 v[164:167], v[240:243], v[52:55], v[164:167]
    ds_read_b64_tr_b16 a[208:209], v12 offset:32768
    ds_read_b64_tr_b16 a[210:211], v12 offset:33792
    v_mfma_f32_16x16x32_bf16 v[164:167], v[244:247], v[48:51], v[164:167]
    s_waitcnt lgkmcnt(7)
    v_exp_f32 v155, v155
    v_mfma_f32_16x16x32_bf16 a[0:3], a[160:163], v[136:139], a[0:3]
    ds_read_b64_tr_b16 a[212:213], v12 offset:34816
    v_cvt_pk_bf16_f32 v153, v154, v155
    v_mfma_f32_16x16x32_bf16 a[0:3], a[164:167], v[140:143], a[0:3]
    v_exp_f32 v156, v156
    v_mfma_f32_16x16x32_bf16 a[4:7], a[168:171], v[140:143], a[4:7]
    ds_read_b64_tr_b16 a[214:215], v12 offset:35840
    ds_read_b64_tr_b16 a[216:217], v13 offset:34816
    v_mfma_f32_16x16x32_bf16 a[4:7], a[172:175], v[136:139], a[4:7]
    v_exp_f32 v157, v157
    v_mfma_f32_16x16x32_bf16 a[8:11], a[176:179], v[136:139], a[8:11]
    ds_read_b64_tr_b16 a[218:219], v13 offset:35840
    v_cvt_pk_bf16_f32 v154, v156, v157
    v_mfma_f32_16x16x32_bf16 a[8:11], a[180:183], v[140:143], a[8:11]
    v_exp_f32 v158, v158
    v_mfma_f32_16x16x32_bf16 a[12:15], a[184:187], v[140:143], a[12:15]
    ds_read_b64_tr_b16 a[220:221], v13 offset:32768
    ds_read_b64_tr_b16 a[222:223], v13 offset:33792
    v_mfma_f32_16x16x32_bf16 a[12:15], a[188:191], v[136:139], a[12:15]
    v_exp_f32 v159, v159
    v_mfma_f32_16x16x32_bf16 a[16:19], a[192:195], v[136:139], a[16:19]
    s_waitcnt lgkmcnt(5)
    v_cvt_pk_bf16_f32 v155, v158, v159
    v_mfma_f32_16x16x32_bf16 a[16:19], a[196:199], v[140:143], a[16:19]
    v_exp_f32 v160, v160
    v_mfma_f32_16x16x32_bf16 a[20:23], a[200:203], v[140:143], a[20:23]
    v_mfma_f32_16x16x32_bf16 a[20:23], a[204:207], v[136:139], a[20:23]
    v_exp_f32 v161, v161
    v_mfma_f32_16x16x32_bf16 a[24:27], a[208:211], v[136:139], a[24:27]
    s_waitcnt lgkmcnt(2)
    v_cvt_pk_bf16_f32 v156, v160, v161
    v_mfma_f32_16x16x32_bf16 a[24:27], a[212:215], v[140:143], a[24:27]
    v_exp_f32 v162, v162
    v_mfma_f32_16x16x32_bf16 a[28:31], a[216:219], v[140:143], a[28:31]
    s_waitcnt lgkmcnt(0)
    v_mfma_f32_16x16x32_bf16 a[28:31], a[220:223], v[136:139], a[28:31]
    s_waitcnt vmcnt(32) lgkmcnt(0)
    v_exp_f32 v163, v163
    v_smfmac_f32_16x16x64_bf16 v[20:23], v[132:135], v[136:143], v0
    s_barrier
    v_cvt_pk_bf16_f32 v157, v162, v163
    v_mfma_f32_16x16x32_bf16 v[136:139], v[184:187], v[64:67], v[120:123]
    v_exp_f32 v164, v164
    v_mfma_f32_16x16x32_bf16 v[136:139], v[188:191], v[68:71], v[136:139]
    ds_read_b128 a[128:131], v96 offset:0
    v_mfma_f32_16x16x32_bf16 v[136:139], v[192:195], v[72:75], v[136:139]
    v_exp_f32 v165, v165
    v_mfma_f32_16x16x32_bf16 v[136:139], v[196:199], v[76:79], v[136:139]
    ds_read_b128 a[132:135], v97 offset:1024
    v_cvt_pk_bf16_f32 v158, v164, v165
    v_mfma_f32_16x16x32_bf16 v[140:143], v[200:203], v[76:79], v[120:123]
    v_exp_f32 v166, v166
    v_mfma_f32_16x16x32_bf16 v[140:143], v[204:207], v[72:75], v[140:143]
    ds_read_b128 a[136:139], v96 offset:2048
    v_mfma_f32_16x16x32_bf16 v[140:143], v[208:211], v[68:71], v[140:143]
    v_exp_f32 v167, v167
    v_mfma_f32_16x16x32_bf16 v[140:143], v[212:215], v[64:67], v[140:143]
    ds_read_b128 a[140:143], v97 offset:3072
    v_cvt_pk_bf16_f32 v159, v166, v167
    v_mfma_f32_16x16x32_bf16 v[144:147], v[216:219], v[64:67], v[120:123]
    v_mfma_f32_16x16x32_bf16 v[144:147], v[220:223], v[68:71], v[144:147]
    ds_read_b128 a[144:147], v96 offset:4096
    v_exp_f32 v136, v136
    v_mfma_f32_16x16x32_bf16 v[144:147], v[224:227], v[72:75], v[144:147]
    s_waitcnt lgkmcnt(4)
    s_mov_b32 s54, 0
    buffer_store_dwordx4 a[128:131], v18, s[20:23], s54 offen sc1 nt
    v_mfma_f32_16x16x32_bf16 v[144:147], v[228:231], v[76:79], v[144:147]
    ds_read_b128 a[148:151], v97 offset:5120
    v_exp_f32 v137, v137
    v_mfma_f32_16x16x32_bf16 v[148:151], v[232:235], v[76:79], v[120:123]
    s_waitcnt lgkmcnt(4)
    s_mov_b32 s54, 4096
    buffer_store_dwordx4 a[132:135], v18, s[20:23], s54 offen sc1 nt
    v_cvt_pk_bf16_f32 v136, v136, v137
    v_mfma_f32_16x16x32_bf16 v[148:151], v[236:239], v[72:75], v[148:151]
    ds_read_b128 a[152:155], v96 offset:6144
    v_exp_f32 v138, v138
    v_mfma_f32_16x16x32_bf16 v[148:151], v[240:243], v[68:71], v[148:151]
    s_waitcnt lgkmcnt(4)
    s_mov_b32 s54, 8192
    buffer_store_dwordx4 a[136:139], v18, s[20:23], s54 offen sc1 nt
    v_mfma_f32_16x16x32_bf16 v[148:151], v[244:247], v[64:67], v[148:151]
    ds_read_b128 a[156:159], v97 offset:7168
    v_exp_f32 v139, v139
    v_mfma_f32_16x16x32_bf16 a[32:35], a[160:163], v[152:155], a[32:35]
    s_waitcnt lgkmcnt(4)
    s_mov_b32 s54, 12288
    buffer_store_dwordx4 a[140:143], v18, s[20:23], s54 offen sc1 nt
    v_cvt_pk_bf16_f32 v137, v138, v139
    v_mfma_f32_16x16x32_bf16 a[32:35], a[164:167], v[156:159], a[32:35]
    ds_read_b128 a[128:131], v96 offset:8192
    v_exp_f32 v140, v140
    v_mfma_f32_16x16x32_bf16 a[36:39], a[168:171], v[156:159], a[36:39]
    s_waitcnt lgkmcnt(4)
    s_mov_b32 s54, 0
    buffer_store_dwordx4 a[144:147], v18, s[20:23], s54 offen offset:1024 sc1 nt
    v_mfma_f32_16x16x32_bf16 a[36:39], a[172:175], v[152:155], a[36:39]
    ds_read_b128 a[132:135], v97 offset:9216
    v_exp_f32 v141, v141
    v_mfma_f32_16x16x32_bf16 a[40:43], a[176:179], v[152:155], a[40:43]
    s_waitcnt lgkmcnt(4)
    s_mov_b32 s54, 4096
    buffer_store_dwordx4 a[148:151], v18, s[20:23], s54 offen offset:1024 sc1 nt
    v_cvt_pk_bf16_f32 v138, v140, v141
    v_mfma_f32_16x16x32_bf16 a[40:43], a[180:183], v[156:159], a[40:43]
    ds_read_b128 a[136:139], v96 offset:10240
    v_exp_f32 v142, v142
    v_mfma_f32_16x16x32_bf16 a[44:47], a[184:187], v[156:159], a[44:47]
    s_waitcnt lgkmcnt(4)
    s_mov_b32 s54, 8192
    buffer_store_dwordx4 a[152:155], v18, s[20:23], s54 offen offset:1024 sc1 nt
    v_mfma_f32_16x16x32_bf16 a[44:47], a[188:191], v[152:155], a[44:47]
    ds_read_b128 a[140:143], v97 offset:11264
    v_exp_f32 v143, v143
    v_mfma_f32_16x16x32_bf16 a[48:51], a[192:195], v[152:155], a[48:51]
    s_waitcnt lgkmcnt(4)
    s_mov_b32 s54, 12288
    buffer_store_dwordx4 a[156:159], v18, s[20:23], s54 offen offset:1024 sc1 nt
    v_cvt_pk_bf16_f32 v139, v142, v143
    v_mfma_f32_16x16x32_bf16 a[48:51], a[196:199], v[156:159], a[48:51]
    ds_read_b128 a[144:147], v96 offset:12288
    v_exp_f32 v144, v144
    v_mfma_f32_16x16x32_bf16 a[52:55], a[200:203], v[156:159], a[52:55]
    s_waitcnt lgkmcnt(4)
    s_mov_b32 s54, 0
    buffer_store_dwordx4 a[128:131], v18, s[20:23], s54 offen offset:2048 sc1 nt
    v_mfma_f32_16x16x32_bf16 a[52:55], a[204:207], v[152:155], a[52:55]
    ds_read_b128 a[148:151], v97 offset:13312
    v_exp_f32 v145, v145
    v_mfma_f32_16x16x32_bf16 a[56:59], a[208:211], v[152:155], a[56:59]
    s_waitcnt lgkmcnt(4)
    s_mov_b32 s54, 4096
    buffer_store_dwordx4 a[132:135], v18, s[20:23], s54 offen offset:2048 sc1 nt
    v_cvt_pk_bf16_f32 v140, v144, v145
    v_mfma_f32_16x16x32_bf16 a[56:59], a[212:215], v[156:159], a[56:59]
    ds_read_b128 a[152:155], v96 offset:14336
    v_exp_f32 v146, v146
    v_mfma_f32_16x16x32_bf16 a[60:63], a[216:219], v[156:159], a[60:63]
    s_waitcnt lgkmcnt(4)
    s_mov_b32 s54, 8192
    buffer_store_dwordx4 a[136:139], v18, s[20:23], s54 offen offset:2048 sc1 nt
    v_mfma_f32_16x16x32_bf16 a[60:63], a[220:223], v[152:155], a[60:63]
    ds_read_b128 a[156:159], v97 offset:15360
    v_exp_f32 v147, v147
    v_smfmac_f32_16x16x64_bf16 v[24:27], v[132:135], v[152:159], v0
    s_waitcnt lgkmcnt(4)
    s_mov_b32 s54, 12288
    buffer_store_dwordx4 a[140:143], v18, s[20:23], s54 offen offset:2048 sc1 nt
    v_cvt_pk_bf16_f32 v141, v146, v147
    v_mfma_f32_16x16x32_bf16 v[168:171], v[184:187], v[80:83], v[124:127]
    ds_read_b128 a[128:131], v96 offset:16384
    v_exp_f32 v148, v148
    v_mfma_f32_16x16x32_bf16 v[168:171], v[188:191], v[84:87], v[168:171]
    s_waitcnt lgkmcnt(4)
    s_mov_b32 s54, 0
    buffer_store_dwordx4 a[144:147], v18, s[20:23], s54 offen offset:3072 sc1 nt
    ds_read_b128 v[184:187], v2
    v_mfma_f32_16x16x32_bf16 v[168:171], v[192:195], v[88:91], v[168:171]
    ds_read_b128 a[132:135], v97 offset:17408
    v_exp_f32 v149, v149
    v_mfma_f32_16x16x32_bf16 v[168:171], v[196:199], v[92:95], v[168:171]
    s_waitcnt lgkmcnt(5)
    s_mov_b32 s54, 4096
    buffer_store_dwordx4 a[148:151], v18, s[20:23], s54 offen offset:3072 sc1 nt
    ds_read_b128 v[188:191], v3
    v_cvt_pk_bf16_f32 v142, v148, v149
    v_mfma_f32_16x16x32_bf16 v[172:175], v[200:203], v[92:95], v[124:127]
    ds_read_b128 a[136:139], v96 offset:18432
    v_exp_f32 v150, v150
    v_mfma_f32_16x16x32_bf16 v[172:175], v[204:207], v[88:91], v[172:175]
    s_waitcnt lgkmcnt(6)
    s_mov_b32 s54, 8192
    buffer_store_dwordx4 a[152:155], v18, s[20:23], s54 offen offset:3072 sc1 nt
    ds_read_b128 v[192:195], v4
    v_mfma_f32_16x16x32_bf16 v[172:175], v[208:211], v[84:87], v[172:175]
    ds_read_b128 a[140:143], v97 offset:19456
    v_exp_f32 v151, v151
    v_mfma_f32_16x16x32_bf16 v[172:175], v[212:215], v[80:83], v[172:175]
    s_waitcnt lgkmcnt(7)
    s_mov_b32 s54, 12288
    buffer_store_dwordx4 a[156:159], v18, s[20:23], s54 offen offset:3072 sc1 nt
    ds_read_b128 v[196:199], v5
    v_cvt_pk_bf16_f32 v143, v150, v151
    v_mfma_f32_16x16x32_bf16 v[176:179], v[216:219], v[80:83], v[124:127]
    ds_read_b128 a[144:147], v96 offset:20480
    ds_read_b128 v[200:203], v5 offset:1024
    v_mfma_f32_16x16x32_bf16 v[176:179], v[220:223], v[84:87], v[176:179]
    s_waitcnt lgkmcnt(8)
    s_mov_b32 s54, 16384
    buffer_store_dwordx4 a[128:131], v18, s[20:23], s54 offen sc1 nt
    v_exp_f32 v168, v168
    v_mfma_f32_16x16x32_bf16 v[176:179], v[224:227], v[88:91], v[176:179]
    ds_read_b128 a[148:151], v97 offset:21504
    ds_read_b128 v[204:207], v4 offset:1024
    v_mfma_f32_16x16x32_bf16 v[176:179], v[228:231], v[92:95], v[176:179]
    s_waitcnt lgkmcnt(8)
    s_mov_b32 s54, 20480
    buffer_store_dwordx4 a[132:135], v18, s[20:23], s54 offen sc1 nt
    v_exp_f32 v169, v169
    v_mfma_f32_16x16x32_bf16 v[180:183], v[232:235], v[92:95], v[124:127]
    ds_read_b128 a[152:155], v96 offset:22528
    ds_read_b128 v[208:211], v3 offset:1024
    v_cvt_pk_bf16_f32 v168, v168, v169
    v_mfma_f32_16x16x32_bf16 v[180:183], v[236:239], v[88:91], v[180:183]
    s_waitcnt lgkmcnt(8)
    s_mov_b32 s54, 24576
    buffer_store_dwordx4 a[136:139], v18, s[20:23], s54 offen sc1 nt
    v_exp_f32 v170, v170
    v_mfma_f32_16x16x32_bf16 v[180:183], v[240:243], v[84:87], v[180:183]
    ds_read_b128 a[156:159], v97 offset:23552
    ds_read_b128 v[212:215], v2 offset:1024
    v_mfma_f32_16x16x32_bf16 v[180:183], v[244:247], v[80:83], v[180:183]
    s_waitcnt lgkmcnt(8)
    s_mov_b32 s54, 28672
    buffer_store_dwordx4 a[140:143], v18, s[20:23], s54 offen sc1 nt
    v_exp_f32 v171, v171
    v_mfma_f32_16x16x32_bf16 a[64:67], a[160:163], v[136:139], a[64:67]
    ds_read_b128 a[128:131], v96 offset:24576
    ds_read_b128 v[216:219], v2 offset:2048
    v_cvt_pk_bf16_f32 v169, v170, v171
    v_mfma_f32_16x16x32_bf16 a[64:67], a[164:167], v[140:143], a[64:67]
    s_waitcnt lgkmcnt(8)
    s_mov_b32 s54, 16384
    buffer_store_dwordx4 a[144:147], v18, s[20:23], s54 offen offset:1024 sc1 nt
    v_exp_f32 v172, v172
    v_mfma_f32_16x16x32_bf16 a[68:71], a[168:171], v[140:143], a[68:71]
    ds_read_b128 a[132:135], v97 offset:25600
    ds_read_b128 v[220:223], v3 offset:2048
    v_mfma_f32_16x16x32_bf16 a[68:71], a[172:175], v[136:139], a[68:71]
    s_waitcnt lgkmcnt(8)
    s_mov_b32 s54, 20480
    buffer_store_dwordx4 a[148:151], v18, s[20:23], s54 offen offset:1024 sc1 nt
    v_exp_f32 v173, v173
    v_mfma_f32_16x16x32_bf16 a[72:75], a[176:179], v[136:139], a[72:75]
    ds_read_b128 a[136:139], v96 offset:26624
    ds_read_b128 v[224:227], v4 offset:2048
    v_cvt_pk_bf16_f32 v170, v172, v173
    v_mfma_f32_16x16x32_bf16 a[72:75], a[180:183], v[140:143], a[72:75]
    s_waitcnt lgkmcnt(8)
    s_mov_b32 s54, 24576
    buffer_store_dwordx4 a[152:155], v18, s[20:23], s54 offen offset:1024 sc1 nt
    v_exp_f32 v174, v174
    v_mfma_f32_16x16x32_bf16 a[76:79], a[184:187], v[140:143], a[76:79]
    ds_read_b128 a[140:143], v97 offset:27648
    ds_read_b128 v[228:231], v5 offset:2048
    v_mfma_f32_16x16x32_bf16 a[76:79], a[188:191], v[136:139], a[76:79]
    s_waitcnt lgkmcnt(8)
    s_mov_b32 s54, 28672
    buffer_store_dwordx4 a[156:159], v18, s[20:23], s54 offen offset:1024 sc1 nt
    v_exp_f32 v175, v175
    v_mfma_f32_16x16x32_bf16 a[80:83], a[192:195], v[136:139], a[80:83]
    ds_read_b128 a[144:147], v96 offset:28672
    ds_read_b128 v[232:235], v5 offset:3072
    v_cvt_pk_bf16_f32 v171, v174, v175
    v_mfma_f32_16x16x32_bf16 a[80:83], a[196:199], v[140:143], a[80:83]
    s_waitcnt lgkmcnt(8)
    s_mov_b32 s54, 16384
    buffer_store_dwordx4 a[128:131], v18, s[20:23], s54 offen offset:2048 sc1 nt
    v_exp_f32 v176, v176
    v_mfma_f32_16x16x32_bf16 a[84:87], a[200:203], v[140:143], a[84:87]
    ds_read_b128 a[148:151], v97 offset:29696
    ds_read_b128 v[236:239], v4 offset:3072
    v_mfma_f32_16x16x32_bf16 a[84:87], a[204:207], v[136:139], a[84:87]
    s_waitcnt lgkmcnt(8)
    s_mov_b32 s54, 20480
    buffer_store_dwordx4 a[132:135], v18, s[20:23], s54 offen offset:2048 sc1 nt
    v_exp_f32 v177, v177
    v_mfma_f32_16x16x32_bf16 a[88:91], a[208:211], v[136:139], a[88:91]
    ds_read_b128 a[152:155], v96 offset:30720
    ds_read_b128 v[240:243], v3 offset:3072
    v_cvt_pk_bf16_f32 v172, v176, v177
    v_mfma_f32_16x16x32_bf16 a[88:91], a[212:215], v[140:143], a[88:91]
    s_waitcnt lgkmcnt(8)
    s_mov_b32 s54, 24576
    buffer_store_dwordx4 a[136:139], v18, s[20:23], s54 offen offset:2048 sc1 nt
    v_exp_f32 v178, v178
    v_mfma_f32_16x16x32_bf16 a[92:95], a[216:219], v[140:143], a[92:95]
    ds_read_b128 a[156:159], v97 offset:31744
    ds_read_b128 v[244:247], v2 offset:3072
    v_mfma_f32_16x16x32_bf16 a[92:95], a[220:223], v[136:139], a[92:95]
    s_waitcnt lgkmcnt(8)
    s_mov_b32 s54, 28672
    buffer_store_dwordx4 a[140:143], v18, s[20:23], s54 offen offset:2048 sc1 nt
    v_exp_f32 v179, v179
    v_smfmac_f32_16x16x64_bf16 v[28:31], v[132:135], v[136:143], v0
    v_cvt_pk_bf16_f32 v173, v178, v179
    v_mfma_f32_16x16x32_bf16 v[136:139], v[184:187], v[32:35], v[112:115]
    s_waitcnt lgkmcnt(6)
    s_mov_b32 s54, 16384
    buffer_store_dwordx4 a[144:147], v18, s[20:23], s54 offen offset:3072 sc1 nt
    v_exp_f32 v180, v180
    v_mfma_f32_16x16x32_bf16 v[136:139], v[188:191], v[36:39], v[136:139]
    v_mfma_f32_16x16x32_bf16 v[136:139], v[192:195], v[40:43], v[136:139]
    s_waitcnt lgkmcnt(4)
    s_mov_b32 s54, 20480
    buffer_store_dwordx4 a[148:151], v18, s[20:23], s54 offen offset:3072 sc1 nt
    v_exp_f32 v181, v181
    v_mfma_f32_16x16x32_bf16 v[136:139], v[196:199], v[44:47], v[136:139]
    v_cvt_pk_bf16_f32 v174, v180, v181
    v_mfma_f32_16x16x32_bf16 v[140:143], v[200:203], v[44:47], v[112:115]
    s_waitcnt lgkmcnt(2)
    s_mov_b32 s54, 24576
    buffer_store_dwordx4 a[152:155], v18, s[20:23], s54 offen offset:3072 sc1 nt
    v_exp_f32 v182, v182
    v_mfma_f32_16x16x32_bf16 v[140:143], v[204:207], v[40:43], v[140:143]
    v_mfma_f32_16x16x32_bf16 v[140:143], v[208:211], v[36:39], v[140:143]
    s_waitcnt lgkmcnt(0)
    s_mov_b32 s54, 28672
    buffer_store_dwordx4 a[156:159], v18, s[20:23], s54 offen offset:3072 sc1 nt
    v_exp_f32 v183, v183
    v_mfma_f32_16x16x32_bf16 v[140:143], v[212:215], v[32:35], v[140:143]
    v_cvt_pk_bf16_f32 v175, v182, v183
    v_mfma_f32_16x16x32_bf16 v[144:147], v[216:219], v[32:35], v[112:115]
    s_waitcnt lgkmcnt(0)
    v_mfma_f32_16x16x32_bf16 v[144:147], v[220:223], v[36:39], v[144:147]
    v_exp_f32 v136, v136
    v_mfma_f32_16x16x32_bf16 v[144:147], v[224:227], v[40:43], v[144:147]
    v_mfma_f32_16x16x32_bf16 v[144:147], v[228:231], v[44:47], v[144:147]
    v_exp_f32 v137, v137
    v_mfma_f32_16x16x32_bf16 v[148:151], v[232:235], v[44:47], v[112:115]
    v_cvt_pk_bf16_f32 v136, v136, v137
    v_mfma_f32_16x16x32_bf16 v[148:151], v[236:239], v[40:43], v[148:151]
    v_exp_f32 v138, v138
    v_mfma_f32_16x16x32_bf16 v[148:151], v[240:243], v[36:39], v[148:151]
    v_mfma_f32_16x16x32_bf16 v[148:151], v[244:247], v[32:35], v[148:151]
    v_exp_f32 v139, v139
    v_mfma_f32_16x16x32_bf16 a[96:99], a[160:163], v[168:171], a[96:99]
    ds_read_b64_tr_b16 a[160:161], v6
    v_cvt_pk_bf16_f32 v137, v138, v139
    v_mfma_f32_16x16x32_bf16 a[96:99], a[164:167], v[172:175], a[96:99]
    v_exp_f32 v140, v140
    v_mfma_f32_16x16x32_bf16 a[100:103], a[168:171], v[172:175], a[100:103]
    ds_read_b64_tr_b16 a[162:163], v6 offset:1024
    ds_read_b64_tr_b16 a[164:165], v6 offset:2048
    v_mfma_f32_16x16x32_bf16 a[100:103], a[172:175], v[168:171], a[100:103]
    v_exp_f32 v141, v141
    v_mfma_f32_16x16x32_bf16 a[104:107], a[176:179], v[168:171], a[104:107]
    ds_read_b64_tr_b16 a[166:167], v6 offset:3072
    v_cvt_pk_bf16_f32 v138, v140, v141
    v_mfma_f32_16x16x32_bf16 a[104:107], a[180:183], v[172:175], a[104:107]
    v_exp_f32 v142, v142
    v_mfma_f32_16x16x32_bf16 a[108:111], a[184:187], v[172:175], a[108:111]
    ds_read_b64_tr_b16 a[168:169], v7 offset:2048
    ds_read_b64_tr_b16 a[170:171], v7 offset:3072
    v_mfma_f32_16x16x32_bf16 a[108:111], a[188:191], v[168:171], a[108:111]
    v_exp_f32 v143, v143
    v_mfma_f32_16x16x32_bf16 a[112:115], a[192:195], v[168:171], a[112:115]
    ds_read_b64_tr_b16 a[172:173], v7
    v_cvt_pk_bf16_f32 v139, v142, v143
    v_mfma_f32_16x16x32_bf16 a[112:115], a[196:199], v[172:175], a[112:115]
    v_exp_f32 v144, v144
    v_mfma_f32_16x16x32_bf16 a[116:119], a[200:203], v[172:175], a[116:119]
    ds_read_b64_tr_b16 a[174:175], v7 offset:1024
    ds_read_b64_tr_b16 a[176:177], v8
    v_mfma_f32_16x16x32_bf16 a[116:119], a[204:207], v[168:171], a[116:119]
    v_exp_f32 v145, v145
    v_mfma_f32_16x16x32_bf16 a[120:123], a[208:211], v[168:171], a[120:123]
    ds_read_b64_tr_b16 a[178:179], v8 offset:1024
    v_cvt_pk_bf16_f32 v140, v144, v145
    v_mfma_f32_16x16x32_bf16 a[120:123], a[212:215], v[172:175], a[120:123]
    v_exp_f32 v146, v146
    v_mfma_f32_16x16x32_bf16 a[124:127], a[216:219], v[172:175], a[124:127]
    ds_read_b64_tr_b16 a[180:181], v8 offset:2048
    ds_read_b64_tr_b16 a[182:183], v8 offset:3072
    v_mfma_f32_16x16x32_bf16 a[124:127], a[220:223], v[168:171], a[124:127]
    v_exp_f32 v147, v147
    v_smfmac_f32_16x16x64_bf16 v[248:251], v[132:135], v[168:175], v0
    ds_read_b64_tr_b16 a[184:185], v9 offset:2048
    v_cvt_pk_bf16_f32 v141, v146, v147
    v_mfma_f32_16x16x32_bf16 v[152:155], v[184:187], v[48:51], v[116:119]
    v_exp_f32 v148, v148
    v_mfma_f32_16x16x32_bf16 v[152:155], v[188:191], v[52:55], v[152:155]
    ds_read_b64_tr_b16 a[186:187], v9 offset:3072
    ds_read_b64_tr_b16 a[188:189], v9
    v_mfma_f32_16x16x32_bf16 v[152:155], v[192:195], v[56:59], v[152:155]
    v_exp_f32 v149, v149
    v_mfma_f32_16x16x32_bf16 v[152:155], v[196:199], v[60:63], v[152:155]
    ds_read_b64_tr_b16 a[190:191], v9 offset:1024
    v_cvt_pk_bf16_f32 v142, v148, v149
    v_mfma_f32_16x16x32_bf16 v[156:159], v[200:203], v[60:63], v[116:119]
    v_exp_f32 v150, v150
    v_mfma_f32_16x16x32_bf16 v[156:159], v[204:207], v[56:59], v[156:159]
    ds_read_b64_tr_b16 a[192:193], v10
    ds_read_b64_tr_b16 a[194:195], v10 offset:1024
    v_mfma_f32_16x16x32_bf16 v[156:159], v[208:211], v[52:55], v[156:159]
    v_exp_f32 v151, v151
    v_mfma_f32_16x16x32_bf16 v[156:159], v[212:215], v[48:51], v[156:159]
    ds_read_b64_tr_b16 a[196:197], v10 offset:2048
    v_cvt_pk_bf16_f32 v143, v150, v151
    v_mfma_f32_16x16x32_bf16 v[160:163], v[216:219], v[48:51], v[116:119]
    ds_read_b64_tr_b16 a[198:199], v10 offset:3072
    ds_read_b64_tr_b16 a[200:201], v11 offset:2048
    v_mfma_f32_16x16x32_bf16 v[160:163], v[220:223], v[52:55], v[160:163]
    v_exp_f32 v152, v152
    v_mfma_f32_16x16x32_bf16 v[160:163], v[224:227], v[56:59], v[160:163]
    ds_read_b64_tr_b16 a[202:203], v11 offset:3072
    ds_read_b64_tr_b16 a[204:205], v11
    v_mfma_f32_16x16x32_bf16 v[160:163], v[228:231], v[60:63], v[160:163]
    v_exp_f32 v153, v153
    v_mfma_f32_16x16x32_bf16 v[164:167], v[232:235], v[60:63], v[116:119]
    ds_read_b64_tr_b16 a[206:207], v11 offset:1024
    v_cvt_pk_bf16_f32 v152, v152, v153
    v_mfma_f32_16x16x32_bf16 v[164:167], v[236:239], v[56:59], v[164:167]
    v_exp_f32 v154, v154
    v_mfma_f32_16x16x32_bf16 v[164:167], v[240:243], v[52:55], v[164:167]
    ds_read_b64_tr_b16 a[208:209], v12
    ds_read_b64_tr_b16 a[210:211], v12 offset:1024
    v_mfma_f32_16x16x32_bf16 v[164:167], v[244:247], v[48:51], v[164:167]
    s_waitcnt lgkmcnt(7)
    v_exp_f32 v155, v155
    v_mfma_f32_16x16x32_bf16 a[0:3], a[160:163], v[136:139], a[0:3]
    ds_read_b64_tr_b16 a[212:213], v12 offset:2048
    v_cvt_pk_bf16_f32 v153, v154, v155
    v_mfma_f32_16x16x32_bf16 a[0:3], a[164:167], v[140:143], a[0:3]
    v_exp_f32 v156, v156
    v_mfma_f32_16x16x32_bf16 a[4:7], a[168:171], v[140:143], a[4:7]
    ds_read_b64_tr_b16 a[214:215], v12 offset:3072
    ds_read_b64_tr_b16 a[216:217], v13 offset:2048
    v_mfma_f32_16x16x32_bf16 a[4:7], a[172:175], v[136:139], a[4:7]
    v_exp_f32 v157, v157
    v_mfma_f32_16x16x32_bf16 a[8:11], a[176:179], v[136:139], a[8:11]
    ds_read_b64_tr_b16 a[218:219], v13 offset:3072
    v_cvt_pk_bf16_f32 v154, v156, v157
    v_mfma_f32_16x16x32_bf16 a[8:11], a[180:183], v[140:143], a[8:11]
    v_exp_f32 v158, v158
    v_mfma_f32_16x16x32_bf16 a[12:15], a[184:187], v[140:143], a[12:15]
    ds_read_b64_tr_b16 a[220:221], v13
    ds_read_b64_tr_b16 a[222:223], v13 offset:1024
    v_mfma_f32_16x16x32_bf16 a[12:15], a[188:191], v[136:139], a[12:15]
    v_exp_f32 v159, v159
    v_mfma_f32_16x16x32_bf16 a[16:19], a[192:195], v[136:139], a[16:19]
    s_waitcnt lgkmcnt(5)
    v_cvt_pk_bf16_f32 v155, v158, v159
    v_mfma_f32_16x16x32_bf16 a[16:19], a[196:199], v[140:143], a[16:19]
    v_exp_f32 v160, v160
    v_mfma_f32_16x16x32_bf16 a[20:23], a[200:203], v[140:143], a[20:23]
    v_mfma_f32_16x16x32_bf16 a[20:23], a[204:207], v[136:139], a[20:23]
    v_exp_f32 v161, v161
    v_mfma_f32_16x16x32_bf16 a[24:27], a[208:211], v[136:139], a[24:27]
    s_waitcnt lgkmcnt(2)
    v_cvt_pk_bf16_f32 v156, v160, v161
    v_mfma_f32_16x16x32_bf16 a[24:27], a[212:215], v[140:143], a[24:27]
    v_exp_f32 v162, v162
    v_mfma_f32_16x16x32_bf16 a[28:31], a[216:219], v[140:143], a[28:31]
    s_waitcnt lgkmcnt(0)
    v_mfma_f32_16x16x32_bf16 a[28:31], a[220:223], v[136:139], a[28:31]
    s_waitcnt vmcnt(32) lgkmcnt(0)
    v_exp_f32 v163, v163
    v_smfmac_f32_16x16x64_bf16 v[20:23], v[132:135], v[136:143], v0
    s_barrier
    v_cvt_pk_bf16_f32 v157, v162, v163
    v_mfma_f32_16x16x32_bf16 v[136:139], v[184:187], v[64:67], v[120:123]
    v_exp_f32 v164, v164
    v_mfma_f32_16x16x32_bf16 v[136:139], v[188:191], v[68:71], v[136:139]
    ds_read_b128 a[128:131], v96 offset:32768
    v_mfma_f32_16x16x32_bf16 v[136:139], v[192:195], v[72:75], v[136:139]
    v_exp_f32 v165, v165
    v_mfma_f32_16x16x32_bf16 v[136:139], v[196:199], v[76:79], v[136:139]
    ds_read_b128 a[132:135], v97 offset:33792
    v_cvt_pk_bf16_f32 v158, v164, v165
    v_mfma_f32_16x16x32_bf16 v[140:143], v[200:203], v[76:79], v[120:123]
    v_exp_f32 v166, v166
    v_mfma_f32_16x16x32_bf16 v[140:143], v[204:207], v[72:75], v[140:143]
    ds_read_b128 a[136:139], v96 offset:34816
    v_mfma_f32_16x16x32_bf16 v[140:143], v[208:211], v[68:71], v[140:143]
    v_exp_f32 v167, v167
    v_mfma_f32_16x16x32_bf16 v[140:143], v[212:215], v[64:67], v[140:143]
    ds_read_b128 a[140:143], v97 offset:35840
    v_cvt_pk_bf16_f32 v159, v166, v167
    v_mfma_f32_16x16x32_bf16 v[144:147], v[216:219], v[64:67], v[120:123]
    v_mfma_f32_16x16x32_bf16 v[144:147], v[220:223], v[68:71], v[144:147]
    ds_read_b128 a[144:147], v96 offset:36864
    v_exp_f32 v136, v136
    v_mfma_f32_16x16x32_bf16 v[144:147], v[224:227], v[72:75], v[144:147]
    s_waitcnt lgkmcnt(4)
    s_mov_b32 s54, 32768
    buffer_store_dwordx4 a[128:131], v18, s[20:23], s54 offen sc1 nt
    v_mfma_f32_16x16x32_bf16 v[144:147], v[228:231], v[76:79], v[144:147]
    ds_read_b128 a[148:151], v97 offset:37888
    v_exp_f32 v137, v137
    v_mfma_f32_16x16x32_bf16 v[148:151], v[232:235], v[76:79], v[120:123]
    s_waitcnt lgkmcnt(4)
    s_mov_b32 s54, 36864
    buffer_store_dwordx4 a[132:135], v18, s[20:23], s54 offen sc1 nt
    v_cvt_pk_bf16_f32 v136, v136, v137
    v_mfma_f32_16x16x32_bf16 v[148:151], v[236:239], v[72:75], v[148:151]
    ds_read_b128 a[152:155], v96 offset:38912
    v_exp_f32 v138, v138
    v_mfma_f32_16x16x32_bf16 v[148:151], v[240:243], v[68:71], v[148:151]
    s_waitcnt lgkmcnt(4)
    s_mov_b32 s54, 40960
    buffer_store_dwordx4 a[136:139], v18, s[20:23], s54 offen sc1 nt
    v_mfma_f32_16x16x32_bf16 v[148:151], v[244:247], v[64:67], v[148:151]
    ds_read_b128 a[156:159], v97 offset:39936
    v_exp_f32 v139, v139
    v_mfma_f32_16x16x32_bf16 a[32:35], a[160:163], v[152:155], a[32:35]
    s_waitcnt lgkmcnt(4)
    s_mov_b32 s54, 45056
    buffer_store_dwordx4 a[140:143], v18, s[20:23], s54 offen sc1 nt
    v_cvt_pk_bf16_f32 v137, v138, v139
    v_mfma_f32_16x16x32_bf16 a[32:35], a[164:167], v[156:159], a[32:35]
    ds_read_b128 a[128:131], v96 offset:40960
    v_exp_f32 v140, v140
    v_mfma_f32_16x16x32_bf16 a[36:39], a[168:171], v[156:159], a[36:39]
    s_waitcnt lgkmcnt(4)
    s_mov_b32 s54, 32768
    buffer_store_dwordx4 a[144:147], v18, s[20:23], s54 offen offset:1024 sc1 nt
    v_mfma_f32_16x16x32_bf16 a[36:39], a[172:175], v[152:155], a[36:39]
    ds_read_b128 a[132:135], v97 offset:41984
    v_exp_f32 v141, v141
    v_mfma_f32_16x16x32_bf16 a[40:43], a[176:179], v[152:155], a[40:43]
    s_waitcnt lgkmcnt(4)
    s_mov_b32 s54, 36864
    buffer_store_dwordx4 a[148:151], v18, s[20:23], s54 offen offset:1024 sc1 nt
    v_cvt_pk_bf16_f32 v138, v140, v141
    v_mfma_f32_16x16x32_bf16 a[40:43], a[180:183], v[156:159], a[40:43]
    ds_read_b128 a[136:139], v96 offset:43008
    v_exp_f32 v142, v142
    v_mfma_f32_16x16x32_bf16 a[44:47], a[184:187], v[156:159], a[44:47]
    s_waitcnt lgkmcnt(4)
    s_mov_b32 s54, 40960
    buffer_store_dwordx4 a[152:155], v18, s[20:23], s54 offen offset:1024 sc1 nt
    v_mfma_f32_16x16x32_bf16 a[44:47], a[188:191], v[152:155], a[44:47]
    ds_read_b128 a[140:143], v97 offset:44032
    v_exp_f32 v143, v143
    v_mfma_f32_16x16x32_bf16 a[48:51], a[192:195], v[152:155], a[48:51]
    s_waitcnt lgkmcnt(4)
    s_mov_b32 s54, 45056
    buffer_store_dwordx4 a[156:159], v18, s[20:23], s54 offen offset:1024 sc1 nt
    v_cvt_pk_bf16_f32 v139, v142, v143
    v_mfma_f32_16x16x32_bf16 a[48:51], a[196:199], v[156:159], a[48:51]
    ds_read_b128 a[144:147], v96 offset:45056
    v_exp_f32 v144, v144
    v_mfma_f32_16x16x32_bf16 a[52:55], a[200:203], v[156:159], a[52:55]
    s_waitcnt lgkmcnt(4)
    s_mov_b32 s54, 32768
    buffer_store_dwordx4 a[128:131], v18, s[20:23], s54 offen offset:2048 sc1 nt
    v_mfma_f32_16x16x32_bf16 a[52:55], a[204:207], v[152:155], a[52:55]
    ds_read_b128 a[148:151], v97 offset:46080
    v_exp_f32 v145, v145
    v_mfma_f32_16x16x32_bf16 a[56:59], a[208:211], v[152:155], a[56:59]
    s_waitcnt lgkmcnt(4)
    s_mov_b32 s54, 36864
    buffer_store_dwordx4 a[132:135], v18, s[20:23], s54 offen offset:2048 sc1 nt
    v_cvt_pk_bf16_f32 v140, v144, v145
    v_mfma_f32_16x16x32_bf16 a[56:59], a[212:215], v[156:159], a[56:59]
    ds_read_b128 a[152:155], v96 offset:47104
    v_exp_f32 v146, v146
    v_mfma_f32_16x16x32_bf16 a[60:63], a[216:219], v[156:159], a[60:63]
    s_waitcnt lgkmcnt(4)
    s_mov_b32 s54, 40960
    buffer_store_dwordx4 a[136:139], v18, s[20:23], s54 offen offset:2048 sc1 nt
    v_mfma_f32_16x16x32_bf16 a[60:63], a[220:223], v[152:155], a[60:63]
    ds_read_b128 a[156:159], v97 offset:48128
    v_exp_f32 v147, v147
    v_smfmac_f32_16x16x64_bf16 v[24:27], v[132:135], v[152:159], v0
    s_waitcnt lgkmcnt(4)
    s_mov_b32 s54, 45056
    buffer_store_dwordx4 a[140:143], v18, s[20:23], s54 offen offset:2048 sc1 nt
    v_cvt_pk_bf16_f32 v141, v146, v147
    v_mfma_f32_16x16x32_bf16 v[168:171], v[184:187], v[80:83], v[124:127]
    ds_read_b128 a[128:131], v96 offset:49152
    v_exp_f32 v148, v148
    v_mfma_f32_16x16x32_bf16 v[168:171], v[188:191], v[84:87], v[168:171]
    s_waitcnt lgkmcnt(4)
    s_mov_b32 s54, 32768
    buffer_store_dwordx4 a[144:147], v18, s[20:23], s54 offen offset:3072 sc1 nt
    ds_read_b128 v[184:187], v2 offset:16384
    v_mfma_f32_16x16x32_bf16 v[168:171], v[192:195], v[88:91], v[168:171]
    ds_read_b128 a[132:135], v97 offset:50176
    v_exp_f32 v149, v149
    v_mfma_f32_16x16x32_bf16 v[168:171], v[196:199], v[92:95], v[168:171]
    s_waitcnt lgkmcnt(5)
    s_mov_b32 s54, 36864
    buffer_store_dwordx4 a[148:151], v18, s[20:23], s54 offen offset:3072 sc1 nt
    ds_read_b128 v[188:191], v3 offset:16384
    v_cvt_pk_bf16_f32 v142, v148, v149
    v_mfma_f32_16x16x32_bf16 v[172:175], v[200:203], v[92:95], v[124:127]
    ds_read_b128 a[136:139], v96 offset:51200
    v_exp_f32 v150, v150
    v_mfma_f32_16x16x32_bf16 v[172:175], v[204:207], v[88:91], v[172:175]
    s_waitcnt lgkmcnt(6)
    s_mov_b32 s54, 40960
    buffer_store_dwordx4 a[152:155], v18, s[20:23], s54 offen offset:3072 sc1 nt
    ds_read_b128 v[192:195], v4 offset:16384
    v_mfma_f32_16x16x32_bf16 v[172:175], v[208:211], v[84:87], v[172:175]
    ds_read_b128 a[140:143], v97 offset:52224
    v_exp_f32 v151, v151
    v_mfma_f32_16x16x32_bf16 v[172:175], v[212:215], v[80:83], v[172:175]
    s_waitcnt lgkmcnt(7)
    s_mov_b32 s54, 45056
    buffer_store_dwordx4 a[156:159], v18, s[20:23], s54 offen offset:3072 sc1 nt
    ds_read_b128 v[196:199], v5 offset:16384
    v_cvt_pk_bf16_f32 v143, v150, v151
    v_mfma_f32_16x16x32_bf16 v[176:179], v[216:219], v[80:83], v[124:127]
    ds_read_b128 a[144:147], v96 offset:53248
    ds_read_b128 v[200:203], v5 offset:17408
    v_mfma_f32_16x16x32_bf16 v[176:179], v[220:223], v[84:87], v[176:179]
    s_waitcnt lgkmcnt(8)
    s_mov_b32 s54, 49152
    buffer_store_dwordx4 a[128:131], v18, s[20:23], s54 offen sc1 nt
    v_exp_f32 v168, v168
    v_mfma_f32_16x16x32_bf16 v[176:179], v[224:227], v[88:91], v[176:179]
    ds_read_b128 a[148:151], v97 offset:54272
    ds_read_b128 v[204:207], v4 offset:17408
    v_mfma_f32_16x16x32_bf16 v[176:179], v[228:231], v[92:95], v[176:179]
    s_waitcnt lgkmcnt(8)
    s_mov_b32 s54, 53248
    buffer_store_dwordx4 a[132:135], v18, s[20:23], s54 offen sc1 nt
    v_exp_f32 v169, v169
    v_mfma_f32_16x16x32_bf16 v[180:183], v[232:235], v[92:95], v[124:127]
    ds_read_b128 a[152:155], v96 offset:55296
    ds_read_b128 v[208:211], v3 offset:17408
    v_cvt_pk_bf16_f32 v168, v168, v169
    v_mfma_f32_16x16x32_bf16 v[180:183], v[236:239], v[88:91], v[180:183]
    s_waitcnt lgkmcnt(8)
    s_mov_b32 s54, 57344
    buffer_store_dwordx4 a[136:139], v18, s[20:23], s54 offen sc1 nt
    v_exp_f32 v170, v170
    v_mfma_f32_16x16x32_bf16 v[180:183], v[240:243], v[84:87], v[180:183]
    ds_read_b128 a[156:159], v97 offset:56320
    ds_read_b128 v[212:215], v2 offset:17408
    v_mfma_f32_16x16x32_bf16 v[180:183], v[244:247], v[80:83], v[180:183]
    s_waitcnt lgkmcnt(8)
    s_mov_b32 s54, 61440
    buffer_store_dwordx4 a[140:143], v18, s[20:23], s54 offen sc1 nt
    v_exp_f32 v171, v171
    v_mfma_f32_16x16x32_bf16 a[64:67], a[160:163], v[136:139], a[64:67]
    ds_read_b128 a[128:131], v96 offset:57344
    ds_read_b128 v[216:219], v2 offset:18432
    v_cvt_pk_bf16_f32 v169, v170, v171
    v_mfma_f32_16x16x32_bf16 a[64:67], a[164:167], v[140:143], a[64:67]
    s_waitcnt lgkmcnt(8)
    s_mov_b32 s54, 49152
    buffer_store_dwordx4 a[144:147], v18, s[20:23], s54 offen offset:1024 sc1 nt
    v_exp_f32 v172, v172
    v_mfma_f32_16x16x32_bf16 a[68:71], a[168:171], v[140:143], a[68:71]
    ds_read_b128 a[132:135], v97 offset:58368
    ds_read_b128 v[220:223], v3 offset:18432
    v_mfma_f32_16x16x32_bf16 a[68:71], a[172:175], v[136:139], a[68:71]
    s_waitcnt lgkmcnt(8)
    s_mov_b32 s54, 53248
    buffer_store_dwordx4 a[148:151], v18, s[20:23], s54 offen offset:1024 sc1 nt
    v_exp_f32 v173, v173
    v_mfma_f32_16x16x32_bf16 a[72:75], a[176:179], v[136:139], a[72:75]
    ds_read_b128 a[136:139], v96 offset:59392
    ds_read_b128 v[224:227], v4 offset:18432
    v_cvt_pk_bf16_f32 v170, v172, v173
    v_mfma_f32_16x16x32_bf16 a[72:75], a[180:183], v[140:143], a[72:75]
    s_waitcnt lgkmcnt(8)
    s_mov_b32 s54, 57344
    buffer_store_dwordx4 a[152:155], v18, s[20:23], s54 offen offset:1024 sc1 nt
    v_exp_f32 v174, v174
    v_mfma_f32_16x16x32_bf16 a[76:79], a[184:187], v[140:143], a[76:79]
    ds_read_b128 a[140:143], v97 offset:60416
    ds_read_b128 v[228:231], v5 offset:18432
    v_mfma_f32_16x16x32_bf16 a[76:79], a[188:191], v[136:139], a[76:79]
    s_waitcnt lgkmcnt(8)
    s_mov_b32 s54, 61440
    buffer_store_dwordx4 a[156:159], v18, s[20:23], s54 offen offset:1024 sc1 nt
    v_exp_f32 v175, v175
    v_mfma_f32_16x16x32_bf16 a[80:83], a[192:195], v[136:139], a[80:83]
    ds_read_b128 a[144:147], v96 offset:61440
    ds_read_b128 v[232:235], v5 offset:19456
    v_cvt_pk_bf16_f32 v171, v174, v175
    v_mfma_f32_16x16x32_bf16 a[80:83], a[196:199], v[140:143], a[80:83]
    s_waitcnt lgkmcnt(8)
    s_mov_b32 s54, 49152
    buffer_store_dwordx4 a[128:131], v18, s[20:23], s54 offen offset:2048 sc1 nt
    v_exp_f32 v176, v176
    v_mfma_f32_16x16x32_bf16 a[84:87], a[200:203], v[140:143], a[84:87]
    ds_read_b128 a[148:151], v97 offset:62464
    ds_read_b128 v[236:239], v4 offset:19456
    v_mfma_f32_16x16x32_bf16 a[84:87], a[204:207], v[136:139], a[84:87]
    s_waitcnt lgkmcnt(8)
    s_mov_b32 s54, 53248
    buffer_store_dwordx4 a[132:135], v18, s[20:23], s54 offen offset:2048 sc1 nt
    v_exp_f32 v177, v177
    v_mfma_f32_16x16x32_bf16 a[88:91], a[208:211], v[136:139], a[88:91]
    ds_read_b128 a[152:155], v96 offset:63488
    ds_read_b128 v[240:243], v3 offset:19456
    v_cvt_pk_bf16_f32 v172, v176, v177
    v_mfma_f32_16x16x32_bf16 a[88:91], a[212:215], v[140:143], a[88:91]
    s_waitcnt lgkmcnt(8)
    s_mov_b32 s54, 57344
    buffer_store_dwordx4 a[136:139], v18, s[20:23], s54 offen offset:2048 sc1 nt
    v_exp_f32 v178, v178
    v_mfma_f32_16x16x32_bf16 a[92:95], a[216:219], v[140:143], a[92:95]
    ds_read_b128 a[156:159], v97 offset:64512
    ds_read_b128 v[244:247], v2 offset:19456
    v_mfma_f32_16x16x32_bf16 a[92:95], a[220:223], v[136:139], a[92:95]
    s_waitcnt lgkmcnt(8)
    s_mov_b32 s54, 61440
    buffer_store_dwordx4 a[140:143], v18, s[20:23], s54 offen offset:2048 sc1 nt
    v_exp_f32 v179, v179
    v_smfmac_f32_16x16x64_bf16 v[28:31], v[132:135], v[136:143], v0
    v_cvt_pk_bf16_f32 v173, v178, v179
    v_mfma_f32_16x16x32_bf16 v[136:139], v[184:187], v[32:35], v[112:115]
    s_waitcnt lgkmcnt(6)
    s_mov_b32 s54, 49152
    buffer_store_dwordx4 a[144:147], v18, s[20:23], s54 offen offset:3072 sc1 nt
    v_exp_f32 v180, v180
    v_mfma_f32_16x16x32_bf16 v[136:139], v[188:191], v[36:39], v[136:139]
    v_mfma_f32_16x16x32_bf16 v[136:139], v[192:195], v[40:43], v[136:139]
    s_waitcnt lgkmcnt(4)
    s_mov_b32 s54, 53248
    buffer_store_dwordx4 a[148:151], v18, s[20:23], s54 offen offset:3072 sc1 nt
    v_exp_f32 v181, v181
    v_mfma_f32_16x16x32_bf16 v[136:139], v[196:199], v[44:47], v[136:139]
    v_cvt_pk_bf16_f32 v174, v180, v181
    v_mfma_f32_16x16x32_bf16 v[140:143], v[200:203], v[44:47], v[112:115]
    s_waitcnt lgkmcnt(2)
    s_mov_b32 s54, 57344
    buffer_store_dwordx4 a[152:155], v18, s[20:23], s54 offen offset:3072 sc1 nt
    v_exp_f32 v182, v182
    v_mfma_f32_16x16x32_bf16 v[140:143], v[204:207], v[40:43], v[140:143]
    v_mfma_f32_16x16x32_bf16 v[140:143], v[208:211], v[36:39], v[140:143]
    s_waitcnt lgkmcnt(0)
    s_mov_b32 s54, 61440
    buffer_store_dwordx4 a[156:159], v18, s[20:23], s54 offen offset:3072 sc1 nt
    v_exp_f32 v183, v183
    v_mfma_f32_16x16x32_bf16 v[140:143], v[212:215], v[32:35], v[140:143]
    v_cvt_pk_bf16_f32 v175, v182, v183
L_last4:
    s_waitcnt lgkmcnt(0)
    v_mfma_f32_16x16x32_bf16 v[144:147], v[216:219], v[32:35], v[112:115]
    s_add_u32 s55, s36, 65536
    v_mfma_f32_16x16x32_bf16 v[144:147], v[220:223], v[36:39], v[144:147]
    s_add_u32 s20, s20, 77824
    v_exp_f32 v136, v136
    v_mfma_f32_16x16x32_bf16 v[144:147], v[224:227], v[40:43], v[144:147]
    s_addc_u32 s21, s21, 0
    v_mfma_f32_16x16x32_bf16 v[144:147], v[228:231], v[44:47], v[144:147]
    s_lshl_b32 s40, s47, 14
    v_exp_f32 v137, v137
    v_mfma_f32_16x16x32_bf16 v[148:151], v[232:235], v[44:47], v[112:115]
    s_add_u32 s41, s40, 4096
    v_cvt_pk_bf16_f32 v136, v136, v137
    v_mfma_f32_16x16x32_bf16 v[148:151], v[236:239], v[40:43], v[148:151]
    s_add_u32 s42, s40, 8192
    v_exp_f32 v138, v138
    v_mfma_f32_16x16x32_bf16 v[148:151], v[240:243], v[36:39], v[148:151]
    s_add_u32 s43, s40, 12288
    v_mfma_f32_16x16x32_bf16 v[148:151], v[244:247], v[32:35], v[148:151]
    s_mov_b64 s[56:57], 0
    v_exp_f32 v139, v139
    v_mfma_f32_16x16x32_bf16 a[96:99], a[160:163], v[168:171], a[96:99]
    s_and_b32 s54, s47, 1
    ds_read_b64_tr_b16 a[160:161], v6 offset:16384
    v_cvt_pk_bf16_f32 v137, v138, v139
    v_mfma_f32_16x16x32_bf16 a[96:99], a[164:167], v[172:175], a[96:99]
    s_lshl_b32 s54, s54, 15
    v_exp_f32 v140, v140
    v_mfma_f32_16x16x32_bf16 a[100:103], a[168:171], v[172:175], a[100:103]
    s_lshr_b32 s52, s47, 1
    ds_read_b64_tr_b16 a[162:163], v6 offset:17408
    ds_read_b64_tr_b16 a[164:165], v6 offset:18432
    v_mfma_f32_16x16x32_bf16 a[100:103], a[172:175], v[168:171], a[100:103]
    s_mul_i32 s52, s52, 49152
    v_exp_f32 v141, v141
    v_mfma_f32_16x16x32_bf16 a[104:107], a[176:179], v[168:171], a[104:107]
    s_add_u32 s54, s54, s52
    ds_read_b64_tr_b16 a[166:167], v6 offset:19456
    v_cvt_pk_bf16_f32 v138, v140, v141
    v_mfma_f32_16x16x32_bf16 a[104:107], a[180:183], v[172:175], a[104:107]
    s_mov_b32 s52, 98288
    v_exp_f32 v142, v142
    v_mfma_f32_16x16x32_bf16 a[108:111], a[184:187], v[172:175], a[108:111]
    ds_read_b64_tr_b16 a[168:169], v7 offset:18432
    ds_read_b64_tr_b16 a[170:171], v7 offset:19456
    v_mfma_f32_16x16x32_bf16 a[108:111], a[188:191], v[168:171], a[108:111]
    v_exp_f32 v143, v143
    v_mfma_f32_16x16x32_bf16 a[112:115], a[192:195], v[168:171], a[112:115]
    ds_read_b64_tr_b16 a[172:173], v7 offset:16384
    v_cvt_pk_bf16_f32 v139, v142, v143
    v_mfma_f32_16x16x32_bf16 a[112:115], a[196:199], v[172:175], a[112:115]
    v_exp_f32 v144, v144
    v_mfma_f32_16x16x32_bf16 a[116:119], a[200:203], v[172:175], a[116:119]
    ds_read_b64_tr_b16 a[174:175], v7 offset:17408
    ds_read_b64_tr_b16 a[176:177], v8 offset:16384
    v_mfma_f32_16x16x32_bf16 a[116:119], a[204:207], v[168:171], a[116:119]
    v_exp_f32 v145, v145
    v_mfma_f32_16x16x32_bf16 a[120:123], a[208:211], v[168:171], a[120:123]
    ds_read_b64_tr_b16 a[178:179], v8 offset:17408
    v_cvt_pk_bf16_f32 v140, v144, v145
    v_mfma_f32_16x16x32_bf16 a[120:123], a[212:215], v[172:175], a[120:123]
    v_exp_f32 v146, v146
    v_mfma_f32_16x16x32_bf16 a[124:127], a[216:219], v[172:175], a[124:127]
    ds_read_b64_tr_b16 a[180:181], v8 offset:18432
    ds_read_b64_tr_b16 a[182:183], v8 offset:19456
    v_mfma_f32_16x16x32_bf16 a[124:127], a[220:223], v[168:171], a[124:127]
    v_exp_f32 v147, v147
    v_smfmac_f32_16x16x64_bf16 v[248:251], v[132:135], v[168:175], v0
    ds_read_b64_tr_b16 a[184:185], v9 offset:18432
    v_cvt_pk_bf16_f32 v141, v146, v147
    v_mfma_f32_16x16x32_bf16 v[152:155], v[184:187], v[48:51], v[116:119]
    v_exp_f32 v148, v148
    v_mfma_f32_16x16x32_bf16 v[152:155], v[188:191], v[52:55], v[152:155]
    ds_read_b64_tr_b16 a[186:187], v9 offset:19456
    ds_read_b64_tr_b16 a[188:189], v9 offset:16384
    v_mfma_f32_16x16x32_bf16 v[152:155], v[192:195], v[56:59], v[152:155]
    v_exp_f32 v149, v149
    v_mfma_f32_16x16x32_bf16 v[152:155], v[196:199], v[60:63], v[152:155]
    ds_read_b64_tr_b16 a[190:191], v9 offset:17408
    v_cvt_pk_bf16_f32 v142, v148, v149
    v_mfma_f32_16x16x32_bf16 v[156:159], v[200:203], v[60:63], v[116:119]
    v_exp_f32 v150, v150
    v_mfma_f32_16x16x32_bf16 v[156:159], v[204:207], v[56:59], v[156:159]
    ds_read_b64_tr_b16 a[192:193], v10 offset:16384
    ds_read_b64_tr_b16 a[194:195], v10 offset:17408
    v_mfma_f32_16x16x32_bf16 v[156:159], v[208:211], v[52:55], v[156:159]
    v_exp_f32 v151, v151
    v_mfma_f32_16x16x32_bf16 v[156:159], v[212:215], v[48:51], v[156:159]
    ds_read_b64_tr_b16 a[196:197], v10 offset:18432
    v_cvt_pk_bf16_f32 v143, v150, v151
    v_mfma_f32_16x16x32_bf16 v[160:163], v[216:219], v[48:51], v[116:119]
    ds_read_b64_tr_b16 a[198:199], v10 offset:19456
    ds_read_b64_tr_b16 a[200:201], v11 offset:18432
    v_mfma_f32_16x16x32_bf16 v[160:163], v[220:223], v[52:55], v[160:163]
    v_exp_f32 v152, v152
    v_mfma_f32_16x16x32_bf16 v[160:163], v[224:227], v[56:59], v[160:163]
    ds_read_b64_tr_b16 a[202:203], v11 offset:19456
    ds_read_b64_tr_b16 a[204:205], v11 offset:16384
    v_mfma_f32_16x16x32_bf16 v[160:163], v[228:231], v[60:63], v[160:163]
    v_exp_f32 v153, v153
    v_mfma_f32_16x16x32_bf16 v[164:167], v[232:235], v[60:63], v[116:119]
    ds_read_b64_tr_b16 a[206:207], v11 offset:17408
    v_cvt_pk_bf16_f32 v152, v152, v153
    v_mfma_f32_16x16x32_bf16 v[164:167], v[236:239], v[56:59], v[164:167]
    v_exp_f32 v154, v154
    v_mfma_f32_16x16x32_bf16 v[164:167], v[240:243], v[52:55], v[164:167]
    ds_read_b64_tr_b16 a[208:209], v12 offset:16384
    ds_read_b64_tr_b16 a[210:211], v12 offset:17408
    v_mfma_f32_16x16x32_bf16 v[164:167], v[244:247], v[48:51], v[164:167]
    s_waitcnt lgkmcnt(7)
    v_exp_f32 v155, v155
    v_mfma_f32_16x16x32_bf16 a[0:3], a[160:163], v[136:139], a[0:3]
    ds_read_b64_tr_b16 a[212:213], v12 offset:18432
    v_cvt_pk_bf16_f32 v153, v154, v155
    v_mfma_f32_16x16x32_bf16 a[0:3], a[164:167], v[140:143], a[0:3]
    v_exp_f32 v156, v156
    v_mfma_f32_16x16x32_bf16 a[4:7], a[168:171], v[140:143], a[4:7]
    ds_read_b64_tr_b16 a[214:215], v12 offset:19456
    ds_read_b64_tr_b16 a[216:217], v13 offset:18432
    v_mfma_f32_16x16x32_bf16 a[4:7], a[172:175], v[136:139], a[4:7]
    v_exp_f32 v157, v157
    v_mfma_f32_16x16x32_bf16 a[8:11], a[176:179], v[136:139], a[8:11]
    ds_read_b64_tr_b16 a[218:219], v13 offset:19456
    v_cvt_pk_bf16_f32 v154, v156, v157
    v_mfma_f32_16x16x32_bf16 a[8:11], a[180:183], v[140:143], a[8:11]
    v_exp_f32 v158, v158
    v_mfma_f32_16x16x32_bf16 a[12:15], a[184:187], v[140:143], a[12:15]
    ds_read_b64_tr_b16 a[220:221], v13 offset:16384
    ds_read_b64_tr_b16 a[222:223], v13 offset:17408
    v_mfma_f32_16x16x32_bf16 a[12:15], a[188:191], v[136:139], a[12:15]
    v_exp_f32 v159, v159
    v_mfma_f32_16x16x32_bf16 a[16:19], a[192:195], v[136:139], a[16:19]
    s_waitcnt lgkmcnt(5)
    v_cvt_pk_bf16_f32 v155, v158, v159
    v_mfma_f32_16x16x32_bf16 a[16:19], a[196:199], v[140:143], a[16:19]
    v_exp_f32 v160, v160
    v_mfma_f32_16x16x32_bf16 a[20:23], a[200:203], v[140:143], a[20:23]
    v_mfma_f32_16x16x32_bf16 a[20:23], a[204:207], v[136:139], a[20:23]
    v_exp_f32 v161, v161
    v_mfma_f32_16x16x32_bf16 a[24:27], a[208:211], v[136:139], a[24:27]
    s_waitcnt lgkmcnt(2)
    v_cvt_pk_bf16_f32 v156, v160, v161
    v_mfma_f32_16x16x32_bf16 a[24:27], a[212:215], v[140:143], a[24:27]
    v_exp_f32 v162, v162
    v_mfma_f32_16x16x32_bf16 a[28:31], a[216:219], v[140:143], a[28:31]
    s_waitcnt lgkmcnt(0)
    v_mfma_f32_16x16x32_bf16 a[28:31], a[220:223], v[136:139], a[28:31]
    v_exp_f32 v163, v163
    v_smfmac_f32_16x16x64_bf16 v[20:23], v[132:135], v[136:143], v0
    v_cvt_pk_bf16_f32 v157, v162, v163
    v_mfma_f32_16x16x32_bf16 v[136:139], v[184:187], v[64:67], v[120:123]
    v_exp_f32 v164, v164
    v_mfma_f32_16x16x32_bf16 v[136:139], v[188:191], v[68:71], v[136:139]
    v_mfma_f32_16x16x32_bf16 v[136:139], v[192:195], v[72:75], v[136:139]
    v_exp_f32 v165, v165
    v_mfma_f32_16x16x32_bf16 v[136:139], v[196:199], v[76:79], v[136:139]
    v_cvt_pk_bf16_f32 v158, v164, v165
    v_mfma_f32_16x16x32_bf16 v[140:143], v[200:203], v[76:79], v[120:123]
    v_exp_f32 v166, v166
    v_mfma_f32_16x16x32_bf16 v[140:143], v[204:207], v[72:75], v[140:143]
    v_mfma_f32_16x16x32_bf16 v[140:143], v[208:211], v[68:71], v[140:143]
    v_exp_f32 v167, v167
    v_mfma_f32_16x16x32_bf16 v[140:143], v[212:215], v[64:67], v[140:143]
    v_cvt_pk_bf16_f32 v159, v166, v167
    v_add_f32 v20, v20, v21
    v_rcp_f32 v112, v20
    v_cmp_ngt_f32 vcc, s62, v20
    v_add_u32 v114, s54, v16
    v_add_u32 v118, s54, v17
    v_xor_b32 v115, 32, v114
    v_xor_b32 v116, 64, v114
    v_xor_b32 v117, 96, v114
    v_xor_b32 v119, 64, v118
    s_or_b64 s[56:57], s[56:57], vcc
    v_accvgpr_read_b32 v32, a0
    v_accvgpr_read_b32 v33, a1
    v_accvgpr_read_b32 v34, a2
    v_accvgpr_read_b32 v35, a3
    v_pk_mul_f32 v[32:33], v[32:33], v[112:113] op_sel_hi:[1,0]
    v_pk_mul_f32 v[34:35], v[34:35], v[112:113] op_sel_hi:[1,0]
    v_cvt_pk_bf16_f32 v32, v32, v33
    v_cvt_pk_bf16_f32 v33, v34, v35
    v_mfma_f32_16x16x32_bf16 v[144:147], v[216:219], v[64:67], v[120:123]
    ds_write_b64 v114, v[32:33] offset:0
    v_accvgpr_read_b32 v36, a4
    v_accvgpr_read_b32 v37, a5
    v_accvgpr_read_b32 v38, a6
    v_accvgpr_read_b32 v39, a7
    v_pk_mul_f32 v[36:37], v[36:37], v[112:113] op_sel_hi:[1,0]
    v_pk_mul_f32 v[38:39], v[38:39], v[112:113] op_sel_hi:[1,0]
    v_cvt_pk_bf16_f32 v36, v36, v37
    v_cvt_pk_bf16_f32 v37, v38, v39
    v_mfma_f32_16x16x32_bf16 v[144:147], v[220:223], v[68:71], v[144:147]
    ds_write_b64 v115, v[36:37] offset:0
    v_exp_f32 v136, v136
    v_accvgpr_read_b32 v40, a8
    v_accvgpr_read_b32 v41, a9
    v_accvgpr_read_b32 v42, a10
    v_accvgpr_read_b32 v43, a11
    v_pk_mul_f32 v[40:41], v[40:41], v[112:113] op_sel_hi:[1,0]
    v_pk_mul_f32 v[42:43], v[42:43], v[112:113] op_sel_hi:[1,0]
    v_cvt_pk_bf16_f32 v40, v40, v41
    v_cvt_pk_bf16_f32 v41, v42, v43
    v_mfma_f32_16x16x32_bf16 v[144:147], v[224:227], v[72:75], v[144:147]
    ds_write_b64 v116, v[40:41] offset:0
    v_accvgpr_read_b32 v44, a12
    v_accvgpr_read_b32 v45, a13
    v_accvgpr_read_b32 v46, a14
    v_accvgpr_read_b32 v47, a15
    v_pk_mul_f32 v[44:45], v[44:45], v[112:113] op_sel_hi:[1,0]
    v_pk_mul_f32 v[46:47], v[46:47], v[112:113] op_sel_hi:[1,0]
    v_cvt_pk_bf16_f32 v44, v44, v45
    v_cvt_pk_bf16_f32 v45, v46, v47
    v_mfma_f32_16x16x32_bf16 v[144:147], v[228:231], v[76:79], v[144:147]
    ds_write_b64 v117, v[44:45] offset:0
    v_exp_f32 v137, v137
    v_accvgpr_read_b32 v32, a16
    v_accvgpr_read_b32 v33, a17
    v_accvgpr_read_b32 v34, a18
    v_accvgpr_read_b32 v35, a19
    v_pk_mul_f32 v[32:33], v[32:33], v[112:113] op_sel_hi:[1,0]
    v_pk_mul_f32 v[34:35], v[34:35], v[112:113] op_sel_hi:[1,0]
    v_cvt_pk_bf16_f32 v32, v32, v33
    v_cvt_pk_bf16_f32 v33, v34, v35
    v_mfma_f32_16x16x32_bf16 v[148:151], v[232:235], v[76:79], v[120:123]
    ds_write_b64 v114, v[32:33] offset:128
    v_cvt_pk_bf16_f32 v136, v136, v137
    v_accvgpr_read_b32 v36, a20
    v_accvgpr_read_b32 v37, a21
    v_accvgpr_read_b32 v38, a22
    v_accvgpr_read_b32 v39, a23
    v_pk_mul_f32 v[36:37], v[36:37], v[112:113] op_sel_hi:[1,0]
    v_pk_mul_f32 v[38:39], v[38:39], v[112:113] op_sel_hi:[1,0]
    v_cvt_pk_bf16_f32 v36, v36, v37
    v_cvt_pk_bf16_f32 v37, v38, v39
    v_mfma_f32_16x16x32_bf16 v[148:151], v[236:239], v[72:75], v[148:151]
    ds_write_b64 v115, v[36:37] offset:128
    v_exp_f32 v138, v138
    v_accvgpr_read_b32 v40, a24
    v_accvgpr_read_b32 v41, a25
    v_accvgpr_read_b32 v42, a26
    v_accvgpr_read_b32 v43, a27
    v_pk_mul_f32 v[40:41], v[40:41], v[112:113] op_sel_hi:[1,0]
    v_pk_mul_f32 v[42:43], v[42:43], v[112:113] op_sel_hi:[1,0]
    v_cvt_pk_bf16_f32 v40, v40, v41
    v_cvt_pk_bf16_f32 v41, v42, v43
    v_mfma_f32_16x16x32_bf16 v[148:151], v[240:243], v[68:71], v[148:151]
    ds_write_b64 v116, v[40:41] offset:128
    v_accvgpr_read_b32 v44, a28
    v_accvgpr_read_b32 v45, a29
    v_accvgpr_read_b32 v46, a30
    v_accvgpr_read_b32 v47, a31
    v_pk_mul_f32 v[44:45], v[44:45], v[112:113] op_sel_hi:[1,0]
    v_pk_mul_f32 v[46:47], v[46:47], v[112:113] op_sel_hi:[1,0]
    v_cvt_pk_bf16_f32 v44, v44, v45
    v_cvt_pk_bf16_f32 v45, v46, v47
    v_mfma_f32_16x16x32_bf16 v[148:151], v[244:247], v[64:67], v[148:151]
    ds_write_b64 v117, v[44:45] offset:128
    ds_read_b128 v[48:51], v118 offset:0
    ds_read_b128 v[52:55], v119 offset:1024
    ds_read_b128 v[56:59], v118 offset:2048
    ds_read_b128 v[60:63], v119 offset:3072
    v_exp_f32 v139, v139
    v_mfma_f32_16x16x32_bf16 a[32:35], a[160:163], v[152:155], a[32:35]
    v_cvt_pk_bf16_f32 v137, v138, v139
    v_mfma_f32_16x16x32_bf16 a[32:35], a[164:167], v[156:159], a[32:35]
    v_exp_f32 v140, v140
    v_mfma_f32_16x16x32_bf16 a[36:39], a[168:171], v[156:159], a[36:39]
    v_mfma_f32_16x16x32_bf16 a[36:39], a[172:175], v[152:155], a[36:39]
    v_exp_f32 v141, v141
    v_mfma_f32_16x16x32_bf16 a[40:43], a[176:179], v[152:155], a[40:43]
    v_cvt_pk_bf16_f32 v138, v140, v141
    v_mfma_f32_16x16x32_bf16 a[40:43], a[180:183], v[156:159], a[40:43]
    v_exp_f32 v142, v142
    v_mfma_f32_16x16x32_bf16 a[44:47], a[184:187], v[156:159], a[44:47]
    v_mfma_f32_16x16x32_bf16 a[44:47], a[188:191], v[152:155], a[44:47]
    s_waitcnt lgkmcnt(0)
    buffer_store_dwordx4 v[48:51], v18, s[20:23], s40 offen sc1 nt
    buffer_store_dwordx4 v[52:55], v18, s[20:23], s41 offen sc1 nt
    buffer_store_dwordx4 v[56:59], v18, s[20:23], s42 offen sc1 nt
    buffer_store_dwordx4 v[60:63], v18, s[20:23], s43 offen sc1 nt
    v_exp_f32 v143, v143
    v_mfma_f32_16x16x32_bf16 a[48:51], a[192:195], v[152:155], a[48:51]
    v_cvt_pk_bf16_f32 v139, v142, v143
    v_mfma_f32_16x16x32_bf16 a[48:51], a[196:199], v[156:159], a[48:51]
    v_exp_f32 v144, v144
    v_mfma_f32_16x16x32_bf16 a[52:55], a[200:203], v[156:159], a[52:55]
    v_mfma_f32_16x16x32_bf16 a[52:55], a[204:207], v[152:155], a[52:55]
    v_exp_f32 v145, v145
    v_mfma_f32_16x16x32_bf16 a[56:59], a[208:211], v[152:155], a[56:59]
    v_cvt_pk_bf16_f32 v140, v144, v145
    v_mfma_f32_16x16x32_bf16 a[56:59], a[212:215], v[156:159], a[56:59]
    v_exp_f32 v146, v146
    v_mfma_f32_16x16x32_bf16 a[60:63], a[216:219], v[156:159], a[60:63]
    v_mfma_f32_16x16x32_bf16 a[60:63], a[220:223], v[152:155], a[60:63]
    v_exp_f32 v147, v147
    v_smfmac_f32_16x16x64_bf16 v[24:27], v[132:135], v[152:159], v0
    v_cvt_pk_bf16_f32 v141, v146, v147
    v_mfma_f32_16x16x32_bf16 v[168:171], v[184:187], v[80:83], v[124:127]
    v_exp_f32 v148, v148
    v_mfma_f32_16x16x32_bf16 v[168:171], v[188:191], v[84:87], v[168:171]
    v_mfma_f32_16x16x32_bf16 v[168:171], v[192:195], v[88:91], v[168:171]
    v_exp_f32 v149, v149
    v_mfma_f32_16x16x32_bf16 v[168:171], v[196:199], v[92:95], v[168:171]
    v_cvt_pk_bf16_f32 v142, v148, v149
    v_mfma_f32_16x16x32_bf16 v[172:175], v[200:203], v[92:95], v[124:127]
    v_exp_f32 v150, v150
    v_mfma_f32_16x16x32_bf16 v[172:175], v[204:207], v[88:91], v[172:175]
    v_mfma_f32_16x16x32_bf16 v[172:175], v[208:211], v[84:87], v[172:175]
    v_exp_f32 v151, v151
    v_mfma_f32_16x16x32_bf16 v[172:175], v[212:215], v[80:83], v[172:175]
    v_cvt_pk_bf16_f32 v143, v150, v151
    v_add_f32 v24, v24, v25
    v_rcp_f32 v112, v24
    v_cmp_ngt_f32 vcc, s62, v24
    s_or_b64 s[56:57], s[56:57], vcc
    v_accvgpr_read_b32 v32, a32
    v_accvgpr_read_b32 v33, a33
    v_accvgpr_read_b32 v34, a34
    v_accvgpr_read_b32 v35, a35
    v_pk_mul_f32 v[32:33], v[32:33], v[112:113] op_sel_hi:[1,0]
    v_pk_mul_f32 v[34:35], v[34:35], v[112:113] op_sel_hi:[1,0]
    v_cvt_pk_bf16_f32 v32, v32, v33
    v_cvt_pk_bf16_f32 v33, v34, v35
    v_mfma_f32_16x16x32_bf16 v[176:179], v[216:219], v[80:83], v[124:127]
    ds_write_b64 v114, v[32:33] offset:0
    v_accvgpr_read_b32 v36, a36
    v_accvgpr_read_b32 v37, a37
    v_accvgpr_read_b32 v38, a38
    v_accvgpr_read_b32 v39, a39
    v_pk_mul_f32 v[36:37], v[36:37], v[112:113] op_sel_hi:[1,0]
    v_pk_mul_f32 v[38:39], v[38:39], v[112:113] op_sel_hi:[1,0]
    v_cvt_pk_bf16_f32 v36, v36, v37
    v_cvt_pk_bf16_f32 v37, v38, v39
    v_mfma_f32_16x16x32_bf16 v[176:179], v[220:223], v[84:87], v[176:179]
    ds_write_b64 v115, v[36:37] offset:0
    v_exp_f32 v168, v168
    v_accvgpr_read_b32 v40, a40
    v_accvgpr_read_b32 v41, a41
    v_accvgpr_read_b32 v42, a42
    v_accvgpr_read_b32 v43, a43
    v_pk_mul_f32 v[40:41], v[40:41], v[112:113] op_sel_hi:[1,0]
    v_pk_mul_f32 v[42:43], v[42:43], v[112:113] op_sel_hi:[1,0]
    v_cvt_pk_bf16_f32 v40, v40, v41
    v_cvt_pk_bf16_f32 v41, v42, v43
    v_mfma_f32_16x16x32_bf16 v[176:179], v[224:227], v[88:91], v[176:179]
    ds_write_b64 v116, v[40:41] offset:0
    v_accvgpr_read_b32 v44, a44
    v_accvgpr_read_b32 v45, a45
    v_accvgpr_read_b32 v46, a46
    v_accvgpr_read_b32 v47, a47
    v_pk_mul_f32 v[44:45], v[44:45], v[112:113] op_sel_hi:[1,0]
    v_pk_mul_f32 v[46:47], v[46:47], v[112:113] op_sel_hi:[1,0]
    v_cvt_pk_bf16_f32 v44, v44, v45
    v_cvt_pk_bf16_f32 v45, v46, v47
    v_mfma_f32_16x16x32_bf16 v[176:179], v[228:231], v[92:95], v[176:179]
    ds_write_b64 v117, v[44:45] offset:0
    v_exp_f32 v169, v169
    v_accvgpr_read_b32 v32, a48
    v_accvgpr_read_b32 v33, a49
    v_accvgpr_read_b32 v34, a50
    v_accvgpr_read_b32 v35, a51
    v_pk_mul_f32 v[32:33], v[32:33], v[112:113] op_sel_hi:[1,0]
    v_pk_mul_f32 v[34:35], v[34:35], v[112:113] op_sel_hi:[1,0]
    v_cvt_pk_bf16_f32 v32, v32, v33
    v_cvt_pk_bf16_f32 v33, v34, v35
    v_mfma_f32_16x16x32_bf16 v[180:183], v[232:235], v[92:95], v[124:127]
    ds_write_b64 v114, v[32:33] offset:128
    v_cvt_pk_bf16_f32 v168, v168, v169
    v_accvgpr_read_b32 v36, a52
    v_accvgpr_read_b32 v37, a53
    v_accvgpr_read_b32 v38, a54
    v_accvgpr_read_b32 v39, a55
    v_pk_mul_f32 v[36:37], v[36:37], v[112:113] op_sel_hi:[1,0]
    v_pk_mul_f32 v[38:39], v[38:39], v[112:113] op_sel_hi:[1,0]
    v_cvt_pk_bf16_f32 v36, v36, v37
    v_cvt_pk_bf16_f32 v37, v38, v39
    v_mfma_f32_16x16x32_bf16 v[180:183], v[236:239], v[88:91], v[180:183]
    ds_write_b64 v115, v[36:37] offset:128
    v_exp_f32 v170, v170
    v_accvgpr_read_b32 v40, a56
    v_accvgpr_read_b32 v41, a57
    v_accvgpr_read_b32 v42, a58
    v_accvgpr_read_b32 v43, a59
    v_pk_mul_f32 v[40:41], v[40:41], v[112:113] op_sel_hi:[1,0]
    v_pk_mul_f32 v[42:43], v[42:43], v[112:113] op_sel_hi:[1,0]
    v_cvt_pk_bf16_f32 v40, v40, v41
    v_cvt_pk_bf16_f32 v41, v42, v43
    v_mfma_f32_16x16x32_bf16 v[180:183], v[240:243], v[84:87], v[180:183]
    ds_write_b64 v116, v[40:41] offset:128
    v_accvgpr_read_b32 v44, a60
    v_accvgpr_read_b32 v45, a61
    v_accvgpr_read_b32 v46, a62
    v_accvgpr_read_b32 v47, a63
    v_pk_mul_f32 v[44:45], v[44:45], v[112:113] op_sel_hi:[1,0]
    v_pk_mul_f32 v[46:47], v[46:47], v[112:113] op_sel_hi:[1,0]
    v_cvt_pk_bf16_f32 v44, v44, v45
    v_cvt_pk_bf16_f32 v45, v46, v47
    v_mfma_f32_16x16x32_bf16 v[180:183], v[244:247], v[80:83], v[180:183]
    ds_write_b64 v117, v[44:45] offset:128
    ds_read_b128 v[48:51], v118 offset:0
    ds_read_b128 v[52:55], v119 offset:1024
    ds_read_b128 v[56:59], v118 offset:2048
    ds_read_b128 v[60:63], v119 offset:3072
    v_exp_f32 v171, v171
    v_mfma_f32_16x16x32_bf16 a[64:67], a[160:163], v[136:139], a[64:67]
    v_cvt_pk_bf16_f32 v169, v170, v171
    v_mfma_f32_16x16x32_bf16 a[64:67], a[164:167], v[140:143], a[64:67]
    v_exp_f32 v172, v172
    v_mfma_f32_16x16x32_bf16 a[68:71], a[168:171], v[140:143], a[68:71]
    v_mfma_f32_16x16x32_bf16 a[68:71], a[172:175], v[136:139], a[68:71]
    v_exp_f32 v173, v173
    v_mfma_f32_16x16x32_bf16 a[72:75], a[176:179], v[136:139], a[72:75]
    v_cvt_pk_bf16_f32 v170, v172, v173
    v_mfma_f32_16x16x32_bf16 a[72:75], a[180:183], v[140:143], a[72:75]
    v_exp_f32 v174, v174
    v_mfma_f32_16x16x32_bf16 a[76:79], a[184:187], v[140:143], a[76:79]
    v_mfma_f32_16x16x32_bf16 a[76:79], a[188:191], v[136:139], a[76:79]
    s_waitcnt lgkmcnt(0)
    buffer_store_dwordx4 v[48:51], v18, s[20:23], s40 offen offset:1024 sc1 nt
    buffer_store_dwordx4 v[52:55], v18, s[20:23], s41 offen offset:1024 sc1 nt
    buffer_store_dwordx4 v[56:59], v18, s[20:23], s42 offen offset:1024 sc1 nt
    buffer_store_dwordx4 v[60:63], v18, s[20:23], s43 offen offset:1024 sc1 nt
    v_exp_f32 v175, v175
    v_mfma_f32_16x16x32_bf16 a[80:83], a[192:195], v[136:139], a[80:83]
    v_cvt_pk_bf16_f32 v171, v174, v175
    v_mfma_f32_16x16x32_bf16 a[80:83], a[196:199], v[140:143], a[80:83]
    v_exp_f32 v176, v176
    v_mfma_f32_16x16x32_bf16 a[84:87], a[200:203], v[140:143], a[84:87]
    v_mfma_f32_16x16x32_bf16 a[84:87], a[204:207], v[136:139], a[84:87]
    v_exp_f32 v177, v177
    v_mfma_f32_16x16x32_bf16 a[88:91], a[208:211], v[136:139], a[88:91]
    v_cvt_pk_bf16_f32 v172, v176, v177
    v_mfma_f32_16x16x32_bf16 a[88:91], a[212:215], v[140:143], a[88:91]
    v_exp_f32 v178, v178
    v_mfma_f32_16x16x32_bf16 a[92:95], a[216:219], v[140:143], a[92:95]
    v_mfma_f32_16x16x32_bf16 a[92:95], a[220:223], v[136:139], a[92:95]
    v_exp_f32 v179, v179
    v_smfmac_f32_16x16x64_bf16 v[28:31], v[132:135], v[136:143], v0
    v_cvt_pk_bf16_f32 v173, v178, v179
    v_exp_f32 v180, v180
    s_nop 0
    v_exp_f32 v181, v181
    s_nop 0
    v_cvt_pk_bf16_f32 v174, v180, v181
    s_nop 0
    v_exp_f32 v182, v182
    s_nop 0
    v_exp_f32 v183, v183
    s_nop 0
    v_cvt_pk_bf16_f32 v175, v182, v183
    s_nop 0
    s_nop 1
    v_smfmac_f32_16x16x64_bf16 v[248:251], v[132:135], v[168:175], v0
    v_add_f32 v28, v28, v29
    v_rcp_f32 v112, v28
    v_cmp_ngt_f32 vcc, s62, v28
    s_or_b64 s[56:57], s[56:57], vcc
    v_accvgpr_read_b32 v32, a64
    v_accvgpr_read_b32 v33, a65
    v_accvgpr_read_b32 v34, a66
    v_accvgpr_read_b32 v35, a67
    v_pk_mul_f32 v[32:33], v[32:33], v[112:113] op_sel_hi:[1,0]
    v_pk_mul_f32 v[34:35], v[34:35], v[112:113] op_sel_hi:[1,0]
    v_cvt_pk_bf16_f32 v32, v32, v33
    v_cvt_pk_bf16_f32 v33, v34, v35
    v_mfma_f32_16x16x32_bf16 a[96:99], a[160:163], v[168:171], a[96:99]
    ds_write_b64 v114, v[32:33] offset:0
    v_mfma_f32_16x16x32_bf16 a[96:99], a[164:167], v[172:175], a[96:99]
    v_accvgpr_read_b32 v36, a68
    v_accvgpr_read_b32 v37, a69
    v_accvgpr_read_b32 v38, a70
    v_accvgpr_read_b32 v39, a71
    v_pk_mul_f32 v[36:37], v[36:37], v[112:113] op_sel_hi:[1,0]
    v_pk_mul_f32 v[38:39], v[38:39], v[112:113] op_sel_hi:[1,0]
    v_cvt_pk_bf16_f32 v36, v36, v37
    v_cvt_pk_bf16_f32 v37, v38, v39
    v_mfma_f32_16x16x32_bf16 a[100:103], a[168:171], v[172:175], a[100:103]
    ds_write_b64 v115, v[36:37] offset:0
    v_mfma_f32_16x16x32_bf16 a[100:103], a[172:175], v[168:171], a[100:103]
    v_accvgpr_read_b32 v40, a72
    v_accvgpr_read_b32 v41, a73
    v_accvgpr_read_b32 v42, a74
    v_accvgpr_read_b32 v43, a75
    v_pk_mul_f32 v[40:41], v[40:41], v[112:113] op_sel_hi:[1,0]
    v_pk_mul_f32 v[42:43], v[42:43], v[112:113] op_sel_hi:[1,0]
    v_cvt_pk_bf16_f32 v40, v40, v41
    v_cvt_pk_bf16_f32 v41, v42, v43
    v_mfma_f32_16x16x32_bf16 a[104:107], a[176:179], v[168:171], a[104:107]
    ds_write_b64 v116, v[40:41] offset:0
    v_mfma_f32_16x16x32_bf16 a[104:107], a[180:183], v[172:175], a[104:107]
    v_accvgpr_read_b32 v44, a76
    v_accvgpr_read_b32 v45, a77
    v_accvgpr_read_b32 v46, a78
    v_accvgpr_read_b32 v47, a79
    v_pk_mul_f32 v[44:45], v[44:45], v[112:113] op_sel_hi:[1,0]
    v_pk_mul_f32 v[46:47], v[46:47], v[112:113] op_sel_hi:[1,0]
    v_cvt_pk_bf16_f32 v44, v44, v45
    v_cvt_pk_bf16_f32 v45, v46, v47
    v_mfma_f32_16x16x32_bf16 a[108:111], a[184:187], v[172:175], a[108:111]
    ds_write_b64 v117, v[44:45] offset:0
    v_mfma_f32_16x16x32_bf16 a[108:111], a[188:191], v[168:171], a[108:111]
    v_accvgpr_read_b32 v32, a80
    v_accvgpr_read_b32 v33, a81
    v_accvgpr_read_b32 v34, a82
    v_accvgpr_read_b32 v35, a83
    v_pk_mul_f32 v[32:33], v[32:33], v[112:113] op_sel_hi:[1,0]
    v_pk_mul_f32 v[34:35], v[34:35], v[112:113] op_sel_hi:[1,0]
    v_cvt_pk_bf16_f32 v32, v32, v33
    v_cvt_pk_bf16_f32 v33, v34, v35
    v_mfma_f32_16x16x32_bf16 a[112:115], a[192:195], v[168:171], a[112:115]
    ds_write_b64 v114, v[32:33] offset:128
    v_mfma_f32_16x16x32_bf16 a[112:115], a[196:199], v[172:175], a[112:115]
    v_accvgpr_read_b32 v36, a84
    v_accvgpr_read_b32 v37, a85
    v_accvgpr_read_b32 v38, a86
    v_accvgpr_read_b32 v39, a87
    v_pk_mul_f32 v[36:37], v[36:37], v[112:113] op_sel_hi:[1,0]
    v_pk_mul_f32 v[38:39], v[38:39], v[112:113] op_sel_hi:[1,0]
    v_cvt_pk_bf16_f32 v36, v36, v37
    v_cvt_pk_bf16_f32 v37, v38, v39
    v_mfma_f32_16x16x32_bf16 a[116:119], a[200:203], v[172:175], a[116:119]
    ds_write_b64 v115, v[36:37] offset:128
    v_mfma_f32_16x16x32_bf16 a[116:119], a[204:207], v[168:171], a[116:119]
    v_accvgpr_read_b32 v40, a88
    v_accvgpr_read_b32 v41, a89
    v_accvgpr_read_b32 v42, a90
    v_accvgpr_read_b32 v43, a91
    v_pk_mul_f32 v[40:41], v[40:41], v[112:113] op_sel_hi:[1,0]
    v_pk_mul_f32 v[42:43], v[42:43], v[112:113] op_sel_hi:[1,0]
    v_cvt_pk_bf16_f32 v40, v40, v41
    v_cvt_pk_bf16_f32 v41, v42, v43
    v_mfma_f32_16x16x32_bf16 a[120:123], a[208:211], v[168:171], a[120:123]
    ds_write_b64 v116, v[40:41] offset:128
    v_mfma_f32_16x16x32_bf16 a[120:123], a[212:215], v[172:175], a[120:123]
    v_accvgpr_read_b32 v44, a92
    v_accvgpr_read_b32 v45, a93
    v_accvgpr_read_b32 v46, a94
    v_accvgpr_read_b32 v47, a95
    v_pk_mul_f32 v[44:45], v[44:45], v[112:113] op_sel_hi:[1,0]
    v_pk_mul_f32 v[46:47], v[46:47], v[112:113] op_sel_hi:[1,0]
    v_cvt_pk_bf16_f32 v44, v44, v45
    v_cvt_pk_bf16_f32 v45, v46, v47
    v_mfma_f32_16x16x32_bf16 a[124:127], a[216:219], v[172:175], a[124:127]
    ds_write_b64 v117, v[44:45] offset:128
    ds_read_b128 v[48:51], v118 offset:0
    ds_read_b128 v[52:55], v119 offset:1024
    ds_read_b128 v[56:59], v118 offset:2048
    ds_read_b128 v[60:63], v119 offset:3072
    v_mfma_f32_16x16x32_bf16 a[124:127], a[220:223], v[168:171], a[124:127]
    v_add_f32 v248, v248, v249
    v_rcp_f32 v112, v248
    v_cmp_ngt_f32 vcc, s62, v248
    s_or_b64 s[56:57], s[56:57], vcc
    v_accvgpr_read_b32 v32, a96
    v_accvgpr_read_b32 v33, a97
    v_accvgpr_read_b32 v34, a98
    v_accvgpr_read_b32 v35, a99
    v_pk_mul_f32 v[32:33], v[32:33], v[112:113] op_sel_hi:[1,0]
    v_pk_mul_f32 v[34:35], v[34:35], v[112:113] op_sel_hi:[1,0]
    v_cvt_pk_bf16_f32 v32, v32, v33
    v_cvt_pk_bf16_f32 v33, v34, v35
    v_accvgpr_read_b32 v36, a100
    v_accvgpr_read_b32 v37, a101
    v_accvgpr_read_b32 v38, a102
    v_accvgpr_read_b32 v39, a103
    v_pk_mul_f32 v[36:37], v[36:37], v[112:113] op_sel_hi:[1,0]
    v_pk_mul_f32 v[38:39], v[38:39], v[112:113] op_sel_hi:[1,0]
    v_cvt_pk_bf16_f32 v36, v36, v37
    v_cvt_pk_bf16_f32 v37, v38, v39
    v_accvgpr_read_b32 v40, a104
    v_accvgpr_read_b32 v41, a105
    v_accvgpr_read_b32 v42, a106
    v_accvgpr_read_b32 v43, a107
    v_pk_mul_f32 v[40:41], v[40:41], v[112:113] op_sel_hi:[1,0]
    v_pk_mul_f32 v[42:43], v[42:43], v[112:113] op_sel_hi:[1,0]
    v_cvt_pk_bf16_f32 v40, v40, v41
    v_cvt_pk_bf16_f32 v41, v42, v43
    v_accvgpr_read_b32 v44, a108
    v_accvgpr_read_b32 v45, a109
    v_accvgpr_read_b32 v46, a110
    v_accvgpr_read_b32 v47, a111
    v_pk_mul_f32 v[44:45], v[44:45], v[112:113] op_sel_hi:[1,0]
    v_pk_mul_f32 v[46:47], v[46:47], v[112:113] op_sel_hi:[1,0]
    v_cvt_pk_bf16_f32 v44, v44, v45
    v_cvt_pk_bf16_f32 v45, v46, v47
    s_waitcnt lgkmcnt(0)
    buffer_store_dwordx4 v[48:51], v18, s[20:23], s40 offen offset:2048 sc1 nt
    buffer_store_dwordx4 v[52:55], v18, s[20:23], s41 offen offset:2048 sc1 nt
    buffer_store_dwordx4 v[56:59], v18, s[20:23], s42 offen offset:2048 sc1 nt
    buffer_store_dwordx4 v[60:63], v18, s[20:23], s43 offen offset:2048 sc1 nt
    ds_write_b64 v114, v[32:33] offset:0
    ds_write_b64 v115, v[36:37] offset:0
    ds_write_b64 v116, v[40:41] offset:0
    ds_write_b64 v117, v[44:45] offset:0
    v_accvgpr_read_b32 v32, a112
    v_accvgpr_read_b32 v33, a113
    v_accvgpr_read_b32 v34, a114
    v_accvgpr_read_b32 v35, a115
    v_pk_mul_f32 v[32:33], v[32:33], v[112:113] op_sel_hi:[1,0]
    v_pk_mul_f32 v[34:35], v[34:35], v[112:113] op_sel_hi:[1,0]
    v_cvt_pk_bf16_f32 v32, v32, v33
    v_cvt_pk_bf16_f32 v33, v34, v35
    v_accvgpr_read_b32 v36, a116
    v_accvgpr_read_b32 v37, a117
    v_accvgpr_read_b32 v38, a118
    v_accvgpr_read_b32 v39, a119
    v_pk_mul_f32 v[36:37], v[36:37], v[112:113] op_sel_hi:[1,0]
    v_pk_mul_f32 v[38:39], v[38:39], v[112:113] op_sel_hi:[1,0]
    v_cvt_pk_bf16_f32 v36, v36, v37
    v_cvt_pk_bf16_f32 v37, v38, v39
    v_accvgpr_read_b32 v40, a120
    v_accvgpr_read_b32 v41, a121
    v_accvgpr_read_b32 v42, a122
    v_accvgpr_read_b32 v43, a123
    v_pk_mul_f32 v[40:41], v[40:41], v[112:113] op_sel_hi:[1,0]
    v_pk_mul_f32 v[42:43], v[42:43], v[112:113] op_sel_hi:[1,0]
    v_cvt_pk_bf16_f32 v40, v40, v41
    v_cvt_pk_bf16_f32 v41, v42, v43
    v_accvgpr_read_b32 v44, a124
    v_accvgpr_read_b32 v45, a125
    v_accvgpr_read_b32 v46, a126
    v_accvgpr_read_b32 v47, a127
    v_pk_mul_f32 v[44:45], v[44:45], v[112:113] op_sel_hi:[1,0]
    v_pk_mul_f32 v[46:47], v[46:47], v[112:113] op_sel_hi:[1,0]
    v_cvt_pk_bf16_f32 v44, v44, v45
    v_cvt_pk_bf16_f32 v45, v46, v47
    ds_write_b64 v114, v[32:33] offset:128
    ds_write_b64 v115, v[36:37] offset:128
    ds_write_b64 v116, v[40:41] offset:128
    ds_write_b64 v117, v[44:45] offset:128
    ds_read_b128 v[48:51], v118 offset:0
    ds_read_b128 v[52:55], v119 offset:1024
    ds_read_b128 v[56:59], v118 offset:2048
    ds_read_b128 v[60:63], v119 offset:3072
    s_waitcnt lgkmcnt(3)
    buffer_store_dwordx4 v[48:51], v18, s[20:23], s40 offen offset:3072 sc1 nt
    s_waitcnt lgkmcnt(2)
    buffer_store_dwordx4 v[52:55], v18, s[20:23], s41 offen offset:3072 sc1 nt
    s_waitcnt lgkmcnt(1)
    buffer_store_dwordx4 v[56:59], v18, s[20:23], s42 offen offset:3072 sc1 nt
    s_waitcnt lgkmcnt(0)
    buffer_store_dwordx4 v[60:63], v18, s[20:23], s43 offen offset:3072 sc1 nt
    s_cmp_lg_u64 s[56:57], 0
    s_cselect_b32 s54, 2, 0
    s_or_b32 s45, s45, s54
    s_branch L_epidone
L_out4:
    s_cmp_lt_u32 s37, 16
    s_cbranch_scc1 L_last4
    v_smfmac_f32_16x16x64_bf16 v[248:251], v[132:135], v[168:175], v0
    v_xor_b32 v180, 0, v14
    v_xor_b32 v181, 64, v14
    v_xor_b32 v182, 128, v14
    v_xor_b32 v183, 192, v14
    v_mfma_f32_16x16x32_bf16 a[96:99], a[160:163], v[168:171], a[96:99]
    ds_read_b128 v[32:35], v180
    ds_read_b128 v[36:39], v181
    v_mfma_f32_16x16x32_bf16 a[96:99], a[164:167], v[172:175], a[96:99]
    ds_read_b128 v[40:43], v182
    ds_read_b128 v[44:47], v183
    v_mfma_f32_16x16x32_bf16 a[100:103], a[168:171], v[172:175], a[100:103]
    ds_read_b128 v[48:51], v180 offset:1024
    ds_read_b128 v[52:55], v181 offset:1024
    v_mfma_f32_16x16x32_bf16 a[100:103], a[172:175], v[168:171], a[100:103]
    ds_read_b128 v[56:59], v182 offset:1024
    ds_read_b128 v[60:63], v183 offset:1024
    v_mfma_f32_16x16x32_bf16 a[104:107], a[176:179], v[168:171], a[104:107]
    ds_read_b128 v[64:67], v180 offset:2048
    ds_read_b128 v[68:71], v181 offset:2048
    v_mfma_f32_16x16x32_bf16 a[104:107], a[180:183], v[172:175], a[104:107]
    ds_read_b128 v[72:75], v182 offset:2048
    ds_read_b128 v[76:79], v183 offset:2048
    v_mfma_f32_16x16x32_bf16 a[108:111], a[184:187], v[172:175], a[108:111]
    ds_read_b128 v[80:83], v180 offset:3072
    ds_read_b128 v[84:87], v181 offset:3072
    v_mfma_f32_16x16x32_bf16 a[108:111], a[188:191], v[168:171], a[108:111]
    ds_read_b128 v[88:91], v182 offset:3072
    ds_read_b128 v[92:95], v183 offset:3072
    v_mfma_f32_16x16x32_bf16 a[112:115], a[192:195], v[168:171], a[112:115]
    v_mov_b32 v132, 0
    v_mov_b32 v133, 0
    v_mov_b32 v134, 0
    v_mov_b32 v135, 0
    v_add_f32 v20, v20, v21
    v_mfma_f32_16x16x32_bf16 a[112:115], a[196:199], v[172:175], a[112:115]
    v_add_f32 v24, v24, v25
    v_add_f32 v28, v28, v29
    v_add_f32 v248, v248, v249
    v_add_f32 v252, v252, v253
    v_rcp_f32 v112, v20
    v_mfma_f32_16x16x32_bf16 a[116:119], a[200:203], v[172:175], a[116:119]
    v_rcp_f32 v114, v24
    v_rcp_f32 v116, v28
    v_rcp_f32 v118, v248
    v_rcp_f32 v120, v252
    v_cmp_ngt_f32 s[56:57], s62, v20
    v_mfma_f32_16x16x32_bf16 a[116:119], a[204:207], v[168:171], a[116:119]
    v_cmp_ngt_f32 vcc, s62, v24
    s_or_b64 s[56:57], s[56:57], vcc
    v_cmp_ngt_f32 vcc, s62, v28
    s_or_b64 s[56:57], s[56:57], vcc
    v_cmp_ngt_f32 vcc, s62, v248
    v_mfma_f32_16x16x32_bf16 a[120:123], a[208:211], v[168:171], a[120:123]
    s_or_b64 s[56:57], s[56:57], vcc
    v_cmp_ngt_f32 vcc, s62, v252
    s_or_b64 s[56:57], s[56:57], vcc
    s_cmp_lg_u64 s[56:57], 0
    s_cselect_b32 s54, 1, 0
    v_mfma_f32_16x16x32_bf16 a[120:123], a[212:215], v[172:175], a[120:123]
    s_lshl_b32 s54, s54, s64
    s_cmp_eq_u32 s46, 0
    s_cselect_b32 s54, s54, 0
    s_or_b32 s45, s45, s54
    s_add_u32 s55, s36, 65536
    v_mfma_f32_16x16x32_bf16 a[124:127], a[216:219], v[172:175], a[124:127]
    s_lshl_b32 s54, s3, 1
    s_add_u32 s54, s54, s64
    s_mul_i32 s54, s54, 77824
    s_add_u32 s20, s10, s54
    s_addc_u32 s21, s11, 0
    v_mfma_f32_16x16x32_bf16 a[124:127], a[220:223], v[168:171], a[124:127]
    s_mov_b32 s49, 1
    s_branch L_trans
L_redomax:
    s_mov_b32 s57, 63
    s_lshl_b32 s56, s64, 18
    v_and_b32 v181, 0xf0, v18
    v_lshlrev_b32 v181, 4, v181
    v_lshrrev_b32 v182, 8, v18
    v_lshl_or_b32 v181, v182, 4, v181
L_max:
    buffer_load_dwordx4 v[184:187], v181, s[12:15], s56 offen offset:0
    buffer_load_dwordx4 v[188:191], v181, s[12:15], s56 offen offset:64
    buffer_load_dwordx4 v[192:195], v181, s[12:15], s56 offen offset:128
    buffer_load_dwordx4 v[196:199], v181, s[12:15], s56 offen offset:192
    s_add_u32 s56, s56, 4096
    s_waitcnt vmcnt(0)
    v_mfma_f32_16x16x32_bf16 v[152:155], v[184:187], v[32:35], 0
    v_mfma_f32_16x16x32_bf16 v[152:155], v[188:191], v[36:39], v[152:155]
    v_mfma_f32_16x16x32_bf16 v[152:155], v[192:195], v[40:43], v[152:155]
    v_mfma_f32_16x16x32_bf16 v[152:155], v[196:199], v[44:47], v[152:155]
    v_mfma_f32_16x16x32_bf16 v[156:159], v[184:187], v[48:51], 0
    v_mfma_f32_16x16x32_bf16 v[156:159], v[188:191], v[52:55], v[156:159]
    v_mfma_f32_16x16x32_bf16 v[156:159], v[192:195], v[56:59], v[156:159]
    v_mfma_f32_16x16x32_bf16 v[156:159], v[196:199], v[60:63], v[156:159]
    v_mfma_f32_16x16x32_bf16 v[160:163], v[184:187], v[64:67], 0
    v_mfma_f32_16x16x32_bf16 v[160:163], v[188:191], v[68:71], v[160:163]
    v_mfma_f32_16x16x32_bf16 v[160:163], v[192:195], v[72:75], v[160:163]
    v_mfma_f32_16x16x32_bf16 v[160:163], v[196:199], v[76:79], v[160:163]
    v_mfma_f32_16x16x32_bf16 v[164:167], v[184:187], v[80:83], 0
    v_mfma_f32_16x16x32_bf16 v[164:167], v[188:191], v[84:87], v[164:167]
    v_mfma_f32_16x16x32_bf16 v[164:167], v[192:195], v[88:91], v[164:167]
    v_mfma_f32_16x16x32_bf16 v[164:167], v[196:199], v[92:95], v[164:167]
    v_mfma_f32_16x16x32_bf16 v[168:171], v[184:187], v[96:99], 0
    v_mfma_f32_16x16x32_bf16 v[168:171], v[188:191], v[100:103], v[168:171]
    v_mfma_f32_16x16x32_bf16 v[168:171], v[192:195], v[104:107], v[168:171]
    v_mfma_f32_16x16x32_bf16 v[168:171], v[196:199], v[108:111], v[168:171]
    s_nop 7
    v_max3_f32 v176, v176, v152, v153
    v_max3_f32 v176, v176, v154, v155
    v_max3_f32 v177, v177, v156, v157
    v_max3_f32 v177, v177, v158, v159
    v_max3_f32 v178, v178, v160, v161
    v_max3_f32 v178, v178, v162, v163
    v_max3_f32 v179, v179, v164, v165
    v_max3_f32 v179, v179, v166, v167
    v_max3_f32 v180, v180, v168, v169
    v_max3_f32 v180, v180, v170, v171
    s_sub_u32 s57, s57, 1
    s_cbranch_scc0 L_max
    ds_read_b128 v[184:187], v2
    ds_read_b128 v[188:191], v3
    ds_read_b128 v[192:195], v4
    ds_read_b128 v[196:199], v5
    s_branch L_maxdone
L_fs0:
    s_add_u32 m0, s29, 98304
    s_nop 0
    buffer_load_dwordx4 v100, s[24:27], s29 offen offset:3072 nt lds
    s_add_u32 m0, s29, 102400
    s_nop 0
    buffer_load_dwordx4 v101, s[24:27], s29 offen offset:3072 nt lds
    s_add_u32 m0, s29, 106496
    s_nop 0
    buffer_load_dwordx4 v102, s[24:27], s29 offen offset:3072 nt lds
    s_add_u32 m0, s29, 110592
    s_nop 0
    buffer_load_dwordx4 v103, s[24:27], s29 offen offset:3072 nt lds
    s_waitcnt vmcnt(12)
    ds_read_b128 v[32:35], v180
    ds_read_b128 v[36:39], v181
    ds_read_b128 v[40:43], v182
    ds_read_b128 v[44:47], v183
    s_waitcnt lgkmcnt(0)
    s_branch L_f0
L_fs1:
    buffer_load_dwordx4 a[224:227], v15, s[24:27], 0 offen offset:0 nt
    buffer_load_dwordx4 a[228:231], v15, s[24:27], 0 offen offset:64 nt
    buffer_load_dwordx4 a[232:235], v15, s[24:27], 0 offen offset:128 nt
    buffer_load_dwordx4 a[236:239], v15, s[24:27], 0 offen offset:192 nt
    s_waitcnt vmcnt(12)
    ds_read_b128 v[48:51], v180 offset:1024
    ds_read_b128 v[52:55], v181 offset:1024
    ds_read_b128 v[56:59], v182 offset:1024
    ds_read_b128 v[60:63], v183 offset:1024
    s_waitcnt lgkmcnt(0)
    s_branch L_f1
L_fs2:
    s_and_b32 s54, s47, 1
    s_lshl_b32 s54, s54, 16
    s_lshr_b32 s55, s47, 1
    s_lshl_b32 s55, s55, 17
    s_or_b32 s54, s54, s55
    s_add_u32 s54, s54, s28
    s_add_u32 m0, s36, 49152
    s_add_u32 s38, s54, 0
    buffer_load_dwordx4 v98, s[16:19], s38 offen nt lds
    s_add_u32 m0, s36, 50176
    s_add_u32 s38, s54, 16384
    buffer_load_dwordx4 v98, s[16:19], s38 offen nt lds
    s_add_u32 m0, s36, 51200
    s_add_u32 s38, s54, 32768
    buffer_load_dwordx4 v98, s[16:19], s38 offen nt lds
    s_add_u32 m0, s36, 52224
    s_add_u32 s38, s54, 49152
    buffer_load_dwordx4 v98, s[16:19], s38 offen nt lds
    s_or_b32 s28, s28, 0xffffc3ff
    s_add_u32 s28, s28, 1
    s_and_b32 s28, s28, 0x3c00
    s_add_u32 s30, s30, 16384
    s_and_b32 s55, s30, 262144
    s_or_b32 s28, s28, s55
    s_waitcnt vmcnt(12)
    ds_read_b128 v[64:67], v180 offset:2048
    ds_read_b128 v[68:71], v181 offset:2048
    ds_read_b128 v[72:75], v182 offset:2048
    ds_read_b128 v[76:79], v183 offset:2048
    s_waitcnt lgkmcnt(0)
    s_branch L_f2
L_fs3:
    s_cmp_eq_u32 s47, 3
    s_cbranch_scc0 L_g3
    s_mov_b32 m0, 16384
    s_add_u32 s38, s28, 0
    buffer_load_dwordx4 v108, s[12:15], s38 offen nt lds
    s_mov_b32 m0, 17408
    s_add_u32 s38, s28, 16384
    buffer_load_dwordx4 v108, s[12:15], s38 offen nt lds
    s_mov_b32 m0, 18432
    s_add_u32 s38, s28, 32768
    buffer_load_dwordx4 v108, s[12:15], s38 offen nt lds
    s_mov_b32 m0, 19456
    s_add_u32 s38, s28, 49152
    buffer_load_dwordx4 v108, s[12:15], s38 offen nt lds
    s_mov_b32 m0, 20480
    s_add_u32 s38, s28, 65536
    buffer_load_dwordx4 v109, s[12:15], s38 offen nt lds
    s_mov_b32 m0, 21504
    s_add_u32 s38, s28, 81920
    buffer_load_dwordx4 v109, s[12:15], s38 offen nt lds
    s_mov_b32 m0, 22528
    s_add_u32 s38, s28, 98304
    buffer_load_dwordx4 v109, s[12:15], s38 offen nt lds
    s_mov_b32 m0, 23552
    s_add_u32 s38, s28, 114688
    buffer_load_dwordx4 v109, s[12:15], s38 offen nt lds
    s_mov_b32 m0, 24576
    s_add_u32 s38, s28, 131072
    buffer_load_dwordx4 v110, s[12:15], s38 offen nt lds
    s_mov_b32 m0, 25600
    s_add_u32 s38, s28, 147456
    buffer_load_dwordx4 v110, s[12:15], s38 offen nt lds
    s_mov_b32 m0, 26624
    s_add_u32 s38, s28, 163840
    buffer_load_dwordx4 v110, s[12:15], s38 offen nt lds
    s_mov_b32 m0, 27648
    s_add_u32 s38, s28, 180224
    buffer_load_dwordx4 v110, s[12:15], s38 offen nt lds
    s_mov_b32 m0, 28672
    s_add_u32 s38, s28, 196608
    buffer_load_dwordx4 v111, s[12:15], s38 offen nt lds
    s_mov_b32 m0, 29696
    s_add_u32 s38, s28, 212992
    buffer_load_dwordx4 v111, s[12:15], s38 offen nt lds
    s_mov_b32 m0, 30720
    s_add_u32 s38, s28, 229376
    buffer_load_dwordx4 v111, s[12:15], s38 offen nt lds
    s_mov_b32 m0, 31744
    s_add_u32 s38, s28, 245760
    buffer_load_dwordx4 v111, s[12:15], s38 offen nt lds
    s_mov_b32 m0, 65536
    s_add_u32 s38, s28, 0
    buffer_load_dwordx4 v108, s[16:19], s38 offen nt lds
    s_mov_b32 m0, 66560
    s_add_u32 s38, s28, 16384
    buffer_load_dwordx4 v108, s[16:19], s38 offen nt lds
    s_mov_b32 m0, 67584
    s_add_u32 s38, s28, 32768
    buffer_load_dwordx4 v108, s[16:19], s38 offen nt lds
    s_mov_b32 m0, 68608
    s_add_u32 s38, s28, 49152
    buffer_load_dwordx4 v108, s[16:19], s38 offen nt lds
    s_mov_b32 m0, 69632
    s_add_u32 s38, s28, 65536
    buffer_load_dwordx4 v109, s[16:19], s38 offen nt lds
    s_mov_b32 m0, 70656
    s_add_u32 s38, s28, 81920
    buffer_load_dwordx4 v109, s[16:19], s38 offen nt lds
    s_mov_b32 m0, 71680
    s_add_u32 s38, s28, 98304
    buffer_load_dwordx4 v109, s[16:19], s38 offen nt lds
    s_mov_b32 m0, 72704
    s_add_u32 s38, s28, 114688
    buffer_load_dwordx4 v109, s[16:19], s38 offen nt lds
    s_mov_b32 m0, 73728
    s_add_u32 s38, s28, 131072
    buffer_load_dwordx4 v110, s[16:19], s38 offen nt lds
    s_mov_b32 m0, 74752
    s_add_u32 s38, s28, 147456
    buffer_load_dwordx4 v110, s[16:19], s38 offen nt lds
    s_mov_b32 m0, 75776
    s_add_u32 s38, s28, 163840
    buffer_load_dwordx4 v110, s[16:19], s38 offen nt lds
    s_mov_b32 m0, 76800
    s_add_u32 s38, s28, 180224
    buffer_load_dwordx4 v110, s[16:19], s38 offen nt lds
    s_mov_b32 m0, 77824
    s_add_u32 s38, s28, 196608
    buffer_load_dwordx4 v111, s[16:19], s38 offen nt lds
    s_mov_b32 m0, 78848
    s_add_u32 s38, s28, 212992
    buffer_load_dwordx4 v111, s[16:19], s38 offen nt lds
    s_mov_b32 m0, 79872
    s_add_u32 s38, s28, 229376
    buffer_load_dwordx4 v111, s[16:19], s38 offen nt lds
    s_mov_b32 m0, 80896
    s_add_u32 s38, s28, 245760
    buffer_load_dwordx4 v111, s[16:19], s38 offen nt lds
    s_or_b32 s28, s28, 0xffffc3ff
    s_add_u32 s28, s28, 1
    s_and_b32 s28, s28, 0x3c00
    s_add_u32 s30, s30, 16384
    s_and_b32 s55, s30, 262144
    s_or_b32 s28, s28, s55
    s_waitcnt vmcnt(40)
    s_branch L_h3
L_g3:
    s_waitcnt vmcnt(8)
L_h3:
    ds_read_b128 v[80:83], v180 offset:3072
    ds_read_b128 v[84:87], v181 offset:3072
    ds_read_b128 v[88:91], v182 offset:3072
    ds_read_b128 v[92:95], v183 offset:3072
    s_waitcnt lgkmcnt(0)
    s_branch L_f3
L_noq4:
    v_mfma_f32_16x16x32_bf16 v[164:167], v[184:187], v[80:83], 0
    v_mfma_f32_16x16x32_bf16 v[164:167], v[188:191], v[84:87], v[164:167]
    v_mfma_f32_16x16x32_bf16 v[164:167], v[192:195], v[88:91], v[164:167]
    v_mfma_f32_16x16x32_bf16 v[164:167], v[196:199], v[92:95], v[164:167]
    s_branch L_q4done
L_final:
    s_lshl_b32 s40, s47, 14
    s_add_u32 s54, s40, 98304
    s_add_u32 s41, s40, 4096
    s_add_u32 s42, s40, 8192
    s_add_u32 s43, s40, 12288
    v_add_u32 v122, s54, v16
    v_add_u32 v126, s54, v17
    v_xor_b32 v123, 32, v122
    v_xor_b32 v124, 64, v122
    v_xor_b32 v125, 96, v122
    v_xor_b32 v127, 64, v126
    v_accvgpr_read_b32 v136, a0
    v_accvgpr_read_b32 v137, a1
    v_accvgpr_read_b32 v138, a2
    v_accvgpr_read_b32 v139, a3
    v_pk_mul_f32 v[136:137], v[136:137], v[112:113] op_sel_hi:[1,0]
    v_pk_mul_f32 v[138:139], v[138:139], v[112:113] op_sel_hi:[1,0]
    v_cvt_pk_bf16_f32 v136, v136, v137
    v_cvt_pk_bf16_f32 v137, v138, v139
    ds_write_b64 v122, v[136:137] offset:0
    v_accvgpr_read_b32 v140, a4
    v_accvgpr_read_b32 v141, a5
    v_accvgpr_read_b32 v142, a6
    v_accvgpr_read_b32 v143, a7
    v_pk_mul_f32 v[140:141], v[140:141], v[112:113] op_sel_hi:[1,0]
    v_pk_mul_f32 v[142:143], v[142:143], v[112:113] op_sel_hi:[1,0]
    v_cvt_pk_bf16_f32 v140, v140, v141
    v_cvt_pk_bf16_f32 v141, v142, v143
    ds_write_b64 v123, v[140:141] offset:0
    v_accvgpr_read_b32 v144, a8
    v_accvgpr_read_b32 v145, a9
    v_accvgpr_read_b32 v146, a10
    v_accvgpr_read_b32 v147, a11
    v_pk_mul_f32 v[144:145], v[144:145], v[112:113] op_sel_hi:[1,0]
    v_pk_mul_f32 v[146:147], v[146:147], v[112:113] op_sel_hi:[1,0]
    v_cvt_pk_bf16_f32 v144, v144, v145
    v_cvt_pk_bf16_f32 v145, v146, v147
    ds_write_b64 v124, v[144:145] offset:0
    v_accvgpr_read_b32 v148, a12
    v_accvgpr_read_b32 v149, a13
    v_accvgpr_read_b32 v150, a14
    v_accvgpr_read_b32 v151, a15
    v_pk_mul_f32 v[148:149], v[148:149], v[112:113] op_sel_hi:[1,0]
    v_pk_mul_f32 v[150:151], v[150:151], v[112:113] op_sel_hi:[1,0]
    v_cvt_pk_bf16_f32 v148, v148, v149
    v_cvt_pk_bf16_f32 v149, v150, v151
    ds_write_b64 v125, v[148:149] offset:0
    v_accvgpr_read_b32 v136, a16
    v_accvgpr_read_b32 v137, a17
    v_accvgpr_read_b32 v138, a18
    v_accvgpr_read_b32 v139, a19
    v_pk_mul_f32 v[136:137], v[136:137], v[112:113] op_sel_hi:[1,0]
    v_pk_mul_f32 v[138:139], v[138:139], v[112:113] op_sel_hi:[1,0]
    v_cvt_pk_bf16_f32 v136, v136, v137
    v_cvt_pk_bf16_f32 v137, v138, v139
    ds_write_b64 v122, v[136:137] offset:128
    v_accvgpr_read_b32 v140, a20
    v_accvgpr_read_b32 v141, a21
    v_accvgpr_read_b32 v142, a22
    v_accvgpr_read_b32 v143, a23
    v_pk_mul_f32 v[140:141], v[140:141], v[112:113] op_sel_hi:[1,0]
    v_pk_mul_f32 v[142:143], v[142:143], v[112:113] op_sel_hi:[1,0]
    v_cvt_pk_bf16_f32 v140, v140, v141
    v_cvt_pk_bf16_f32 v141, v142, v143
    ds_write_b64 v123, v[140:141] offset:128
    v_accvgpr_read_b32 v144, a24
    v_accvgpr_read_b32 v145, a25
    v_accvgpr_read_b32 v146, a26
    v_accvgpr_read_b32 v147, a27
    v_pk_mul_f32 v[144:145], v[144:145], v[112:113] op_sel_hi:[1,0]
    v_pk_mul_f32 v[146:147], v[146:147], v[112:113] op_sel_hi:[1,0]
    v_cvt_pk_bf16_f32 v144, v144, v145
    v_cvt_pk_bf16_f32 v145, v146, v147
    ds_write_b64 v124, v[144:145] offset:128
    v_accvgpr_read_b32 v148, a28
    v_accvgpr_read_b32 v149, a29
    v_accvgpr_read_b32 v150, a30
    v_accvgpr_read_b32 v151, a31
    v_pk_mul_f32 v[148:149], v[148:149], v[112:113] op_sel_hi:[1,0]
    v_pk_mul_f32 v[150:151], v[150:151], v[112:113] op_sel_hi:[1,0]
    v_cvt_pk_bf16_f32 v148, v148, v149
    v_cvt_pk_bf16_f32 v149, v150, v151
    ds_write_b64 v125, v[148:149] offset:128
    ds_read_b128 v[152:155], v126 offset:0
    ds_read_b128 v[156:159], v127 offset:1024
    ds_read_b128 v[160:163], v126 offset:2048
    ds_read_b128 v[164:167], v127 offset:3072
    v_accvgpr_read_b32 v136, a32
    v_accvgpr_read_b32 v137, a33
    v_accvgpr_read_b32 v138, a34
    v_accvgpr_read_b32 v139, a35
    v_pk_mul_f32 v[136:137], v[136:137], v[114:115] op_sel_hi:[1,0]
    v_pk_mul_f32 v[138:139], v[138:139], v[114:115] op_sel_hi:[1,0]
    v_cvt_pk_bf16_f32 v136, v136, v137
    v_cvt_pk_bf16_f32 v137, v138, v139
    ds_write_b64 v122, v[136:137] offset:4096
    v_accvgpr_read_b32 v140, a36
    v_accvgpr_read_b32 v141, a37
    v_accvgpr_read_b32 v142, a38
    v_accvgpr_read_b32 v143, a39
    v_pk_mul_f32 v[140:141], v[140:141], v[114:115] op_sel_hi:[1,0]
    v_pk_mul_f32 v[142:143], v[142:143], v[114:115] op_sel_hi:[1,0]
    v_cvt_pk_bf16_f32 v140, v140, v141
    v_cvt_pk_bf16_f32 v141, v142, v143
    ds_write_b64 v123, v[140:141] offset:4096
    v_accvgpr_read_b32 v144, a40
    v_accvgpr_read_b32 v145, a41
    v_accvgpr_read_b32 v146, a42
    v_accvgpr_read_b32 v147, a43
    v_pk_mul_f32 v[144:145], v[144:145], v[114:115] op_sel_hi:[1,0]
    v_pk_mul_f32 v[146:147], v[146:147], v[114:115] op_sel_hi:[1,0]
    v_cvt_pk_bf16_f32 v144, v144, v145
    v_cvt_pk_bf16_f32 v145, v146, v147
    ds_write_b64 v124, v[144:145] offset:4096
    v_accvgpr_read_b32 v148, a44
    v_accvgpr_read_b32 v149, a45
    v_accvgpr_read_b32 v150, a46
    v_accvgpr_read_b32 v151, a47
    v_pk_mul_f32 v[148:149], v[148:149], v[114:115] op_sel_hi:[1,0]
    v_pk_mul_f32 v[150:151], v[150:151], v[114:115] op_sel_hi:[1,0]
    v_cvt_pk_bf16_f32 v148, v148, v149
    v_cvt_pk_bf16_f32 v149, v150, v151
    s_waitcnt lgkmcnt(3)
    ds_write_b64 v125, v[148:149] offset:4096
    buffer_store_dwordx4 v[152:155], v18, s[20:23], s40 offen sc1 nt
    v_accvgpr_read_b32 v136, a48
    v_accvgpr_read_b32 v137, a49
    v_accvgpr_read_b32 v138, a50
    v_accvgpr_read_b32 v139, a51
    v_pk_mul_f32 v[136:137], v[136:137], v[114:115] op_sel_hi:[1,0]
    v_pk_mul_f32 v[138:139], v[138:139], v[114:115] op_sel_hi:[1,0]
    v_cvt_pk_bf16_f32 v136, v136, v137
    v_cvt_pk_bf16_f32 v137, v138, v139
    ds_write_b64 v122, v[136:137] offset:4224
    buffer_store_dwordx4 v[156:159], v18, s[20:23], s41 offen sc1 nt
    v_accvgpr_read_b32 v140, a52
    v_accvgpr_read_b32 v141, a53
    v_accvgpr_read_b32 v142, a54
    v_accvgpr_read_b32 v143, a55
    v_pk_mul_f32 v[140:141], v[140:141], v[114:115] op_sel_hi:[1,0]
    v_pk_mul_f32 v[142:143], v[142:143], v[114:115] op_sel_hi:[1,0]
    v_cvt_pk_bf16_f32 v140, v140, v141
    v_cvt_pk_bf16_f32 v141, v142, v143
    ds_write_b64 v123, v[140:141] offset:4224
    buffer_store_dwordx4 v[160:163], v18, s[20:23], s42 offen sc1 nt
    v_accvgpr_read_b32 v144, a56
    v_accvgpr_read_b32 v145, a57
    v_accvgpr_read_b32 v146, a58
    v_accvgpr_read_b32 v147, a59
    v_pk_mul_f32 v[144:145], v[144:145], v[114:115] op_sel_hi:[1,0]
    v_pk_mul_f32 v[146:147], v[146:147], v[114:115] op_sel_hi:[1,0]
    v_cvt_pk_bf16_f32 v144, v144, v145
    v_cvt_pk_bf16_f32 v145, v146, v147
    ds_write_b64 v124, v[144:145] offset:4224
    buffer_store_dwordx4 v[164:167], v18, s[20:23], s43 offen sc1 nt
    v_accvgpr_read_b32 v148, a60
    v_accvgpr_read_b32 v149, a61
    v_accvgpr_read_b32 v150, a62
    v_accvgpr_read_b32 v151, a63
    v_pk_mul_f32 v[148:149], v[148:149], v[114:115] op_sel_hi:[1,0]
    v_pk_mul_f32 v[150:151], v[150:151], v[114:115] op_sel_hi:[1,0]
    v_cvt_pk_bf16_f32 v148, v148, v149
    v_cvt_pk_bf16_f32 v149, v150, v151
    ds_write_b64 v125, v[148:149] offset:4224
    ds_read_b128 v[168:171], v126 offset:4096
    ds_read_b128 v[172:175], v127 offset:5120
    ds_read_b128 v[176:179], v126 offset:6144
    ds_read_b128 v[180:183], v127 offset:7168
    v_accvgpr_read_b32 v136, a64
    v_accvgpr_read_b32 v137, a65
    v_accvgpr_read_b32 v138, a66
    v_accvgpr_read_b32 v139, a67
    v_pk_mul_f32 v[136:137], v[136:137], v[116:117] op_sel_hi:[1,0]
    v_pk_mul_f32 v[138:139], v[138:139], v[116:117] op_sel_hi:[1,0]
    v_cvt_pk_bf16_f32 v136, v136, v137
    v_cvt_pk_bf16_f32 v137, v138, v139
    ds_write_b64 v122, v[136:137] offset:8192
    v_accvgpr_read_b32 v140, a68
    v_accvgpr_read_b32 v141, a69
    v_accvgpr_read_b32 v142, a70
    v_accvgpr_read_b32 v143, a71
    v_pk_mul_f32 v[140:141], v[140:141], v[116:117] op_sel_hi:[1,0]
    v_pk_mul_f32 v[142:143], v[142:143], v[116:117] op_sel_hi:[1,0]
    v_cvt_pk_bf16_f32 v140, v140, v141
    v_cvt_pk_bf16_f32 v141, v142, v143
    ds_write_b64 v123, v[140:141] offset:8192
    v_accvgpr_read_b32 v144, a72
    v_accvgpr_read_b32 v145, a73
    v_accvgpr_read_b32 v146, a74
    v_accvgpr_read_b32 v147, a75
    v_pk_mul_f32 v[144:145], v[144:145], v[116:117] op_sel_hi:[1,0]
    v_pk_mul_f32 v[146:147], v[146:147], v[116:117] op_sel_hi:[1,0]
    v_cvt_pk_bf16_f32 v144, v144, v145
    v_cvt_pk_bf16_f32 v145, v146, v147
    ds_write_b64 v124, v[144:145] offset:8192
    v_accvgpr_read_b32 v148, a76
    v_accvgpr_read_b32 v149, a77
    v_accvgpr_read_b32 v150, a78
    v_accvgpr_read_b32 v151, a79
    v_pk_mul_f32 v[148:149], v[148:149], v[116:117] op_sel_hi:[1,0]
    v_pk_mul_f32 v[150:151], v[150:151], v[116:117] op_sel_hi:[1,0]
    v_cvt_pk_bf16_f32 v148, v148, v149
    v_cvt_pk_bf16_f32 v149, v150, v151
    s_waitcnt lgkmcnt(3)
    ds_write_b64 v125, v[148:149] offset:8192
    buffer_store_dwordx4 v[168:171], v18, s[20:23], s40 offen offset:1024 sc1 nt
    v_accvgpr_read_b32 v136, a80
    v_accvgpr_read_b32 v137, a81
    v_accvgpr_read_b32 v138, a82
    v_accvgpr_read_b32 v139, a83
    v_pk_mul_f32 v[136:137], v[136:137], v[116:117] op_sel_hi:[1,0]
    v_pk_mul_f32 v[138:139], v[138:139], v[116:117] op_sel_hi:[1,0]
    v_cvt_pk_bf16_f32 v136, v136, v137
    v_cvt_pk_bf16_f32 v137, v138, v139
    ds_write_b64 v122, v[136:137] offset:8320
    buffer_store_dwordx4 v[172:175], v18, s[20:23], s41 offen offset:1024 sc1 nt
    v_accvgpr_read_b32 v140, a84
    v_accvgpr_read_b32 v141, a85
    v_accvgpr_read_b32 v142, a86
    v_accvgpr_read_b32 v143, a87
    v_pk_mul_f32 v[140:141], v[140:141], v[116:117] op_sel_hi:[1,0]
    v_pk_mul_f32 v[142:143], v[142:143], v[116:117] op_sel_hi:[1,0]
    v_cvt_pk_bf16_f32 v140, v140, v141
    v_cvt_pk_bf16_f32 v141, v142, v143
    ds_write_b64 v123, v[140:141] offset:8320
    buffer_store_dwordx4 v[176:179], v18, s[20:23], s42 offen offset:1024 sc1 nt
    v_accvgpr_read_b32 v144, a88
    v_accvgpr_read_b32 v145, a89
    v_accvgpr_read_b32 v146, a90
    v_accvgpr_read_b32 v147, a91
    v_pk_mul_f32 v[144:145], v[144:145], v[116:117] op_sel_hi:[1,0]
    v_pk_mul_f32 v[146:147], v[146:147], v[116:117] op_sel_hi:[1,0]
    v_cvt_pk_bf16_f32 v144, v144, v145
    v_cvt_pk_bf16_f32 v145, v146, v147
    ds_write_b64 v124, v[144:145] offset:8320
    buffer_store_dwordx4 v[180:183], v18, s[20:23], s43 offen offset:1024 sc1 nt
    v_accvgpr_read_b32 v148, a92
    v_accvgpr_read_b32 v149, a93
    v_accvgpr_read_b32 v150, a94
    v_accvgpr_read_b32 v151, a95
    v_pk_mul_f32 v[148:149], v[148:149], v[116:117] op_sel_hi:[1,0]
    v_pk_mul_f32 v[150:151], v[150:151], v[116:117] op_sel_hi:[1,0]
    v_cvt_pk_bf16_f32 v148, v148, v149
    v_cvt_pk_bf16_f32 v149, v150, v151
    ds_write_b64 v125, v[148:149] offset:8320
    ds_read_b128 v[152:155], v126 offset:8192
    ds_read_b128 v[156:159], v127 offset:9216
    ds_read_b128 v[160:163], v126 offset:10240
    ds_read_b128 v[164:167], v127 offset:11264
    v_accvgpr_read_b32 v136, a96
    v_accvgpr_read_b32 v137, a97
    v_accvgpr_read_b32 v138, a98
    v_accvgpr_read_b32 v139, a99
    v_pk_mul_f32 v[136:137], v[136:137], v[118:119] op_sel_hi:[1,0]
    v_pk_mul_f32 v[138:139], v[138:139], v[118:119] op_sel_hi:[1,0]
    v_cvt_pk_bf16_f32 v136, v136, v137
    v_cvt_pk_bf16_f32 v137, v138, v139
    ds_write_b64 v122, v[136:137] offset:12288
    v_accvgpr_read_b32 v140, a100
    v_accvgpr_read_b32 v141, a101
    v_accvgpr_read_b32 v142, a102
    v_accvgpr_read_b32 v143, a103
    v_pk_mul_f32 v[140:141], v[140:141], v[118:119] op_sel_hi:[1,0]
    v_pk_mul_f32 v[142:143], v[142:143], v[118:119] op_sel_hi:[1,0]
    v_cvt_pk_bf16_f32 v140, v140, v141
    v_cvt_pk_bf16_f32 v141, v142, v143
    ds_write_b64 v123, v[140:141] offset:12288
    v_accvgpr_read_b32 v144, a104
    v_accvgpr_read_b32 v145, a105
    v_accvgpr_read_b32 v146, a106
    v_accvgpr_read_b32 v147, a107
    v_pk_mul_f32 v[144:145], v[144:145], v[118:119] op_sel_hi:[1,0]
    v_pk_mul_f32 v[146:147], v[146:147], v[118:119] op_sel_hi:[1,0]
    v_cvt_pk_bf16_f32 v144, v144, v145
    v_cvt_pk_bf16_f32 v145, v146, v147
    ds_write_b64 v124, v[144:145] offset:12288
    v_accvgpr_read_b32 v148, a108
    v_accvgpr_read_b32 v149, a109
    v_accvgpr_read_b32 v150, a110
    v_accvgpr_read_b32 v151, a111
    v_pk_mul_f32 v[148:149], v[148:149], v[118:119] op_sel_hi:[1,0]
    v_pk_mul_f32 v[150:151], v[150:151], v[118:119] op_sel_hi:[1,0]
    v_cvt_pk_bf16_f32 v148, v148, v149
    v_cvt_pk_bf16_f32 v149, v150, v151
    s_waitcnt lgkmcnt(3)
    ds_write_b64 v125, v[148:149] offset:12288
    buffer_store_dwordx4 v[152:155], v18, s[20:23], s40 offen offset:2048 sc1 nt
    v_accvgpr_read_b32 v136, a112
    v_accvgpr_read_b32 v137, a113
    v_accvgpr_read_b32 v138, a114
    v_accvgpr_read_b32 v139, a115
    v_pk_mul_f32 v[136:137], v[136:137], v[118:119] op_sel_hi:[1,0]
    v_pk_mul_f32 v[138:139], v[138:139], v[118:119] op_sel_hi:[1,0]
    v_cvt_pk_bf16_f32 v136, v136, v137
    v_cvt_pk_bf16_f32 v137, v138, v139
    ds_write_b64 v122, v[136:137] offset:12416
    buffer_store_dwordx4 v[156:159], v18, s[20:23], s41 offen offset:2048 sc1 nt
    v_accvgpr_read_b32 v140, a116
    v_accvgpr_read_b32 v141, a117
    v_accvgpr_read_b32 v142, a118
    v_accvgpr_read_b32 v143, a119
    v_pk_mul_f32 v[140:141], v[140:141], v[118:119] op_sel_hi:[1,0]
    v_pk_mul_f32 v[142:143], v[142:143], v[118:119] op_sel_hi:[1,0]
    v_cvt_pk_bf16_f32 v140, v140, v141
    v_cvt_pk_bf16_f32 v141, v142, v143
    ds_write_b64 v123, v[140:141] offset:12416
    buffer_store_dwordx4 v[160:163], v18, s[20:23], s42 offen offset:2048 sc1 nt
    v_accvgpr_read_b32 v144, a120
    v_accvgpr_read_b32 v145, a121
    v_accvgpr_read_b32 v146, a122
    v_accvgpr_read_b32 v147, a123
    v_pk_mul_f32 v[144:145], v[144:145], v[118:119] op_sel_hi:[1,0]
    v_pk_mul_f32 v[146:147], v[146:147], v[118:119] op_sel_hi:[1,0]
    v_cvt_pk_bf16_f32 v144, v144, v145
    v_cvt_pk_bf16_f32 v145, v146, v147
    ds_write_b64 v124, v[144:145] offset:12416
    buffer_store_dwordx4 v[164:167], v18, s[20:23], s43 offen offset:2048 sc1 nt
    v_accvgpr_read_b32 v148, a124
    v_accvgpr_read_b32 v149, a125
    v_accvgpr_read_b32 v150, a126
    v_accvgpr_read_b32 v151, a127
    v_pk_mul_f32 v[148:149], v[148:149], v[118:119] op_sel_hi:[1,0]
    v_pk_mul_f32 v[150:151], v[150:151], v[118:119] op_sel_hi:[1,0]
    v_cvt_pk_bf16_f32 v148, v148, v149
    v_cvt_pk_bf16_f32 v149, v150, v151
    ds_write_b64 v125, v[148:149] offset:12416
    ds_read_b128 v[168:171], v126 offset:12288
    ds_read_b128 v[172:175], v127 offset:13312
    ds_read_b128 v[176:179], v126 offset:14336
    ds_read_b128 v[180:183], v127 offset:15360
    s_cmp_eq_u32 s47, 3
    s_cbranch_scc1 L_epi3
    v_accvgpr_read_b32 v136, a128
    v_accvgpr_read_b32 v137, a129
    v_accvgpr_read_b32 v138, a130
    v_accvgpr_read_b32 v139, a131
    v_pk_mul_f32 v[136:137], v[136:137], v[120:121] op_sel_hi:[1,0]
    v_pk_mul_f32 v[138:139], v[138:139], v[120:121] op_sel_hi:[1,0]
    v_cvt_pk_bf16_f32 v136, v136, v137
    v_cvt_pk_bf16_f32 v137, v138, v139
    ds_write_b64 v122, v[136:137] offset:0
    v_accvgpr_read_b32 v140, a132
    v_accvgpr_read_b32 v141, a133
    v_accvgpr_read_b32 v142, a134
    v_accvgpr_read_b32 v143, a135
    v_pk_mul_f32 v[140:141], v[140:141], v[120:121] op_sel_hi:[1,0]
    v_pk_mul_f32 v[142:143], v[142:143], v[120:121] op_sel_hi:[1,0]
    v_cvt_pk_bf16_f32 v140, v140, v141
    v_cvt_pk_bf16_f32 v141, v142, v143
    ds_write_b64 v123, v[140:141] offset:0
    v_accvgpr_read_b32 v144, a136
    v_accvgpr_read_b32 v145, a137
    v_accvgpr_read_b32 v146, a138
    v_accvgpr_read_b32 v147, a139
    v_pk_mul_f32 v[144:145], v[144:145], v[120:121] op_sel_hi:[1,0]
    v_pk_mul_f32 v[146:147], v[146:147], v[120:121] op_sel_hi:[1,0]
    v_cvt_pk_bf16_f32 v144, v144, v145
    v_cvt_pk_bf16_f32 v145, v146, v147
    ds_write_b64 v124, v[144:145] offset:0
    v_accvgpr_read_b32 v148, a140
    v_accvgpr_read_b32 v149, a141
    v_accvgpr_read_b32 v150, a142
    v_accvgpr_read_b32 v151, a143
    v_pk_mul_f32 v[148:149], v[148:149], v[120:121] op_sel_hi:[1,0]
    v_pk_mul_f32 v[150:151], v[150:151], v[120:121] op_sel_hi:[1,0]
    v_cvt_pk_bf16_f32 v148, v148, v149
    v_cvt_pk_bf16_f32 v149, v150, v151
    s_waitcnt lgkmcnt(3)
    ds_write_b64 v125, v[148:149] offset:0
    buffer_store_dwordx4 v[168:171], v18, s[20:23], s40 offen offset:3072 sc1 nt
    v_accvgpr_read_b32 v136, a144
    v_accvgpr_read_b32 v137, a145
    v_accvgpr_read_b32 v138, a146
    v_accvgpr_read_b32 v139, a147
    v_pk_mul_f32 v[136:137], v[136:137], v[120:121] op_sel_hi:[1,0]
    v_pk_mul_f32 v[138:139], v[138:139], v[120:121] op_sel_hi:[1,0]
    v_cvt_pk_bf16_f32 v136, v136, v137
    v_cvt_pk_bf16_f32 v137, v138, v139
    ds_write_b64 v122, v[136:137] offset:128
    buffer_store_dwordx4 v[172:175], v18, s[20:23], s41 offen offset:3072 sc1 nt
    v_accvgpr_read_b32 v140, a148
    v_accvgpr_read_b32 v141, a149
    v_accvgpr_read_b32 v142, a150
    v_accvgpr_read_b32 v143, a151
    v_pk_mul_f32 v[140:141], v[140:141], v[120:121] op_sel_hi:[1,0]
    v_pk_mul_f32 v[142:143], v[142:143], v[120:121] op_sel_hi:[1,0]
    v_cvt_pk_bf16_f32 v140, v140, v141
    v_cvt_pk_bf16_f32 v141, v142, v143
    ds_write_b64 v123, v[140:141] offset:128
    buffer_store_dwordx4 v[176:179], v18, s[20:23], s42 offen offset:3072 sc1 nt
    v_accvgpr_read_b32 v144, a152
    v_accvgpr_read_b32 v145, a153
    v_accvgpr_read_b32 v146, a154
    v_accvgpr_read_b32 v147, a155
    v_pk_mul_f32 v[144:145], v[144:145], v[120:121] op_sel_hi:[1,0]
    v_pk_mul_f32 v[146:147], v[146:147], v[120:121] op_sel_hi:[1,0]
    v_cvt_pk_bf16_f32 v144, v144, v145
    v_cvt_pk_bf16_f32 v145, v146, v147
    ds_write_b64 v124, v[144:145] offset:128
    buffer_store_dwordx4 v[180:183], v18, s[20:23], s43 offen offset:3072 sc1 nt
    v_accvgpr_read_b32 v148, a156
    v_accvgpr_read_b32 v149, a157
    v_accvgpr_read_b32 v150, a158
    v_accvgpr_read_b32 v151, a159
    v_pk_mul_f32 v[148:149], v[148:149], v[120:121] op_sel_hi:[1,0]
    v_pk_mul_f32 v[150:151], v[150:151], v[120:121] op_sel_hi:[1,0]
    v_cvt_pk_bf16_f32 v148, v148, v149
    v_cvt_pk_bf16_f32 v149, v150, v151
    ds_write_b64 v125, v[148:149] offset:128
    ds_read_b128 v[152:155], v126 offset:0
    ds_read_b128 v[156:159], v127 offset:1024
    ds_read_b128 v[160:163], v126 offset:2048
    ds_read_b128 v[164:167], v127 offset:3072
    s_waitcnt lgkmcnt(3)
    buffer_store_dwordx4 v[152:155], v18, s[20:23], s55 offen sc1 nt
    s_waitcnt lgkmcnt(2)
    buffer_store_dwordx4 v[156:159], v18, s[20:23], s55 offen offset:1024 sc1 nt
    s_waitcnt lgkmcnt(1)
    buffer_store_dwordx4 v[160:163], v18, s[20:23], s55 offen offset:2048 sc1 nt
    s_waitcnt lgkmcnt(0)
    buffer_store_dwordx4 v[164:167], v18, s[20:23], s55 offen offset:3072 sc1 nt
    s_branch L_epidone
L_epi3:
    s_waitcnt lgkmcnt(3)
    buffer_store_dwordx4 v[168:171], v18, s[20:23], s40 offen offset:3072 sc1 nt
    s_waitcnt lgkmcnt(2)
    buffer_store_dwordx4 v[172:175], v18, s[20:23], s41 offen offset:3072 sc1 nt
    s_waitcnt lgkmcnt(1)
    buffer_store_dwordx4 v[176:179], v18, s[20:23], s42 offen offset:3072 sc1 nt
    s_waitcnt lgkmcnt(0)
    buffer_store_dwordx4 v[180:183], v18, s[20:23], s43 offen offset:3072 sc1 nt
L_epidone:
    s_lshl_b32 s55, s47, 2
    s_add_u32 s55, s55, s52
    v_mov_b32 v181, s45
    v_mov_b32 v182, s55
    ds_write_b32 v182, v181
    v_mov_b32 v182, s52
    s_waitcnt lgkmcnt(0)
    s_barrier
    ds_read_b128 v[184:187], v182
    s_waitcnt lgkmcnt(0)
    v_or_b32 v181, v184, v185
    v_or3_b32 v181, v181, v186, v187
    s_nop 1
    v_readfirstlane_b32 s45, v181
    s_nop 3
    s_cmp_eq_u32 s45, 0
    s_cbranch_scc1 L_exit
    s_waitcnt vmcnt(0)
    s_barrier
    s_and_b32 s54, s45, 1
    s_xor_b32 s63, s54, 1
    s_lshl_b32 s54, 1, s63
    s_andn2_b32 s45, s45, s54
    s_mov_b32 s46, 1
    s_mov_b32 s65, 0x10000
    s_branch L_start
L_exit:
    s_endpgm
.section .rodata,"a"
.p2align 6
.amdhsa_kernel standalone__mha_softmax__near_ridge_kernel
  .amdhsa_next_free_vgpr 512
  .amdhsa_next_free_sgpr 88
  .amdhsa_accum_offset 256
  .amdhsa_group_segment_fixed_size 0
  .amdhsa_kernarg_size 48
  .amdhsa_user_sgpr_count 2
  .amdhsa_user_sgpr_kernarg_segment_ptr 1
  .amdhsa_system_sgpr_workgroup_id_x 1
.end_amdhsa_kernel
```
